```python
import torch

def _softmax(x, axis=-1):
    return torch.softmax(x, dim=axis)

def _gelu(x):
    return torch.nn.functional.gelu(x, approximate='tanh')

def _silu(x):
    return torch.nn.functional.silu(x)

def _sigmoid(x):
    return torch.sigmoid(x)

def _layernorm(x, axis=-1, eps=1e-05):
    m = x.mean(dim=axis, keepdim=True)
    v = x.var(dim=axis, keepdim=True, unbiased=False)
    return (x - m) / torch.sqrt(v + eps)

def _scatter_add(tgt, idx, src, axis=0):
    return tgt.clone().index_add_(axis, idx, src)

def _segment_sum(src, seg, n):
    out = torch.zeros((n,) + src.shape[1:], dtype=src.dtype)
    return out.index_add_(0, seg, src)

def _pad(x, pw):
    flat = tuple((v for pair in reversed(pw) for v in pair))
    return torch.nn.functional.pad(x, flat)
kernel_name = 'adaLN_cond__sliding_local_dilated__glu_gated_glu__prompt'

def setup_inputs():

    _w = lambda a: (lambda t: t.to(torch.bfloat16) if t.is_floating_point() else t)(torch.as_tensor(a))

    def _A_setup():
        B, S, D = (1, 2048, 512)
        return {'x': _w((lambda *s: torch.randn(*s, dtype=torch.bfloat16) * 0.05)(B, S, D)), 'wqkv': _w((lambda *s: torch.randn(*s, dtype=torch.bfloat16) * 0.05)(D, 3 * D)), 'wo': _w((lambda *s: torch.randn(*s, dtype=torch.bfloat16) * 0.05)(D, D))}
    _A_in = _A_setup()

    def _B_setup():
        B, S, D, F = (1, 2048, 512, 1792)
        return {'x': _w((lambda *s: torch.randn(*s, dtype=torch.bfloat16) * 0.05)(B, S, D)), 'w_gate': _w((lambda *s: torch.randn(*s, dtype=torch.bfloat16) * 0.05)(D, F)), 'w_up': _w((lambda *s: torch.randn(*s, dtype=torch.bfloat16) * 0.05)(D, F)), 'w_down': _w((lambda *s: torch.randn(*s, dtype=torch.bfloat16) * 0.05)(F, D))}
    _B_in = _B_setup()
    return {'A_x': _A_in['x'], 'A_wqkv': _A_in['wqkv'], 'A_wo': _A_in['wo'], 'B_x': _B_in['x'], 'B_w_gate': _B_in['w_gate'], 'B_w_up': _B_in['w_up'], 'B_w_down': _B_in['w_down'], 'c': _w((lambda *s: torch.randn(*s, dtype=torch.bfloat16) * 0.1)(1, 512) * 8.0), 'w_mod': _w((lambda *s: torch.randn(*s, dtype=torch.bfloat16) * 0.1)(512, 6 * 512) * 512 ** (-0.5) * 8.0)}

def reference(A_x, A_wqkv, A_wo, B_x, B_w_gate, B_w_up, B_w_down, c, w_mod):

    def _A_ref(x, wqkv, wo):
        B, S, D = x.shape
        H = 32
        Dh = D // H
        W, dil = (8, 2)
        qkv = (lambda x, *d: x.permute(*d))((x @ wqkv).reshape(B, S, 3, H, Dh), 2, 0, 3, 1, 4)
        q, k, v = (qkv[0], qkv[1], qkv[2])
        scale = Dh ** (-0.5)
        pos = torch.arange(S)
        off = torch.arange(W) * dil
        idx = pos[:, None] - off[None, :]
        mask = idx >= 0
        idx_c = torch.where(mask, idx, 0).reshape(-1)
        kg = k[:, :, idx_c, :].reshape(B, H, S, W, Dh)
        vg = v[:, :, idx_c, :].reshape(B, H, S, W, Dh)
        logits = torch.einsum('bhsd,bhswd->bhsw', q, kg) * scale
        logits = torch.where(mask[None, None, :, :], logits, -1000000000.0)
        attn = _softmax(logits, axis=-1)
        o = torch.einsum('bhsw,bhswd->bhsd', attn, vg)
        return (lambda x, *d: x.permute(*d))(o, 0, 2, 1, 3).reshape(B, S, D) @ wo

    def _B_ref(x, w_gate, w_up, w_down):
        g = torch.einsum('bsd,df->bsf', x, w_gate)
        u = torch.einsum('bsd,df->bsf', x, w_up)
        h = _sigmoid(g) * u
        return torch.einsum('bsf,fd->bsd', h, w_down)
    x = A_x
    mod = (_silu(c) @ w_mod).reshape(c.shape[0], 6, 1, -1)
    sa, ca, ga, sb, cb, gb = (mod[:, 0].clone(), mod[:, 1].clone(), mod[:, 2].clone(), mod[:, 3].clone(), mod[:, 4].clone(), mod[:, 5].clone())
    h = _layernorm(x, axis=-1) * (1 + ca) + sa
    x = x + ga * _A_ref(h, A_wqkv, A_wo)
    h = _layernorm(x, axis=-1) * (1 + cb) + sb
    x = x + gb * _B_ref(h, B_w_gate, B_w_up, B_w_down)
    return x
```

```asm
; @launch grid=(256,1,1) block=(512,1,1) lds=163840
.amdgcn_target "amdgcn-amd-amdhsa--gfx950"
.text
.globl adaLN_cond__sliding_local_dilated__glu_gated_glu__prompt_kernel
.p2align 8
.type adaLN_cond__sliding_local_dilated__glu_gated_glu__prompt_kernel,@function
adaLN_cond__sliding_local_dilated__glu_gated_glu__prompt_kernel:
    s_cmp_ge_u32 s2, 256
    s_cbranch_scc1 L_end
    s_load_dwordx4 s[4:7], s[0:1], 0
    s_load_dwordx2 s[8:9], s[0:1], 16
    s_load_dwordx8 s[12:19], s[0:1], 32
    s_load_dwordx8 s[20:27], s[0:1], 64
    s_getreg_b32 s50, hwreg(HW_REG_XCC_ID, 0, 4)
    v_and_b32 v1, 63, v0
    v_lshrrev_b32 v2, 6, v0
    s_and_b32 s45, s2, 7
    s_lshr_b32 s46, s2, 3
    v_readfirstlane_b32 s44, v2
    s_lshr_b32 s47, s46, 3
    s_and_b32 s48, s46, 7
    v_mov_b32 v255, 0

    s_getpc_b64 s[56:57]
L_pc0:
    s_sub_u32 s56, s56, L_pc0-adaLN_cond__sliding_local_dilated__glu_gated_glu__prompt_kernel
    s_subb_u32 s57, s57, 0
    s_mul_i32 s53, s46, (L_code_end-adaLN_cond__sliding_local_dilated__glu_gated_glu__prompt_kernel+128*32-1)/(128*32)
    v_add_u32 v3, s53, v1
    v_lshlrev_b32 v3, 7, v3
    s_mov_b32 s58, L_code_end-adaLN_cond__sliding_local_dilated__glu_gated_glu__prompt_kernel-4
    v_min_u32 v3, s58, v3
    v_cmp_le_u32 vcc, 448, v0
    v_cmp_gt_u32 s[80:81], 20, v1
    s_nop 1
    s_and_b64 vcc, vcc, s[80:81]
    s_and_saveexec_b64 s[82:83], vcc
    s_cbranch_execz L_noec
    global_load_dword v4, v3, s[56:57]
L_noec:
    s_mov_b64 exec, s[82:83]
    s_waitcnt lgkmcnt(0)
    s_mov_b32 s32, s26
    s_and_b32 s33, s27, 0xffff
    s_mov_b32 s34, 0x10000000
    s_mov_b32 s35, 0x20000
    s_cmp_ge_u32 s44, 4
    s_cbranch_scc1 L_loader
    s_cmp_ge_u32 s2, 32
    s_cbranch_scc1 L_c_nos0
    s_barrier
L_c_nos0:
    s_mov_b32 s36, s4
    s_and_b32 s37, s5, 0xffff
    s_mov_b32 s38, 0x200000
    s_mov_b32 s39, 0x20000
    s_lshl_b32 s52, s45, 8
    s_lshl_b32 s53, s47, 6
    s_add_u32 s52, s52, s53
    s_sub_u32 s52, s52, 16
    v_lshrrev_b32 v200, 3, v1
    v_add_u32 v200, s52, v200
    v_and_b32 v201, 7, v1
    v_lshlrev_b32 v201, 4, v201
    s_lshl_b32 s53, s44, 8
    v_add_u32 v201, s53, v201

    v_add_u32 v202, 0, v200
    v_max_i32 v202, 0, v202
    v_lshl_add_u32 v203, v202, 10, v201
    buffer_load_dwordx4 v[82:85], v203, s[36:39], 0 offen offset:0
    buffer_load_dwordx4 v[86:89], v203, s[36:39], 0 offen offset:128
    v_add_u32 v202, 8, v200
    v_max_i32 v202, 0, v202
    v_lshl_add_u32 v204, v202, 10, v201
    buffer_load_dwordx4 v[90:93], v204, s[36:39], 0 offen offset:0
    buffer_load_dwordx4 v[94:97], v204, s[36:39], 0 offen offset:128
    v_add_u32 v202, 16, v200
    v_lshl_add_u32 v203, v202, 10, v201
    buffer_load_dwordx4 v[98:101], v203, s[36:39], 0 offen offset:0
    buffer_load_dwordx4 v[102:105], v203, s[36:39], 0 offen offset:128
    v_add_u32 v202, 24, v200
    v_lshl_add_u32 v204, v202, 10, v201
    buffer_load_dwordx4 v[106:109], v204, s[36:39], 0 offen offset:0
    buffer_load_dwordx4 v[110:113], v204, s[36:39], 0 offen offset:128
    v_add_u32 v202, 32, v200
    v_lshl_add_u32 v203, v202, 10, v201
    buffer_load_dwordx4 v[114:117], v203, s[36:39], 0 offen offset:0
    buffer_load_dwordx4 v[118:121], v203, s[36:39], 0 offen offset:128
    v_add_u32 v202, 40, v200
    v_lshl_add_u32 v204, v202, 10, v201
    buffer_load_dwordx4 v[122:125], v204, s[36:39], 0 offen offset:0
    buffer_load_dwordx4 v[126:129], v204, s[36:39], 0 offen offset:128
    v_add_u32 v202, 48, v200
    v_lshl_add_u32 v203, v202, 10, v201
    buffer_load_dwordx4 v[130:133], v203, s[36:39], 0 offen offset:0
    buffer_load_dwordx4 v[134:137], v203, s[36:39], 0 offen offset:128
    v_add_u32 v202, 56, v200
    v_lshl_add_u32 v204, v202, 10, v201
    buffer_load_dwordx4 v[138:141], v204, s[36:39], 0 offen offset:0
    buffer_load_dwordx4 v[142:145], v204, s[36:39], 0 offen offset:128
    v_add_u32 v202, 64, v200
    v_lshl_add_u32 v203, v202, 10, v201
    buffer_load_dwordx4 v[146:149], v203, s[36:39], 0 offen offset:0
    buffer_load_dwordx4 v[150:153], v203, s[36:39], 0 offen offset:128
    v_add_u32 v202, 72, v200
    v_lshl_add_u32 v204, v202, 10, v201
    buffer_load_dwordx4 v[154:157], v204, s[36:39], 0 offen offset:0
    buffer_load_dwordx4 v[158:161], v204, s[36:39], 0 offen offset:128
    s_cmp_ge_u32 s2, 96
    s_cbranch_scc1 L_c2
    s_barrier
    s_branch L_c2
L_loader:
    s_sub_u32 s44, s44, 4
    s_cmp_lg_u32 s44, 1
    s_cbranch_scc1 L_l_nononce
    s_cmp_lg_u32 s2, 0
    s_cbranch_scc1 L_l_nononce
    s_memrealtime s[54:55]
    s_waitcnt lgkmcnt(0)
    s_or_b32 s54, s54, 1
    s_mov_b64 exec, 1
    v_mov_b32 v5, 132
    v_mov_b32 v6, s54
    global_store_dword v5, v6, s[24:25] sc1
    s_mov_b64 exec, -1

L_l_nononce:
    s_cmp_ge_u32 s2, 96
    s_cbranch_scc1 L_l_nop0a
    s_cmp_lt_u32 s2, 32
    s_cbranch_scc1 L_l_nos1b
    s_barrier
L_l_nos1b:
    s_mov_b32 s40, s20
    s_and_b32 s41, s21, 0xffff
    s_mov_b32 s42, 0x300000
    s_mov_b32 s43, 0x20000
    s_mov_b32 s36, s18
    s_and_b32 s37, s19, 0xffff
    s_mov_b32 s38, 0x400
    s_mov_b32 s39, 0x20000
    s_and_b32 s52, s2, 1
    s_lshl_b32 s52, s52, 8
    s_lshl_b32 s53, s44, 6
    s_add_u32 s52, s52, s53
    v_lshrrev_b32 v20, 3, v1
    v_add_u32 v20, s52, v20
    v_lshlrev_b32 v21, 1, v20
    v_mul_u32_u24 v20, 6144, v20
    v_and_b32 v22, 7, v1
    v_lshl_add_u32 v20, v22, 4, v20
    s_lshr_b32 s53, s2, 1
    s_lshl_b32 s54, s53, 7
    v_add_u32 v20, s54, v20

    buffer_load_ushort v24, v21, s[36:39], 0 offen offset:0
    buffer_load_ushort v25, v21, s[36:39], 0 offen offset:16
    buffer_load_ushort v26, v21, s[36:39], 0 offen offset:32
    buffer_load_ushort v27, v21, s[36:39], 0 offen offset:48
    buffer_load_ushort v28, v21, s[36:39], 0 offen offset:64
    buffer_load_ushort v29, v21, s[36:39], 0 offen offset:80
    buffer_load_ushort v30, v21, s[36:39], 0 offen offset:96
    buffer_load_ushort v31, v21, s[36:39], 0 offen offset:112
    s_mov_b32 s55, 0
    buffer_load_dwordx4 v[32:35], v20, s[40:43], s55 offen
    s_mov_b32 s55, 49152
    buffer_load_dwordx4 v[36:39], v20, s[40:43], s55 offen
    s_mov_b32 s55, 98304
    buffer_load_dwordx4 v[40:43], v20, s[40:43], s55 offen
    s_mov_b32 s55, 147456
    buffer_load_dwordx4 v[44:47], v20, s[40:43], s55 offen
    s_mov_b32 s55, 196608
    buffer_load_dwordx4 v[48:51], v20, s[40:43], s55 offen
    s_mov_b32 s55, 245760
    buffer_load_dwordx4 v[52:55], v20, s[40:43], s55 offen
    s_mov_b32 s55, 294912
    buffer_load_dwordx4 v[56:59], v20, s[40:43], s55 offen
    s_mov_b32 s55, 344064
    buffer_load_dwordx4 v[60:63], v20, s[40:43], s55 offen
    v_mov_b32 v6, 132
    global_load_dword v5, v6, s[24:25] sc1
    s_cmp_ge_u32 s2, 32
    s_cbranch_scc1 L_l_nos0
    s_barrier
L_l_nos0:
    s_branch L_l_nopref
L_l_nop0a:
    s_branch L_l_nocode0
    s_cmp_lg_u32 s44, 0
    s_cbranch_scc1 L_l_nocode
    s_getpc_b64 s[56:57]
L_pc:
    s_sub_u32 s56, s56, L_pc-adaLN_cond__sliding_local_dilated__glu_gated_glu__prompt_kernel
    s_subb_u32 s57, s57, 0
    s_sub_u32 s53, s46, 12
    s_mul_i32 s53, s53, (L_code_end-adaLN_cond__sliding_local_dilated__glu_gated_glu__prompt_kernel+128*20-1)/(128*20)
    v_add_u32 v2, s53, v1
    v_lshlrev_b32 v2, 7, v2
    s_mov_b32 s58, L_code_end-adaLN_cond__sliding_local_dilated__glu_gated_glu__prompt_kernel-4
    v_min_u32 v3, s58, v2
    s_mov_b32 exec_hi, 0
    global_load_dword v4, v3, s[56:57]
    s_mov_b64 exec, -1
    s_branch L_l_nopref
L_l_nocode0:
    s_cmp_eq_u32 s44, 0
    s_cbranch_scc1 L_l_nopref
L_l_nocode:
    s_sub_u32 s53, s2, 96
    s_mul_i32 s53, s53, 3
    s_add_u32 s53, s53, s44
    s_sub_u32 s53, s53, 1
    s_mul_i32 s53, s53, 35
    v_min_u32 v3, 34, v1
    v_add_u32 v3, s53, v3
    v_min_u32 v3, 16383, v3
    v_cmp_gt_u32 vcc, 12288, v3
    v_subrev_u32 v2, 12288, v3
    v_lshlrev_b32 v3, 7, v3
    v_lshlrev_b32 v2, 7, v2

    s_mov_b32 exec_lo, -1
    s_mov_b32 exec_hi, 0x7
    s_and_saveexec_b64 s[80:81], vcc
    s_cbranch_execz L_l_tq1
    global_load_dword v4, v3, s[6:7]
L_l_tq1:
    s_andn2_b64 exec, s[80:81], exec
    s_cbranch_execz L_l_tq2
    global_load_dword v4, v2, s[8:9]
L_l_tq2:
    s_mov_b64 exec, -1
L_l_nopref:
    s_mov_b32 s28, s6
    s_and_b32 s29, s7, 0xffff
    s_mov_b32 s30, 0x180000
    s_mov_b32 s31, 0x20000
    v_lshrrev_b32 v10, 3, v1
    s_lshl_b32 s53, s44, 3
    v_add_u32 v10, s53, v10
    v_mul_u32_u24 v10, 3072, v10
    v_lshrrev_b32 v11, 4, v1
    v_and_b32 v11, 1, v11
    v_lshlrev_b32 v11, 1, v11
    s_and_b32 s53, s44, 1
    s_lshl_b32 s53, s53, 2
    v_add_u32 v11, s53, v11
    v_and_b32 v12, 7, v1
    v_xor_b32 v11, v11, v12
    v_lshl_add_u32 v10, v11, 4, v10
    s_lshl_b32 s53, s48, 7
    v_add_u32 v10, s53, v10
    s_mul_i32 s62, s44, 3072
    s_add_u32 s62, s62, 81920

    s_cmp_lt_u32 s2, 32
    s_cbranch_scc1 L_l_q3_late
    s_cmp_lg_u32 s44, 3
    s_cbranch_scc1 L_l_q3_skip
    v_and_b32 v204, 15, v1
    s_lshl_b32 s53, s46, 4
    v_add_u32 v204, s53, v204
    v_mul_u32_u24 v204, 3072, v204
    v_lshrrev_b32 v205, 4, v1
    v_lshl_add_u32 v204, v205, 10, v204
    v_add_u32 v204, 384, v204

    s_mov_b32 exec_lo, -1
    s_mov_b32 exec_hi, 0xffff
    buffer_load_dword v205, v204, s[28:31], 0 offen
    s_mov_b64 exec, -1
L_l_q3_skip:
L_l_q3_late:
    s_cmp_ge_u32 s2, 32
    s_cbranch_scc1 L_l_nop0
    s_waitcnt vmcnt(8)
    s_mov_b32 s56, 0xffff0000
    s_mov_b32 s57, 0xbfb8aa3b
    v_lshlrev_b32 v24, 16, v24
    v_lshlrev_b32 v25, 16, v25
    v_lshlrev_b32 v26, 16, v26
    v_lshlrev_b32 v27, 16, v27
    v_lshlrev_b32 v28, 16, v28
    v_lshlrev_b32 v29, 16, v29
    v_lshlrev_b32 v30, 16, v30
    v_lshlrev_b32 v31, 16, v31
    v_mul_f32 v64, s57, v24
    v_mul_f32 v65, s57, v25
    v_mul_f32 v66, s57, v26
    v_mul_f32 v67, s57, v27
    v_mul_f32 v68, s57, v28
    v_mul_f32 v69, s57, v29
    v_mul_f32 v70, s57, v30
    v_mul_f32 v71, s57, v31
    v_exp_f32 v64, v64
    v_exp_f32 v65, v65
    v_exp_f32 v66, v66
    v_exp_f32 v67, v67
    v_exp_f32 v68, v68
    v_exp_f32 v69, v69
    v_exp_f32 v70, v70
    v_exp_f32 v71, v71
    s_nop 0
    v_add_f32 v64, 1.0, v64
    v_add_f32 v65, 1.0, v65
    v_add_f32 v66, 1.0, v66
    v_add_f32 v67, 1.0, v67
    v_add_f32 v68, 1.0, v68
    v_add_f32 v69, 1.0, v69
    v_add_f32 v70, 1.0, v70
    v_add_f32 v71, 1.0, v71
    v_rcp_f32 v64, v64
    v_rcp_f32 v65, v65
    v_rcp_f32 v66, v66
    v_rcp_f32 v67, v67
    v_rcp_f32 v68, v68
    v_rcp_f32 v69, v69
    v_rcp_f32 v70, v70
    v_rcp_f32 v71, v71
    s_nop 0
    v_mul_f32 v64, v64, v24
    v_mul_f32 v65, v65, v25
    v_mul_f32 v66, v66, v26
    v_mul_f32 v67, v67, v27
    v_mul_f32 v68, v68, v28
    v_mul_f32 v69, v69, v29
    v_mul_f32 v70, v70, v30
    v_mul_f32 v71, v71, v31
    v_cvt_pk_bf16_f32 v64, v64, v64
    v_cvt_pk_bf16_f32 v65, v65, v65
    v_cvt_pk_bf16_f32 v66, v66, v66
    v_cvt_pk_bf16_f32 v67, v67, v67
    v_cvt_pk_bf16_f32 v68, v68, v68
    v_cvt_pk_bf16_f32 v69, v69, v69
    v_cvt_pk_bf16_f32 v70, v70, v70
    v_cvt_pk_bf16_f32 v71, v71, v71
    v_and_b32 v24, 0xffff, v64
    v_and_b32 v64, s56, v64
    v_and_b32 v25, 0xffff, v65
    v_and_b32 v65, s56, v65
    v_and_b32 v26, 0xffff, v66
    v_and_b32 v66, s56, v66
    v_and_b32 v27, 0xffff, v67
    v_and_b32 v67, s56, v67
    v_and_b32 v28, 0xffff, v68
    v_and_b32 v68, s56, v68
    v_and_b32 v29, 0xffff, v69
    v_and_b32 v69, s56, v69
    v_and_b32 v30, 0xffff, v70
    v_and_b32 v70, s56, v70
    v_and_b32 v31, 0xffff, v71
    v_and_b32 v71, s56, v71
    v_mov_b32 v72, 0
    v_mov_b32 v73, 0
    v_mov_b32 v74, 0
    v_mov_b32 v75, 0
    v_mov_b32 v76, 0
    v_mov_b32 v77, 0
    v_mov_b32 v78, 0
    v_mov_b32 v79, 0
    s_waitcnt vmcnt(7)
    v_dot2c_f32_bf16 v72, v32, v24
    v_dot2c_f32_bf16 v73, v32, v64
    v_dot2c_f32_bf16 v74, v33, v24
    v_dot2c_f32_bf16 v75, v33, v64
    v_dot2c_f32_bf16 v76, v34, v24
    v_dot2c_f32_bf16 v77, v34, v64
    v_dot2c_f32_bf16 v78, v35, v24
    v_dot2c_f32_bf16 v79, v35, v64
    s_waitcnt vmcnt(6)
    v_dot2c_f32_bf16 v72, v36, v25
    v_dot2c_f32_bf16 v73, v36, v65
    v_dot2c_f32_bf16 v74, v37, v25
    v_dot2c_f32_bf16 v75, v37, v65
    v_dot2c_f32_bf16 v76, v38, v25
    v_dot2c_f32_bf16 v77, v38, v65
    v_dot2c_f32_bf16 v78, v39, v25
    v_dot2c_f32_bf16 v79, v39, v65
    s_waitcnt vmcnt(5)
    v_dot2c_f32_bf16 v72, v40, v26
    v_dot2c_f32_bf16 v73, v40, v66
    v_dot2c_f32_bf16 v74, v41, v26
    v_dot2c_f32_bf16 v75, v41, v66
    v_dot2c_f32_bf16 v76, v42, v26
    v_dot2c_f32_bf16 v77, v42, v66
    v_dot2c_f32_bf16 v78, v43, v26
    v_dot2c_f32_bf16 v79, v43, v66
    s_waitcnt vmcnt(4)
    v_dot2c_f32_bf16 v72, v44, v27
    v_dot2c_f32_bf16 v73, v44, v67
    v_dot2c_f32_bf16 v74, v45, v27
    v_dot2c_f32_bf16 v75, v45, v67
    v_dot2c_f32_bf16 v76, v46, v27
    v_dot2c_f32_bf16 v77, v46, v67
    v_dot2c_f32_bf16 v78, v47, v27
    v_dot2c_f32_bf16 v79, v47, v67
    s_waitcnt vmcnt(3)
    v_dot2c_f32_bf16 v72, v48, v28
    v_dot2c_f32_bf16 v73, v48, v68
    v_dot2c_f32_bf16 v74, v49, v28
    v_dot2c_f32_bf16 v75, v49, v68
    v_dot2c_f32_bf16 v76, v50, v28
    v_dot2c_f32_bf16 v77, v50, v68
    v_dot2c_f32_bf16 v78, v51, v28
    v_dot2c_f32_bf16 v79, v51, v68
    s_waitcnt vmcnt(2)
    v_dot2c_f32_bf16 v72, v52, v29
    v_dot2c_f32_bf16 v73, v52, v69
    v_dot2c_f32_bf16 v74, v53, v29
    v_dot2c_f32_bf16 v75, v53, v69
    v_dot2c_f32_bf16 v76, v54, v29
    v_dot2c_f32_bf16 v77, v54, v69
    v_dot2c_f32_bf16 v78, v55, v29
    v_dot2c_f32_bf16 v79, v55, v69
    s_waitcnt vmcnt(1)
    v_dot2c_f32_bf16 v72, v56, v30
    v_dot2c_f32_bf16 v73, v56, v70
    v_dot2c_f32_bf16 v74, v57, v30
    v_dot2c_f32_bf16 v75, v57, v70
    v_dot2c_f32_bf16 v76, v58, v30
    v_dot2c_f32_bf16 v77, v58, v70
    v_dot2c_f32_bf16 v78, v59, v30
    v_dot2c_f32_bf16 v79, v59, v70
    s_waitcnt vmcnt(0)
    v_dot2c_f32_bf16 v72, v60, v31
    v_dot2c_f32_bf16 v73, v60, v71
    v_dot2c_f32_bf16 v74, v61, v31
    v_dot2c_f32_bf16 v75, v61, v71
    v_dot2c_f32_bf16 v76, v62, v31
    v_dot2c_f32_bf16 v77, v62, v71
    v_dot2c_f32_bf16 v78, v63, v31
    v_dot2c_f32_bf16 v79, v63, v71
    s_nop 1
    v_permlane32_swap_b32 v72, v76
    v_permlane32_swap_b32 v73, v77
    v_permlane32_swap_b32 v74, v78
    v_permlane32_swap_b32 v75, v79
    s_nop 0
    v_add_f32 v72, v72, v76
    v_add_f32 v73, v73, v77
    v_add_f32 v74, v74, v78
    v_add_f32 v75, v75, v79
    s_nop 1
    v_permlane16_swap_b32 v72, v74
    v_permlane16_swap_b32 v73, v75
    s_nop 0
    v_add_f32 v72, v72, v74
    v_add_f32 v73, v73, v75
    s_nop 1
    v_add_f32_dpp v72, v72, v72 row_ror:8 row_mask:0xf bank_mask:0xf
    v_add_f32_dpp v73, v73, v73 row_ror:8 row_mask:0xf bank_mask:0xf
    v_and_b32 v20, 7, v1
    v_lshlrev_b32 v20, 3, v20
    v_lshrrev_b32 v21, 5, v1
    v_lshl_add_u32 v20, v21, 2, v20
    v_lshrrev_b32 v21, 4, v1
    v_and_b32 v21, 1, v21
    v_lshl_add_u32 v20, v21, 1, v20
    v_lshlrev_b32 v20, 2, v20
    s_lshl_b32 s53, s44, 8
    s_add_u32 s53, s53, 162304
    v_add_u32 v20, s53, v20
    ds_write_b64 v20, v[72:73]
    s_waitcnt lgkmcnt(0)

    s_barrier
    s_cmp_lg_u32 s44, 0
    s_cbranch_scc1 L_l_p0done
    v_lshlrev_b32 v20, 2, v1
    v_add_u32 v21, 162304, v20
    ds_read_b32 v24, v21
    ds_read_b32 v25, v21 offset:256
    ds_read_b32 v26, v21 offset:512
    ds_read_b32 v27, v21 offset:768
    s_and_b32 s52, s2, 1
    s_mul_i32 s52, s52, 12288
    s_lshr_b32 s53, s2, 1
    s_lshl_b32 s53, s53, 8
    s_add_u32 s52, s52, s53
    s_add_u32 s52, s52, 0
    s_waitcnt lgkmcnt(0)
    v_add_f32 v24, v24, v25
    v_add_f32 v26, v26, v27
    v_add_f32 v24, v24, v26

    s_and_b32 s52, s2, 1
    s_mul_i32 s52, s52, 24576
    s_lshr_b32 s53, s2, 1
    s_lshl_b32 s53, s53, 9
    s_add_u32 s52, s52, s53
    s_add_u32 s52, s52, 131072
    v_lshlrev_b32 v20, 3, v1
    v_mov_b32 v6, 132
    s_mov_b32 s72, 0

L_l_non:
    s_waitcnt vmcnt(0)
    v_readfirstlane_b32 s49, v5
    s_add_u32 s72, s72, 1
    s_cmp_gt_u32 s72, 0x100000
    s_cbranch_scc1 L_l_non_out
    s_cmp_lg_u32 s49, 0
    s_cbranch_scc1 L_l_non_out
    global_load_dword v5, v6, s[24:25] sc1
    s_branch L_l_non

L_l_non_out:
    v_mov_b32 v25, v5
    s_nop 0
    buffer_store_dwordx2 v[24:25], v20, s[32:35], s52 offen sc1
L_l_p0done:
    s_cmp_lg_u32 s44, 3
    s_cbranch_scc1 L_l_q3_skip2
    v_and_b32 v204, 15, v1
    s_lshl_b32 s53, s46, 4
    v_add_u32 v204, s53, v204
    v_mul_u32_u24 v204, 3072, v204
    v_lshrrev_b32 v205, 4, v1
    v_lshl_add_u32 v204, v205, 10, v204
    v_add_u32 v204, 384, v204

    s_mov_b32 exec_lo, -1
    s_mov_b32 exec_hi, 0xffff
    buffer_load_dword v205, v204, s[28:31], 0 offen
    s_mov_b64 exec, -1
L_l_q3_skip2:
L_l_nop0:
    s_branch L_loader2
L_c2:
    v_mov_b32 v182, 0x3f803f80
    s_waitcnt vmcnt(18)
    v_dot2_f32_bf16 v162, v82, v182, 0
    v_dot2_f32_bf16 v163, v82, v82, 0
    v_dot2c_f32_bf16 v162, v83, v182
    v_dot2c_f32_bf16 v163, v83, v83
    v_dot2c_f32_bf16 v162, v84, v182
    v_dot2c_f32_bf16 v163, v84, v84
    v_dot2c_f32_bf16 v162, v85, v182
    v_dot2c_f32_bf16 v163, v85, v85
    v_dot2c_f32_bf16 v162, v86, v182
    v_dot2c_f32_bf16 v163, v86, v86
    v_dot2c_f32_bf16 v162, v87, v182
    v_dot2c_f32_bf16 v163, v87, v87
    v_dot2c_f32_bf16 v162, v88, v182
    v_dot2c_f32_bf16 v163, v88, v88
    v_dot2c_f32_bf16 v162, v89, v182
    v_dot2c_f32_bf16 v163, v89, v89
    s_waitcnt vmcnt(16)
    v_dot2_f32_bf16 v164, v90, v182, 0
    v_dot2_f32_bf16 v165, v90, v90, 0
    v_dot2c_f32_bf16 v164, v91, v182
    v_dot2c_f32_bf16 v165, v91, v91
    v_dot2c_f32_bf16 v164, v92, v182
    v_dot2c_f32_bf16 v165, v92, v92
    v_dot2c_f32_bf16 v164, v93, v182
    v_dot2c_f32_bf16 v165, v93, v93
    v_dot2c_f32_bf16 v164, v94, v182
    v_dot2c_f32_bf16 v165, v94, v94
    v_dot2c_f32_bf16 v164, v95, v182
    v_dot2c_f32_bf16 v165, v95, v95
    v_dot2c_f32_bf16 v164, v96, v182
    v_dot2c_f32_bf16 v165, v96, v96
    v_dot2c_f32_bf16 v164, v97, v182
    v_dot2c_f32_bf16 v165, v97, v97
    s_waitcnt vmcnt(14)
    v_dot2_f32_bf16 v166, v98, v182, 0
    v_dot2_f32_bf16 v167, v98, v98, 0
    v_dot2c_f32_bf16 v166, v99, v182
    v_dot2c_f32_bf16 v167, v99, v99
    v_dot2c_f32_bf16 v166, v100, v182
    v_dot2c_f32_bf16 v167, v100, v100
    v_dot2c_f32_bf16 v166, v101, v182
    v_dot2c_f32_bf16 v167, v101, v101
    v_dot2c_f32_bf16 v166, v102, v182
    v_dot2c_f32_bf16 v167, v102, v102
    v_dot2c_f32_bf16 v166, v103, v182
    v_dot2c_f32_bf16 v167, v103, v103
    v_dot2c_f32_bf16 v166, v104, v182
    v_dot2c_f32_bf16 v167, v104, v104
    v_dot2c_f32_bf16 v166, v105, v182
    v_dot2c_f32_bf16 v167, v105, v105
    s_waitcnt vmcnt(12)
    v_dot2_f32_bf16 v168, v106, v182, 0
    v_dot2_f32_bf16 v169, v106, v106, 0
    v_dot2c_f32_bf16 v168, v107, v182
    v_dot2c_f32_bf16 v169, v107, v107
    v_dot2c_f32_bf16 v168, v108, v182
    v_dot2c_f32_bf16 v169, v108, v108
    v_dot2c_f32_bf16 v168, v109, v182
    v_dot2c_f32_bf16 v169, v109, v109
    v_dot2c_f32_bf16 v168, v110, v182
    v_dot2c_f32_bf16 v169, v110, v110
    v_dot2c_f32_bf16 v168, v111, v182
    v_dot2c_f32_bf16 v169, v111, v111
    v_dot2c_f32_bf16 v168, v112, v182
    v_dot2c_f32_bf16 v169, v112, v112
    v_dot2c_f32_bf16 v168, v113, v182
    v_dot2c_f32_bf16 v169, v113, v113
    s_waitcnt vmcnt(10)
    v_dot2_f32_bf16 v170, v114, v182, 0
    v_dot2_f32_bf16 v171, v114, v114, 0
    v_dot2c_f32_bf16 v170, v115, v182
    v_dot2c_f32_bf16 v171, v115, v115
    v_dot2c_f32_bf16 v170, v116, v182
    v_dot2c_f32_bf16 v171, v116, v116
    v_dot2c_f32_bf16 v170, v117, v182
    v_dot2c_f32_bf16 v171, v117, v117
    v_dot2c_f32_bf16 v170, v118, v182
    v_dot2c_f32_bf16 v171, v118, v118
    v_dot2c_f32_bf16 v170, v119, v182
    v_dot2c_f32_bf16 v171, v119, v119
    v_dot2c_f32_bf16 v170, v120, v182
    v_dot2c_f32_bf16 v171, v120, v120
    v_dot2c_f32_bf16 v170, v121, v182
    v_dot2c_f32_bf16 v171, v121, v121
    s_waitcnt vmcnt(8)
    v_dot2_f32_bf16 v172, v122, v182, 0
    v_dot2_f32_bf16 v173, v122, v122, 0
    v_dot2c_f32_bf16 v172, v123, v182
    v_dot2c_f32_bf16 v173, v123, v123
    v_dot2c_f32_bf16 v172, v124, v182
    v_dot2c_f32_bf16 v173, v124, v124
    v_dot2c_f32_bf16 v172, v125, v182
    v_dot2c_f32_bf16 v173, v125, v125
    v_dot2c_f32_bf16 v172, v126, v182
    v_dot2c_f32_bf16 v173, v126, v126
    v_dot2c_f32_bf16 v172, v127, v182
    v_dot2c_f32_bf16 v173, v127, v127
    v_dot2c_f32_bf16 v172, v128, v182
    v_dot2c_f32_bf16 v173, v128, v128
    v_dot2c_f32_bf16 v172, v129, v182
    v_dot2c_f32_bf16 v173, v129, v129
    s_waitcnt vmcnt(6)
    v_dot2_f32_bf16 v174, v130, v182, 0
    v_dot2_f32_bf16 v175, v130, v130, 0
    v_dot2c_f32_bf16 v174, v131, v182
    v_dot2c_f32_bf16 v175, v131, v131
    v_dot2c_f32_bf16 v174, v132, v182
    v_dot2c_f32_bf16 v175, v132, v132
    v_dot2c_f32_bf16 v174, v133, v182
    v_dot2c_f32_bf16 v175, v133, v133
    v_dot2c_f32_bf16 v174, v134, v182
    v_dot2c_f32_bf16 v175, v134, v134
    v_dot2c_f32_bf16 v174, v135, v182
    v_dot2c_f32_bf16 v175, v135, v135
    v_dot2c_f32_bf16 v174, v136, v182
    v_dot2c_f32_bf16 v175, v136, v136
    v_dot2c_f32_bf16 v174, v137, v182
    v_dot2c_f32_bf16 v175, v137, v137
    s_waitcnt vmcnt(4)
    v_dot2_f32_bf16 v176, v138, v182, 0
    v_dot2_f32_bf16 v177, v138, v138, 0
    v_dot2c_f32_bf16 v176, v139, v182
    v_dot2c_f32_bf16 v177, v139, v139
    v_dot2c_f32_bf16 v176, v140, v182
    v_dot2c_f32_bf16 v177, v140, v140
    v_dot2c_f32_bf16 v176, v141, v182
    v_dot2c_f32_bf16 v177, v141, v141
    v_dot2c_f32_bf16 v176, v142, v182
    v_dot2c_f32_bf16 v177, v142, v142
    v_dot2c_f32_bf16 v176, v143, v182
    v_dot2c_f32_bf16 v177, v143, v143
    v_dot2c_f32_bf16 v176, v144, v182
    v_dot2c_f32_bf16 v177, v144, v144
    v_dot2c_f32_bf16 v176, v145, v182
    v_dot2c_f32_bf16 v177, v145, v145
    s_waitcnt vmcnt(2)
    v_dot2_f32_bf16 v178, v146, v182, 0
    v_dot2_f32_bf16 v179, v146, v146, 0
    v_dot2c_f32_bf16 v178, v147, v182
    v_dot2c_f32_bf16 v179, v147, v147
    v_dot2c_f32_bf16 v178, v148, v182
    v_dot2c_f32_bf16 v179, v148, v148
    v_dot2c_f32_bf16 v178, v149, v182
    v_dot2c_f32_bf16 v179, v149, v149
    v_dot2c_f32_bf16 v178, v150, v182
    v_dot2c_f32_bf16 v179, v150, v150
    v_dot2c_f32_bf16 v178, v151, v182
    v_dot2c_f32_bf16 v179, v151, v151
    v_dot2c_f32_bf16 v178, v152, v182
    v_dot2c_f32_bf16 v179, v152, v152
    v_dot2c_f32_bf16 v178, v153, v182
    v_dot2c_f32_bf16 v179, v153, v153
    s_waitcnt vmcnt(0)
    v_dot2_f32_bf16 v180, v154, v182, 0
    v_dot2_f32_bf16 v181, v154, v154, 0
    v_dot2c_f32_bf16 v180, v155, v182
    v_dot2c_f32_bf16 v181, v155, v155
    v_dot2c_f32_bf16 v180, v156, v182
    v_dot2c_f32_bf16 v181, v156, v156
    v_dot2c_f32_bf16 v180, v157, v182
    v_dot2c_f32_bf16 v181, v157, v157
    v_dot2c_f32_bf16 v180, v158, v182
    v_dot2c_f32_bf16 v181, v158, v158
    v_dot2c_f32_bf16 v180, v159, v182
    v_dot2c_f32_bf16 v181, v159, v159
    v_dot2c_f32_bf16 v180, v160, v182
    v_dot2c_f32_bf16 v181, v160, v160
    v_dot2c_f32_bf16 v180, v161, v182
    v_dot2c_f32_bf16 v181, v161, v161
    s_nop 2
    v_add_f32_dpp v162, v162, v162 quad_perm:[1,0,3,2] row_mask:0xf bank_mask:0xf
    v_add_f32_dpp v163, v163, v163 quad_perm:[1,0,3,2] row_mask:0xf bank_mask:0xf
    v_add_f32_dpp v164, v164, v164 quad_perm:[1,0,3,2] row_mask:0xf bank_mask:0xf
    v_add_f32_dpp v165, v165, v165 quad_perm:[1,0,3,2] row_mask:0xf bank_mask:0xf
    v_add_f32_dpp v166, v166, v166 quad_perm:[1,0,3,2] row_mask:0xf bank_mask:0xf
    v_add_f32_dpp v167, v167, v167 quad_perm:[1,0,3,2] row_mask:0xf bank_mask:0xf
    v_add_f32_dpp v168, v168, v168 quad_perm:[1,0,3,2] row_mask:0xf bank_mask:0xf
    v_add_f32_dpp v169, v169, v169 quad_perm:[1,0,3,2] row_mask:0xf bank_mask:0xf
    v_add_f32_dpp v170, v170, v170 quad_perm:[1,0,3,2] row_mask:0xf bank_mask:0xf
    v_add_f32_dpp v171, v171, v171 quad_perm:[1,0,3,2] row_mask:0xf bank_mask:0xf
    v_add_f32_dpp v172, v172, v172 quad_perm:[1,0,3,2] row_mask:0xf bank_mask:0xf
    v_add_f32_dpp v173, v173, v173 quad_perm:[1,0,3,2] row_mask:0xf bank_mask:0xf
    v_add_f32_dpp v174, v174, v174 quad_perm:[1,0,3,2] row_mask:0xf bank_mask:0xf
    v_add_f32_dpp v175, v175, v175 quad_perm:[1,0,3,2] row_mask:0xf bank_mask:0xf
    v_add_f32_dpp v176, v176, v176 quad_perm:[1,0,3,2] row_mask:0xf bank_mask:0xf
    v_add_f32_dpp v177, v177, v177 quad_perm:[1,0,3,2] row_mask:0xf bank_mask:0xf
    v_add_f32_dpp v178, v178, v178 quad_perm:[1,0,3,2] row_mask:0xf bank_mask:0xf
    v_add_f32_dpp v179, v179, v179 quad_perm:[1,0,3,2] row_mask:0xf bank_mask:0xf
    v_add_f32_dpp v180, v180, v180 quad_perm:[1,0,3,2] row_mask:0xf bank_mask:0xf
    v_add_f32_dpp v181, v181, v181 quad_perm:[1,0,3,2] row_mask:0xf bank_mask:0xf
    v_add_f32_dpp v162, v162, v162 quad_perm:[2,3,0,1] row_mask:0xf bank_mask:0xf
    v_add_f32_dpp v163, v163, v163 quad_perm:[2,3,0,1] row_mask:0xf bank_mask:0xf
    v_add_f32_dpp v164, v164, v164 quad_perm:[2,3,0,1] row_mask:0xf bank_mask:0xf
    v_add_f32_dpp v165, v165, v165 quad_perm:[2,3,0,1] row_mask:0xf bank_mask:0xf
    v_add_f32_dpp v166, v166, v166 quad_perm:[2,3,0,1] row_mask:0xf bank_mask:0xf
    v_add_f32_dpp v167, v167, v167 quad_perm:[2,3,0,1] row_mask:0xf bank_mask:0xf
    v_add_f32_dpp v168, v168, v168 quad_perm:[2,3,0,1] row_mask:0xf bank_mask:0xf
    v_add_f32_dpp v169, v169, v169 quad_perm:[2,3,0,1] row_mask:0xf bank_mask:0xf
    v_add_f32_dpp v170, v170, v170 quad_perm:[2,3,0,1] row_mask:0xf bank_mask:0xf
    v_add_f32_dpp v171, v171, v171 quad_perm:[2,3,0,1] row_mask:0xf bank_mask:0xf
    v_add_f32_dpp v172, v172, v172 quad_perm:[2,3,0,1] row_mask:0xf bank_mask:0xf
    v_add_f32_dpp v173, v173, v173 quad_perm:[2,3,0,1] row_mask:0xf bank_mask:0xf
    v_add_f32_dpp v174, v174, v174 quad_perm:[2,3,0,1] row_mask:0xf bank_mask:0xf
    v_add_f32_dpp v175, v175, v175 quad_perm:[2,3,0,1] row_mask:0xf bank_mask:0xf
    v_add_f32_dpp v176, v176, v176 quad_perm:[2,3,0,1] row_mask:0xf bank_mask:0xf
    v_add_f32_dpp v177, v177, v177 quad_perm:[2,3,0,1] row_mask:0xf bank_mask:0xf
    v_add_f32_dpp v178, v178, v178 quad_perm:[2,3,0,1] row_mask:0xf bank_mask:0xf
    v_add_f32_dpp v179, v179, v179 quad_perm:[2,3,0,1] row_mask:0xf bank_mask:0xf
    v_add_f32_dpp v180, v180, v180 quad_perm:[2,3,0,1] row_mask:0xf bank_mask:0xf
    v_add_f32_dpp v181, v181, v181 quad_perm:[2,3,0,1] row_mask:0xf bank_mask:0xf
    v_add_f32_dpp v162, v162, v162 row_half_mirror row_mask:0xf bank_mask:0xf
    v_add_f32_dpp v163, v163, v163 row_half_mirror row_mask:0xf bank_mask:0xf
    v_add_f32_dpp v164, v164, v164 row_half_mirror row_mask:0xf bank_mask:0xf
    v_add_f32_dpp v165, v165, v165 row_half_mirror row_mask:0xf bank_mask:0xf
    v_add_f32_dpp v166, v166, v166 row_half_mirror row_mask:0xf bank_mask:0xf
    v_add_f32_dpp v167, v167, v167 row_half_mirror row_mask:0xf bank_mask:0xf
    v_add_f32_dpp v168, v168, v168 row_half_mirror row_mask:0xf bank_mask:0xf
    v_add_f32_dpp v169, v169, v169 row_half_mirror row_mask:0xf bank_mask:0xf
    v_add_f32_dpp v170, v170, v170 row_half_mirror row_mask:0xf bank_mask:0xf
    v_add_f32_dpp v171, v171, v171 row_half_mirror row_mask:0xf bank_mask:0xf
    v_add_f32_dpp v172, v172, v172 row_half_mirror row_mask:0xf bank_mask:0xf
    v_add_f32_dpp v173, v173, v173 row_half_mirror row_mask:0xf bank_mask:0xf
    v_add_f32_dpp v174, v174, v174 row_half_mirror row_mask:0xf bank_mask:0xf
    v_add_f32_dpp v175, v175, v175 row_half_mirror row_mask:0xf bank_mask:0xf
    v_add_f32_dpp v176, v176, v176 row_half_mirror row_mask:0xf bank_mask:0xf
    v_add_f32_dpp v177, v177, v177 row_half_mirror row_mask:0xf bank_mask:0xf
    v_add_f32_dpp v178, v178, v178 row_half_mirror row_mask:0xf bank_mask:0xf
    v_add_f32_dpp v179, v179, v179 row_half_mirror row_mask:0xf bank_mask:0xf
    v_add_f32_dpp v180, v180, v180 row_half_mirror row_mask:0xf bank_mask:0xf
    v_add_f32_dpp v181, v181, v181 row_half_mirror row_mask:0xf bank_mask:0xf
    v_lshrrev_b32 v200, 3, v1
    v_lshlrev_b32 v200, 5, v200
    s_lshl_b32 s53, s44, 3
    s_add_u32 s53, s53, 155648
    v_add_u32 v201, s53, v200
    v_add_u32 v208, 155648, v200

    ds_write_b64 v201, v[162:163] offset:0
    ds_write_b64 v201, v[164:165] offset:256
    ds_write_b64 v201, v[166:167] offset:512
    ds_write_b64 v201, v[168:169] offset:768
    ds_write_b64 v201, v[170:171] offset:1024
    ds_write_b64 v201, v[172:173] offset:1280
    ds_write_b64 v201, v[174:175] offset:1536
    ds_write_b64 v201, v[176:177] offset:1792
    ds_write_b64 v201, v[178:179] offset:2048
    ds_write_b64 v201, v[180:181] offset:2304
    s_waitcnt lgkmcnt(0)
    s_barrier
    s_mov_b32 s54, 0x3b000000
    s_mov_b32 s55, 0x3727c5ac
    ds_read_b128 v[224:227], v208 offset:0
    ds_read_b128 v[228:231], v208 offset:16
    ds_read_b128 v[232:235], v208 offset:256
    ds_read_b128 v[236:239], v208 offset:272
    s_waitcnt lgkmcnt(2)
    v_pk_add_f32 v[224:225], v[224:225], v[226:227]
    v_pk_add_f32 v[228:229], v[228:229], v[230:231]
    v_pk_add_f32 v[224:225], v[224:225], v[228:229]
    v_mul_f32 v224, s54, v224
    v_mul_f32 v225, s54, v225
    v_fma_f32 v225, -v224, v224, v225
    v_max_f32 v225, 0, v225
    v_add_f32 v225, s55, v225
    v_rsq_f32 v162, v225
    s_nop 0
    v_mul_f32 v224, v224, v162
    v_sub_f32 v163, 0, v224
    ds_read_b128 v[224:227], v208 offset:512
    ds_read_b128 v[228:231], v208 offset:528
    s_waitcnt lgkmcnt(2)
    v_pk_add_f32 v[232:233], v[232:233], v[234:235]
    v_pk_add_f32 v[236:237], v[236:237], v[238:239]
    v_pk_add_f32 v[232:233], v[232:233], v[236:237]
    v_mul_f32 v232, s54, v232
    v_mul_f32 v233, s54, v233
    v_fma_f32 v233, -v232, v232, v233
    v_max_f32 v233, 0, v233
    v_add_f32 v233, s55, v233
    v_rsq_f32 v164, v233
    s_nop 0
    v_mul_f32 v232, v232, v164
    v_sub_f32 v165, 0, v232
    ds_read_b128 v[232:235], v208 offset:768
    ds_read_b128 v[236:239], v208 offset:784
    s_waitcnt lgkmcnt(2)
    v_pk_add_f32 v[224:225], v[224:225], v[226:227]
    v_pk_add_f32 v[228:229], v[228:229], v[230:231]
    v_pk_add_f32 v[224:225], v[224:225], v[228:229]
    v_mul_f32 v224, s54, v224
    v_mul_f32 v225, s54, v225
    v_fma_f32 v225, -v224, v224, v225
    v_max_f32 v225, 0, v225
    v_add_f32 v225, s55, v225
    v_rsq_f32 v166, v225
    s_nop 0
    v_mul_f32 v224, v224, v166
    v_sub_f32 v167, 0, v224
    ds_read_b128 v[224:227], v208 offset:1024
    ds_read_b128 v[228:231], v208 offset:1040
    s_waitcnt lgkmcnt(2)
    v_pk_add_f32 v[232:233], v[232:233], v[234:235]
    v_pk_add_f32 v[236:237], v[236:237], v[238:239]
    v_pk_add_f32 v[232:233], v[232:233], v[236:237]
    v_mul_f32 v232, s54, v232
    v_mul_f32 v233, s54, v233
    v_fma_f32 v233, -v232, v232, v233
    v_max_f32 v233, 0, v233
    v_add_f32 v233, s55, v233
    v_rsq_f32 v168, v233
    s_nop 0
    v_mul_f32 v232, v232, v168
    v_sub_f32 v169, 0, v232
    ds_read_b128 v[232:235], v208 offset:1280
    ds_read_b128 v[236:239], v208 offset:1296
    s_waitcnt lgkmcnt(2)
    v_pk_add_f32 v[224:225], v[224:225], v[226:227]
    v_pk_add_f32 v[228:229], v[228:229], v[230:231]
    v_pk_add_f32 v[224:225], v[224:225], v[228:229]
    v_mul_f32 v224, s54, v224
    v_mul_f32 v225, s54, v225
    v_fma_f32 v225, -v224, v224, v225
    v_max_f32 v225, 0, v225
    v_add_f32 v225, s55, v225
    v_rsq_f32 v170, v225
    s_nop 0
    v_mul_f32 v224, v224, v170
    v_sub_f32 v171, 0, v224
    ds_read_b128 v[224:227], v208 offset:1536
    ds_read_b128 v[228:231], v208 offset:1552
    s_waitcnt lgkmcnt(2)
    v_pk_add_f32 v[232:233], v[232:233], v[234:235]
    v_pk_add_f32 v[236:237], v[236:237], v[238:239]
    v_pk_add_f32 v[232:233], v[232:233], v[236:237]
    v_mul_f32 v232, s54, v232
    v_mul_f32 v233, s54, v233
    v_fma_f32 v233, -v232, v232, v233
    v_max_f32 v233, 0, v233
    v_add_f32 v233, s55, v233
    v_rsq_f32 v172, v233
    s_nop 0
    v_mul_f32 v232, v232, v172
    v_sub_f32 v173, 0, v232
    ds_read_b128 v[232:235], v208 offset:1792
    ds_read_b128 v[236:239], v208 offset:1808
    s_waitcnt lgkmcnt(2)
    v_pk_add_f32 v[224:225], v[224:225], v[226:227]
    v_pk_add_f32 v[228:229], v[228:229], v[230:231]
    v_pk_add_f32 v[224:225], v[224:225], v[228:229]
    v_mul_f32 v224, s54, v224
    v_mul_f32 v225, s54, v225
    v_fma_f32 v225, -v224, v224, v225
    v_max_f32 v225, 0, v225
    v_add_f32 v225, s55, v225
    v_rsq_f32 v174, v225
    s_nop 0
    v_mul_f32 v224, v224, v174
    v_sub_f32 v175, 0, v224
    ds_read_b128 v[224:227], v208 offset:2048
    ds_read_b128 v[228:231], v208 offset:2064
    s_waitcnt lgkmcnt(2)
    v_pk_add_f32 v[232:233], v[232:233], v[234:235]
    v_pk_add_f32 v[236:237], v[236:237], v[238:239]
    v_pk_add_f32 v[232:233], v[232:233], v[236:237]
    v_mul_f32 v232, s54, v232
    v_mul_f32 v233, s54, v233
    v_fma_f32 v233, -v232, v232, v233
    v_max_f32 v233, 0, v233
    v_add_f32 v233, s55, v233
    v_rsq_f32 v176, v233
    s_nop 0
    v_mul_f32 v232, v232, v176
    v_sub_f32 v177, 0, v232
    ds_read_b128 v[232:235], v208 offset:2304
    ds_read_b128 v[236:239], v208 offset:2320
    s_waitcnt lgkmcnt(2)
    v_pk_add_f32 v[224:225], v[224:225], v[226:227]
    v_pk_add_f32 v[228:229], v[228:229], v[230:231]
    v_pk_add_f32 v[224:225], v[224:225], v[228:229]
    v_mul_f32 v224, s54, v224
    v_mul_f32 v225, s54, v225
    v_fma_f32 v225, -v224, v224, v225
    v_max_f32 v225, 0, v225
    v_add_f32 v225, s55, v225
    v_rsq_f32 v178, v225
    s_nop 0
    v_mul_f32 v224, v224, v178
    v_sub_f32 v179, 0, v224
    s_waitcnt lgkmcnt(0)
    v_pk_add_f32 v[232:233], v[232:233], v[234:235]
    v_pk_add_f32 v[236:237], v[236:237], v[238:239]
    v_pk_add_f32 v[232:233], v[232:233], v[236:237]
    v_mul_f32 v232, s54, v232
    v_mul_f32 v233, s54, v233
    v_fma_f32 v233, -v232, v232, v233
    v_max_f32 v233, 0, v233
    v_add_f32 v233, s55, v233
    v_rsq_f32 v180, v233
    s_nop 0
    v_mul_f32 v232, v232, v180
    v_sub_f32 v181, 0, v232
    s_mov_b32 s56, 0xffff0000
    .p2align 3
    v_lshlrev_b32 v2, 16, v82
    v_and_b32 v3, s56, v82
    v_pk_fma_f32 v[2:3], v[2:3], v[162:163], v[162:163] op_sel:[0,0,1] op_sel_hi:[1,0,1]
    v_lshlrev_b32 v4, 16, v83
    v_and_b32 v5, s56, v83
    v_pk_fma_f32 v[4:5], v[4:5], v[162:163], v[162:163] op_sel:[0,0,1] op_sel_hi:[1,0,1]
    v_lshlrev_b32 v6, 16, v84
    v_and_b32 v7, s56, v84
    v_pk_fma_f32 v[6:7], v[6:7], v[162:163], v[162:163] op_sel:[0,0,1] op_sel_hi:[1,0,1]
    v_lshlrev_b32 v8, 16, v85
    v_and_b32 v9, s56, v85
    v_pk_fma_f32 v[8:9], v[8:9], v[162:163], v[162:163] op_sel:[0,0,1] op_sel_hi:[1,0,1]
    v_lshlrev_b32 v10, 16, v86
    v_and_b32 v11, s56, v86
    v_pk_fma_f32 v[10:11], v[10:11], v[162:163], v[162:163] op_sel:[0,0,1] op_sel_hi:[1,0,1]
    v_lshlrev_b32 v12, 16, v87
    v_and_b32 v13, s56, v87
    v_pk_fma_f32 v[12:13], v[12:13], v[162:163], v[162:163] op_sel:[0,0,1] op_sel_hi:[1,0,1]
    v_lshlrev_b32 v14, 16, v88
    v_and_b32 v15, s56, v88
    v_pk_fma_f32 v[14:15], v[14:15], v[162:163], v[162:163] op_sel:[0,0,1] op_sel_hi:[1,0,1]
    v_lshlrev_b32 v16, 16, v89
    v_and_b32 v17, s56, v89
    v_pk_fma_f32 v[16:17], v[16:17], v[162:163], v[162:163] op_sel:[0,0,1] op_sel_hi:[1,0,1]
    v_lshlrev_b32 v18, 16, v90
    v_and_b32 v19, s56, v90
    v_pk_fma_f32 v[18:19], v[18:19], v[164:165], v[164:165] op_sel:[0,0,1] op_sel_hi:[1,0,1]
    v_lshlrev_b32 v20, 16, v91
    v_and_b32 v21, s56, v91
    v_pk_fma_f32 v[20:21], v[20:21], v[164:165], v[164:165] op_sel:[0,0,1] op_sel_hi:[1,0,1]
    v_lshlrev_b32 v22, 16, v92
    v_and_b32 v23, s56, v92
    v_pk_fma_f32 v[22:23], v[22:23], v[164:165], v[164:165] op_sel:[0,0,1] op_sel_hi:[1,0,1]
    v_lshlrev_b32 v24, 16, v93
    v_and_b32 v25, s56, v93
    v_pk_fma_f32 v[24:25], v[24:25], v[164:165], v[164:165] op_sel:[0,0,1] op_sel_hi:[1,0,1]
    v_lshlrev_b32 v26, 16, v94
    v_and_b32 v27, s56, v94
    v_pk_fma_f32 v[26:27], v[26:27], v[164:165], v[164:165] op_sel:[0,0,1] op_sel_hi:[1,0,1]
    v_lshlrev_b32 v28, 16, v95
    v_and_b32 v29, s56, v95
    v_pk_fma_f32 v[28:29], v[28:29], v[164:165], v[164:165] op_sel:[0,0,1] op_sel_hi:[1,0,1]
    v_lshlrev_b32 v30, 16, v96
    v_and_b32 v31, s56, v96
    v_pk_fma_f32 v[30:31], v[30:31], v[164:165], v[164:165] op_sel:[0,0,1] op_sel_hi:[1,0,1]
    v_lshlrev_b32 v32, 16, v97
    v_and_b32 v33, s56, v97
    v_pk_fma_f32 v[32:33], v[32:33], v[164:165], v[164:165] op_sel:[0,0,1] op_sel_hi:[1,0,1]
    v_lshlrev_b32 v34, 16, v98
    v_and_b32 v35, s56, v98
    v_pk_fma_f32 v[34:35], v[34:35], v[166:167], v[166:167] op_sel:[0,0,1] op_sel_hi:[1,0,1]
    v_lshlrev_b32 v36, 16, v99
    v_and_b32 v37, s56, v99
    v_pk_fma_f32 v[36:37], v[36:37], v[166:167], v[166:167] op_sel:[0,0,1] op_sel_hi:[1,0,1]
    v_lshlrev_b32 v38, 16, v100
    v_and_b32 v39, s56, v100
    v_pk_fma_f32 v[38:39], v[38:39], v[166:167], v[166:167] op_sel:[0,0,1] op_sel_hi:[1,0,1]
    v_lshlrev_b32 v40, 16, v101
    v_and_b32 v41, s56, v101
    v_pk_fma_f32 v[40:41], v[40:41], v[166:167], v[166:167] op_sel:[0,0,1] op_sel_hi:[1,0,1]
    v_lshlrev_b32 v42, 16, v102
    v_and_b32 v43, s56, v102
    v_pk_fma_f32 v[42:43], v[42:43], v[166:167], v[166:167] op_sel:[0,0,1] op_sel_hi:[1,0,1]
    v_lshlrev_b32 v44, 16, v103
    v_and_b32 v45, s56, v103
    v_pk_fma_f32 v[44:45], v[44:45], v[166:167], v[166:167] op_sel:[0,0,1] op_sel_hi:[1,0,1]
    v_lshlrev_b32 v46, 16, v104
    v_and_b32 v47, s56, v104
    v_pk_fma_f32 v[46:47], v[46:47], v[166:167], v[166:167] op_sel:[0,0,1] op_sel_hi:[1,0,1]
    v_lshlrev_b32 v48, 16, v105
    v_and_b32 v49, s56, v105
    v_pk_fma_f32 v[48:49], v[48:49], v[166:167], v[166:167] op_sel:[0,0,1] op_sel_hi:[1,0,1]
    v_lshlrev_b32 v50, 16, v106
    v_and_b32 v51, s56, v106
    v_pk_fma_f32 v[50:51], v[50:51], v[168:169], v[168:169] op_sel:[0,0,1] op_sel_hi:[1,0,1]
    v_lshlrev_b32 v52, 16, v107
    v_and_b32 v53, s56, v107
    v_pk_fma_f32 v[52:53], v[52:53], v[168:169], v[168:169] op_sel:[0,0,1] op_sel_hi:[1,0,1]
    v_lshlrev_b32 v54, 16, v108
    v_and_b32 v55, s56, v108
    v_pk_fma_f32 v[54:55], v[54:55], v[168:169], v[168:169] op_sel:[0,0,1] op_sel_hi:[1,0,1]
    v_lshlrev_b32 v56, 16, v109
    v_and_b32 v57, s56, v109
    v_pk_fma_f32 v[56:57], v[56:57], v[168:169], v[168:169] op_sel:[0,0,1] op_sel_hi:[1,0,1]
    v_lshlrev_b32 v58, 16, v110
    v_and_b32 v59, s56, v110
    v_pk_fma_f32 v[58:59], v[58:59], v[168:169], v[168:169] op_sel:[0,0,1] op_sel_hi:[1,0,1]
    v_lshlrev_b32 v60, 16, v111
    v_and_b32 v61, s56, v111
    v_pk_fma_f32 v[60:61], v[60:61], v[168:169], v[168:169] op_sel:[0,0,1] op_sel_hi:[1,0,1]
    v_lshlrev_b32 v62, 16, v112
    v_and_b32 v63, s56, v112
    v_pk_fma_f32 v[62:63], v[62:63], v[168:169], v[168:169] op_sel:[0,0,1] op_sel_hi:[1,0,1]
    v_lshlrev_b32 v64, 16, v113
    v_and_b32 v65, s56, v113
    v_pk_fma_f32 v[64:65], v[64:65], v[168:169], v[168:169] op_sel:[0,0,1] op_sel_hi:[1,0,1]
    v_lshlrev_b32 v66, 16, v114
    v_and_b32 v67, s56, v114
    v_pk_fma_f32 v[66:67], v[66:67], v[170:171], v[170:171] op_sel:[0,0,1] op_sel_hi:[1,0,1]
    v_lshlrev_b32 v68, 16, v115
    v_and_b32 v69, s56, v115
    v_pk_fma_f32 v[68:69], v[68:69], v[170:171], v[170:171] op_sel:[0,0,1] op_sel_hi:[1,0,1]
    v_lshlrev_b32 v70, 16, v116
    v_and_b32 v71, s56, v116
    v_pk_fma_f32 v[70:71], v[70:71], v[170:171], v[170:171] op_sel:[0,0,1] op_sel_hi:[1,0,1]
    v_lshlrev_b32 v72, 16, v117
    v_and_b32 v73, s56, v117
    v_pk_fma_f32 v[72:73], v[72:73], v[170:171], v[170:171] op_sel:[0,0,1] op_sel_hi:[1,0,1]
    v_lshlrev_b32 v74, 16, v118
    v_and_b32 v75, s56, v118
    v_pk_fma_f32 v[74:75], v[74:75], v[170:171], v[170:171] op_sel:[0,0,1] op_sel_hi:[1,0,1]
    v_lshlrev_b32 v76, 16, v119
    v_and_b32 v77, s56, v119
    v_pk_fma_f32 v[76:77], v[76:77], v[170:171], v[170:171] op_sel:[0,0,1] op_sel_hi:[1,0,1]
    v_lshlrev_b32 v78, 16, v120
    v_and_b32 v79, s56, v120
    v_pk_fma_f32 v[78:79], v[78:79], v[170:171], v[170:171] op_sel:[0,0,1] op_sel_hi:[1,0,1]
    v_lshlrev_b32 v80, 16, v121
    v_and_b32 v81, s56, v121
    v_pk_fma_f32 v[80:81], v[80:81], v[170:171], v[170:171] op_sel:[0,0,1] op_sel_hi:[1,0,1]
    v_lshlrev_b32 v82, 16, v122
    v_and_b32 v83, s56, v122
    v_pk_fma_f32 v[82:83], v[82:83], v[172:173], v[172:173] op_sel:[0,0,1] op_sel_hi:[1,0,1]
    v_lshlrev_b32 v84, 16, v123
    v_and_b32 v85, s56, v123
    v_pk_fma_f32 v[84:85], v[84:85], v[172:173], v[172:173] op_sel:[0,0,1] op_sel_hi:[1,0,1]
    v_lshlrev_b32 v86, 16, v124
    v_and_b32 v87, s56, v124
    v_pk_fma_f32 v[86:87], v[86:87], v[172:173], v[172:173] op_sel:[0,0,1] op_sel_hi:[1,0,1]
    v_lshlrev_b32 v88, 16, v125
    v_and_b32 v89, s56, v125
    v_pk_fma_f32 v[88:89], v[88:89], v[172:173], v[172:173] op_sel:[0,0,1] op_sel_hi:[1,0,1]
    v_lshlrev_b32 v90, 16, v126
    v_and_b32 v91, s56, v126
    v_pk_fma_f32 v[90:91], v[90:91], v[172:173], v[172:173] op_sel:[0,0,1] op_sel_hi:[1,0,1]
    v_lshlrev_b32 v92, 16, v127
    v_and_b32 v93, s56, v127
    v_pk_fma_f32 v[92:93], v[92:93], v[172:173], v[172:173] op_sel:[0,0,1] op_sel_hi:[1,0,1]
    v_lshlrev_b32 v94, 16, v128
    v_and_b32 v95, s56, v128
    v_pk_fma_f32 v[94:95], v[94:95], v[172:173], v[172:173] op_sel:[0,0,1] op_sel_hi:[1,0,1]
    v_lshlrev_b32 v96, 16, v129
    v_and_b32 v97, s56, v129
    v_pk_fma_f32 v[96:97], v[96:97], v[172:173], v[172:173] op_sel:[0,0,1] op_sel_hi:[1,0,1]
    v_lshlrev_b32 v98, 16, v130
    v_and_b32 v99, s56, v130
    v_pk_fma_f32 v[98:99], v[98:99], v[174:175], v[174:175] op_sel:[0,0,1] op_sel_hi:[1,0,1]
    v_lshlrev_b32 v100, 16, v131
    v_and_b32 v101, s56, v131
    v_pk_fma_f32 v[100:101], v[100:101], v[174:175], v[174:175] op_sel:[0,0,1] op_sel_hi:[1,0,1]
    v_lshlrev_b32 v102, 16, v132
    v_and_b32 v103, s56, v132
    v_pk_fma_f32 v[102:103], v[102:103], v[174:175], v[174:175] op_sel:[0,0,1] op_sel_hi:[1,0,1]
    v_lshlrev_b32 v104, 16, v133
    v_and_b32 v105, s56, v133
    v_pk_fma_f32 v[104:105], v[104:105], v[174:175], v[174:175] op_sel:[0,0,1] op_sel_hi:[1,0,1]
    v_lshlrev_b32 v106, 16, v134
    v_and_b32 v107, s56, v134
    v_pk_fma_f32 v[106:107], v[106:107], v[174:175], v[174:175] op_sel:[0,0,1] op_sel_hi:[1,0,1]
    v_lshlrev_b32 v108, 16, v135
    v_and_b32 v109, s56, v135
    v_pk_fma_f32 v[108:109], v[108:109], v[174:175], v[174:175] op_sel:[0,0,1] op_sel_hi:[1,0,1]
    v_lshlrev_b32 v110, 16, v136
    v_and_b32 v111, s56, v136
    v_pk_fma_f32 v[110:111], v[110:111], v[174:175], v[174:175] op_sel:[0,0,1] op_sel_hi:[1,0,1]
    v_lshlrev_b32 v112, 16, v137
    v_and_b32 v113, s56, v137
    v_pk_fma_f32 v[112:113], v[112:113], v[174:175], v[174:175] op_sel:[0,0,1] op_sel_hi:[1,0,1]
    v_lshlrev_b32 v114, 16, v138
    v_and_b32 v115, s56, v138
    v_pk_fma_f32 v[114:115], v[114:115], v[176:177], v[176:177] op_sel:[0,0,1] op_sel_hi:[1,0,1]
    v_lshlrev_b32 v116, 16, v139
    v_and_b32 v117, s56, v139
    v_pk_fma_f32 v[116:117], v[116:117], v[176:177], v[176:177] op_sel:[0,0,1] op_sel_hi:[1,0,1]
    v_lshlrev_b32 v118, 16, v140
    v_and_b32 v119, s56, v140
    v_pk_fma_f32 v[118:119], v[118:119], v[176:177], v[176:177] op_sel:[0,0,1] op_sel_hi:[1,0,1]
    v_lshlrev_b32 v120, 16, v141
    v_and_b32 v121, s56, v141
    v_pk_fma_f32 v[120:121], v[120:121], v[176:177], v[176:177] op_sel:[0,0,1] op_sel_hi:[1,0,1]
    v_lshlrev_b32 v122, 16, v142
    v_and_b32 v123, s56, v142
    v_pk_fma_f32 v[122:123], v[122:123], v[176:177], v[176:177] op_sel:[0,0,1] op_sel_hi:[1,0,1]
    v_lshlrev_b32 v124, 16, v143
    v_and_b32 v125, s56, v143
    v_pk_fma_f32 v[124:125], v[124:125], v[176:177], v[176:177] op_sel:[0,0,1] op_sel_hi:[1,0,1]
    v_lshlrev_b32 v126, 16, v144
    v_and_b32 v127, s56, v144
    v_pk_fma_f32 v[126:127], v[126:127], v[176:177], v[176:177] op_sel:[0,0,1] op_sel_hi:[1,0,1]
    v_lshlrev_b32 v128, 16, v145
    v_and_b32 v129, s56, v145
    v_pk_fma_f32 v[128:129], v[128:129], v[176:177], v[176:177] op_sel:[0,0,1] op_sel_hi:[1,0,1]
    s_lshl_b32 s53, s44, 10
    s_add_u32 s53, s53, 131072
    v_lshlrev_b32 v200, 4, v1
    v_add_u32 v200, s53, v200
    s_movk_i32 s57, 0x1000
    s_movk_i32 s58, 0x6000
    s_movk_i32 s59, 0x7000
    v_mov_b32 v201, 132
    s_mov_b32 s72, 0

    global_load_dword v202, v201, s[24:25] sc1
    buffer_load_dwordx4 v[184:187], v200, s[32:35], 0 offen sc1
    buffer_load_dwordx4 v[188:191], v200, s[32:35], s58 offen sc1
    buffer_load_dwordx4 v[192:195], v200, s[32:35], s57 offen sc1
    buffer_load_dwordx4 v[196:199], v200, s[32:35], s59 offen sc1
    s_barrier
    .p2align 3
    v_lshlrev_b32 v130, 16, v146
    v_and_b32 v131, s56, v146
    v_pk_fma_f32 v[130:131], v[130:131], v[178:179], v[178:179] op_sel:[0,0,1] op_sel_hi:[1,0,1]
    v_lshlrev_b32 v132, 16, v147
    v_and_b32 v133, s56, v147
    v_pk_fma_f32 v[132:133], v[132:133], v[178:179], v[178:179] op_sel:[0,0,1] op_sel_hi:[1,0,1]
    v_lshlrev_b32 v134, 16, v148
    v_and_b32 v135, s56, v148
    v_pk_fma_f32 v[134:135], v[134:135], v[178:179], v[178:179] op_sel:[0,0,1] op_sel_hi:[1,0,1]
    v_lshlrev_b32 v136, 16, v149
    v_and_b32 v137, s56, v149
    v_pk_fma_f32 v[136:137], v[136:137], v[178:179], v[178:179] op_sel:[0,0,1] op_sel_hi:[1,0,1]
    v_lshlrev_b32 v138, 16, v150
    v_and_b32 v139, s56, v150
    v_pk_fma_f32 v[138:139], v[138:139], v[178:179], v[178:179] op_sel:[0,0,1] op_sel_hi:[1,0,1]
    v_lshlrev_b32 v140, 16, v151
    v_and_b32 v141, s56, v151
    v_pk_fma_f32 v[140:141], v[140:141], v[178:179], v[178:179] op_sel:[0,0,1] op_sel_hi:[1,0,1]
    v_lshlrev_b32 v142, 16, v152
    v_and_b32 v143, s56, v152
    v_pk_fma_f32 v[142:143], v[142:143], v[178:179], v[178:179] op_sel:[0,0,1] op_sel_hi:[1,0,1]
    v_lshlrev_b32 v144, 16, v153
    v_and_b32 v145, s56, v153
    v_pk_fma_f32 v[144:145], v[144:145], v[178:179], v[178:179] op_sel:[0,0,1] op_sel_hi:[1,0,1]
    v_lshlrev_b32 v146, 16, v154
    v_and_b32 v147, s56, v154
    v_pk_fma_f32 v[146:147], v[146:147], v[180:181], v[180:181] op_sel:[0,0,1] op_sel_hi:[1,0,1]
    v_lshlrev_b32 v148, 16, v155
    v_and_b32 v149, s56, v155
    v_pk_fma_f32 v[148:149], v[148:149], v[180:181], v[180:181] op_sel:[0,0,1] op_sel_hi:[1,0,1]
    v_lshlrev_b32 v150, 16, v156
    v_and_b32 v151, s56, v156
    v_pk_fma_f32 v[150:151], v[150:151], v[180:181], v[180:181] op_sel:[0,0,1] op_sel_hi:[1,0,1]
    v_lshlrev_b32 v152, 16, v157
    v_and_b32 v153, s56, v157
    v_pk_fma_f32 v[152:153], v[152:153], v[180:181], v[180:181] op_sel:[0,0,1] op_sel_hi:[1,0,1]
    v_lshlrev_b32 v154, 16, v158
    v_and_b32 v155, s56, v158
    v_pk_fma_f32 v[154:155], v[154:155], v[180:181], v[180:181] op_sel:[0,0,1] op_sel_hi:[1,0,1]
    v_lshlrev_b32 v156, 16, v159
    v_and_b32 v157, s56, v159
    v_pk_fma_f32 v[156:157], v[156:157], v[180:181], v[180:181] op_sel:[0,0,1] op_sel_hi:[1,0,1]
    v_lshlrev_b32 v158, 16, v160
    v_and_b32 v159, s56, v160
    v_pk_fma_f32 v[158:159], v[158:159], v[180:181], v[180:181] op_sel:[0,0,1] op_sel_hi:[1,0,1]
    v_lshlrev_b32 v160, 16, v161
    v_and_b32 v161, s56, v161
    v_pk_fma_f32 v[160:161], v[160:161], v[180:181], v[180:181] op_sel:[0,0,1] op_sel_hi:[1,0,1]
    s_branch L_h0_chk
L_h0:
    global_load_dword v202, v201, s[24:25] sc1
    buffer_load_dwordx4 v[184:187], v200, s[32:35], 0 offen sc1
    buffer_load_dwordx4 v[188:191], v200, s[32:35], s58 offen sc1
    buffer_load_dwordx4 v[192:195], v200, s[32:35], s57 offen sc1
    buffer_load_dwordx4 v[196:199], v200, s[32:35], s59 offen sc1
L_h0_chk:
    s_add_u32 s72, s72, 1
    s_waitcnt vmcnt(0)
    v_xor_b32 v203, v185, v202
    v_xor_b32 v204, v187, v202
    v_xor_b32 v205, v189, v202
    v_xor_b32 v206, v191, v202
    v_or3_b32 v203, v203, v204, v205
    v_xor_b32 v204, v193, v202
    v_xor_b32 v205, v195, v202
    v_or3_b32 v203, v203, v206, v204
    v_xor_b32 v204, v197, v202
    v_xor_b32 v206, v199, v202
    v_or3_b32 v203, v203, v205, v204
    v_or_b32 v203, v203, v206
    v_readfirstlane_b32 s49, v202
    v_cmp_ne_u32 vcc, 0, v203
    s_cmp_gt_u32 s72, 0x100000
    s_cbranch_scc1 L_h0_out
    s_cmp_eq_u32 s49, 0
    s_cbranch_scc1 L_h0_again
    s_cbranch_vccz L_h0_out

L_h0_again:
    s_sleep 4
    s_branch L_h0
L_h0_out:
    v_add_f32 v184, v184, v188
    v_add_f32 v185, v186, v190
    v_add_f32 v188, v192, v196
    v_add_f32 v189, v194, v198

    s_lshl_b32 s53, s44, 10
    s_add_u32 s53, s53, 158208
    v_lshlrev_b32 v201, 3, v1
    v_add_u32 v201, s53, v201
    v_and_b32 v202, 7, v1
    v_lshlrev_b32 v203, 5, v202
    v_add_u32 v203, s53, v203

    v_lshrrev_b32 v204, 2, v202
    s_lshl_b32 s54, s44, 2
    v_add_u32 v204, s54, v204
    v_mul_u32_u24 v204, 5120, v204
    v_and_b32 v205, 3, v202
    v_lshl_add_u32 v204, v205, 8, v204
    v_lshrrev_b32 v205, 3, v1
    v_xor_b32 v205, v205, v202
    v_lshl_add_u32 v204, v205, 4, v204

    v_cvt_pk_bf16_f32 v186, v184, v185
    v_cvt_pk_bf16_f32 v190, v188, v189
    v_lshlrev_b32 v184, 16, v186
    v_and_b32 v185, s56, v186
    v_lshlrev_b32 v188, 16, v190
    v_and_b32 v189, s56, v190
    v_add_f32 v188, 1.0, v188
    v_add_f32 v189, 1.0, v189
    v_cvt_pk_bf16_f32 v190, v188, v189
    s_nop 0
    v_lshlrev_b32 v188, 16, v190
    v_and_b32 v189, s56, v190
    s_nop 0
    ds_write_b64 v201, v[188:189]
    ds_write_b64 v201, v[184:185] offset:512
    s_waitcnt lgkmcnt(0)

    ds_read_b128 v[208:211], v203 offset:0
    ds_read_b128 v[212:215], v203 offset:16
    ds_read_b128 v[224:227], v203 offset:512
    ds_read_b128 v[228:231], v203 offset:528
    ds_read_b128 v[216:219], v203 offset:256
    ds_read_b128 v[220:223], v203 offset:272
    ds_read_b128 v[232:235], v203 offset:768
    ds_read_b128 v[236:239], v203 offset:784
    .p2align 3
    s_waitcnt lgkmcnt(4)
    s_nop 0
    v_pk_fma_f32 v[2:3], v[2:3], v[208:209], v[224:225]
    v_pk_fma_f32 v[4:5], v[4:5], v[210:211], v[226:227]
    v_pk_fma_f32 v[6:7], v[6:7], v[212:213], v[228:229]
    v_pk_fma_f32 v[8:9], v[8:9], v[214:215], v[230:231]
    v_cvt_pk_bf16_f32 v184, v2, v3
    v_cvt_pk_bf16_f32 v185, v4, v5
    v_cvt_pk_bf16_f32 v186, v6, v7
    v_cvt_pk_bf16_f32 v187, v8, v9
    ds_write_b128 v204, v[184:187] offset:0
    v_pk_fma_f32 v[18:19], v[18:19], v[208:209], v[224:225]
    v_pk_fma_f32 v[20:21], v[20:21], v[210:211], v[226:227]
    v_pk_fma_f32 v[22:23], v[22:23], v[212:213], v[228:229]
    v_pk_fma_f32 v[24:25], v[24:25], v[214:215], v[230:231]
    v_cvt_pk_bf16_f32 v188, v18, v19
    v_cvt_pk_bf16_f32 v189, v20, v21
    v_cvt_pk_bf16_f32 v190, v22, v23
    v_cvt_pk_bf16_f32 v191, v24, v25
    ds_write_b128 v204, v[188:191] offset:128
    v_pk_fma_f32 v[34:35], v[34:35], v[208:209], v[224:225]
    v_pk_fma_f32 v[36:37], v[36:37], v[210:211], v[226:227]
    v_pk_fma_f32 v[38:39], v[38:39], v[212:213], v[228:229]
    v_pk_fma_f32 v[40:41], v[40:41], v[214:215], v[230:231]
    v_cvt_pk_bf16_f32 v184, v34, v35
    v_cvt_pk_bf16_f32 v185, v36, v37
    v_cvt_pk_bf16_f32 v186, v38, v39
    v_cvt_pk_bf16_f32 v187, v40, v41
    ds_write_b128 v204, v[184:187] offset:1024
    v_pk_fma_f32 v[50:51], v[50:51], v[208:209], v[224:225]
    v_pk_fma_f32 v[52:53], v[52:53], v[210:211], v[226:227]
    v_pk_fma_f32 v[54:55], v[54:55], v[212:213], v[228:229]
    v_pk_fma_f32 v[56:57], v[56:57], v[214:215], v[230:231]
    v_cvt_pk_bf16_f32 v188, v50, v51
    v_cvt_pk_bf16_f32 v189, v52, v53
    v_cvt_pk_bf16_f32 v190, v54, v55
    v_cvt_pk_bf16_f32 v191, v56, v57
    ds_write_b128 v204, v[188:191] offset:1152
    v_pk_fma_f32 v[66:67], v[66:67], v[208:209], v[224:225]
    v_pk_fma_f32 v[68:69], v[68:69], v[210:211], v[226:227]
    v_pk_fma_f32 v[70:71], v[70:71], v[212:213], v[228:229]
    v_pk_fma_f32 v[72:73], v[72:73], v[214:215], v[230:231]
    v_cvt_pk_bf16_f32 v184, v66, v67
    v_cvt_pk_bf16_f32 v185, v68, v69
    v_cvt_pk_bf16_f32 v186, v70, v71
    v_cvt_pk_bf16_f32 v187, v72, v73
    ds_write_b128 v204, v[184:187] offset:2048
    v_pk_fma_f32 v[82:83], v[82:83], v[208:209], v[224:225]
    v_pk_fma_f32 v[84:85], v[84:85], v[210:211], v[226:227]
    v_pk_fma_f32 v[86:87], v[86:87], v[212:213], v[228:229]
    v_pk_fma_f32 v[88:89], v[88:89], v[214:215], v[230:231]
    v_cvt_pk_bf16_f32 v188, v82, v83
    v_cvt_pk_bf16_f32 v189, v84, v85
    v_cvt_pk_bf16_f32 v190, v86, v87
    v_cvt_pk_bf16_f32 v191, v88, v89
    ds_write_b128 v204, v[188:191] offset:2176
    v_pk_fma_f32 v[98:99], v[98:99], v[208:209], v[224:225]
    v_pk_fma_f32 v[100:101], v[100:101], v[210:211], v[226:227]
    v_pk_fma_f32 v[102:103], v[102:103], v[212:213], v[228:229]
    v_pk_fma_f32 v[104:105], v[104:105], v[214:215], v[230:231]
    v_cvt_pk_bf16_f32 v184, v98, v99
    v_cvt_pk_bf16_f32 v185, v100, v101
    v_cvt_pk_bf16_f32 v186, v102, v103
    v_cvt_pk_bf16_f32 v187, v104, v105
    ds_write_b128 v204, v[184:187] offset:3072
    v_pk_fma_f32 v[114:115], v[114:115], v[208:209], v[224:225]
    v_pk_fma_f32 v[116:117], v[116:117], v[210:211], v[226:227]
    v_pk_fma_f32 v[118:119], v[118:119], v[212:213], v[228:229]
    v_pk_fma_f32 v[120:121], v[120:121], v[214:215], v[230:231]
    v_cvt_pk_bf16_f32 v188, v114, v115
    v_cvt_pk_bf16_f32 v189, v116, v117
    v_cvt_pk_bf16_f32 v190, v118, v119
    v_cvt_pk_bf16_f32 v191, v120, v121
    ds_write_b128 v204, v[188:191] offset:3200
    v_pk_fma_f32 v[130:131], v[130:131], v[208:209], v[224:225]
    v_pk_fma_f32 v[132:133], v[132:133], v[210:211], v[226:227]
    v_pk_fma_f32 v[134:135], v[134:135], v[212:213], v[228:229]
    v_pk_fma_f32 v[136:137], v[136:137], v[214:215], v[230:231]
    v_cvt_pk_bf16_f32 v184, v130, v131
    v_cvt_pk_bf16_f32 v185, v132, v133
    v_cvt_pk_bf16_f32 v186, v134, v135
    v_cvt_pk_bf16_f32 v187, v136, v137
    ds_write_b128 v204, v[184:187] offset:4096
    v_pk_fma_f32 v[146:147], v[146:147], v[208:209], v[224:225]
    v_pk_fma_f32 v[148:149], v[148:149], v[210:211], v[226:227]
    v_pk_fma_f32 v[150:151], v[150:151], v[212:213], v[228:229]
    v_pk_fma_f32 v[152:153], v[152:153], v[214:215], v[230:231]
    v_cvt_pk_bf16_f32 v188, v146, v147
    v_cvt_pk_bf16_f32 v189, v148, v149
    v_cvt_pk_bf16_f32 v190, v150, v151
    v_cvt_pk_bf16_f32 v191, v152, v153
    ds_write_b128 v204, v[188:191] offset:4224
    s_waitcnt lgkmcnt(10)
    s_nop 0
    v_pk_fma_f32 v[10:11], v[10:11], v[216:217], v[232:233]
    v_pk_fma_f32 v[12:13], v[12:13], v[218:219], v[234:235]
    v_pk_fma_f32 v[14:15], v[14:15], v[220:221], v[236:237]
    v_pk_fma_f32 v[16:17], v[16:17], v[222:223], v[238:239]
    v_cvt_pk_bf16_f32 v184, v10, v11
    v_cvt_pk_bf16_f32 v185, v12, v13
    v_cvt_pk_bf16_f32 v186, v14, v15
    v_cvt_pk_bf16_f32 v187, v16, v17
    ds_write_b128 v204, v[184:187] offset:10240
    v_pk_fma_f32 v[26:27], v[26:27], v[216:217], v[232:233]
    v_pk_fma_f32 v[28:29], v[28:29], v[218:219], v[234:235]
    v_pk_fma_f32 v[30:31], v[30:31], v[220:221], v[236:237]
    v_pk_fma_f32 v[32:33], v[32:33], v[222:223], v[238:239]
    v_cvt_pk_bf16_f32 v188, v26, v27
    v_cvt_pk_bf16_f32 v189, v28, v29
    v_cvt_pk_bf16_f32 v190, v30, v31
    v_cvt_pk_bf16_f32 v191, v32, v33
    ds_write_b128 v204, v[188:191] offset:10368
    v_pk_fma_f32 v[42:43], v[42:43], v[216:217], v[232:233]
    v_pk_fma_f32 v[44:45], v[44:45], v[218:219], v[234:235]
    v_pk_fma_f32 v[46:47], v[46:47], v[220:221], v[236:237]
    v_pk_fma_f32 v[48:49], v[48:49], v[222:223], v[238:239]
    v_cvt_pk_bf16_f32 v184, v42, v43
    v_cvt_pk_bf16_f32 v185, v44, v45
    v_cvt_pk_bf16_f32 v186, v46, v47
    v_cvt_pk_bf16_f32 v187, v48, v49
    ds_write_b128 v204, v[184:187] offset:11264
    v_pk_fma_f32 v[58:59], v[58:59], v[216:217], v[232:233]
    v_pk_fma_f32 v[60:61], v[60:61], v[218:219], v[234:235]
    v_pk_fma_f32 v[62:63], v[62:63], v[220:221], v[236:237]
    v_pk_fma_f32 v[64:65], v[64:65], v[222:223], v[238:239]
    v_cvt_pk_bf16_f32 v188, v58, v59
    v_cvt_pk_bf16_f32 v189, v60, v61
    v_cvt_pk_bf16_f32 v190, v62, v63
    v_cvt_pk_bf16_f32 v191, v64, v65
    ds_write_b128 v204, v[188:191] offset:11392
    v_pk_fma_f32 v[74:75], v[74:75], v[216:217], v[232:233]
    v_pk_fma_f32 v[76:77], v[76:77], v[218:219], v[234:235]
    v_pk_fma_f32 v[78:79], v[78:79], v[220:221], v[236:237]
    v_pk_fma_f32 v[80:81], v[80:81], v[222:223], v[238:239]
    v_cvt_pk_bf16_f32 v184, v74, v75
    v_cvt_pk_bf16_f32 v185, v76, v77
    v_cvt_pk_bf16_f32 v186, v78, v79
    v_cvt_pk_bf16_f32 v187, v80, v81
    ds_write_b128 v204, v[184:187] offset:12288
    v_pk_fma_f32 v[90:91], v[90:91], v[216:217], v[232:233]
    v_pk_fma_f32 v[92:93], v[92:93], v[218:219], v[234:235]
    v_pk_fma_f32 v[94:95], v[94:95], v[220:221], v[236:237]
    v_pk_fma_f32 v[96:97], v[96:97], v[222:223], v[238:239]
    v_cvt_pk_bf16_f32 v188, v90, v91
    v_cvt_pk_bf16_f32 v189, v92, v93
    v_cvt_pk_bf16_f32 v190, v94, v95
    v_cvt_pk_bf16_f32 v191, v96, v97
    ds_write_b128 v204, v[188:191] offset:12416
    v_pk_fma_f32 v[106:107], v[106:107], v[216:217], v[232:233]
    v_pk_fma_f32 v[108:109], v[108:109], v[218:219], v[234:235]
    v_pk_fma_f32 v[110:111], v[110:111], v[220:221], v[236:237]
    v_pk_fma_f32 v[112:113], v[112:113], v[222:223], v[238:239]
    v_cvt_pk_bf16_f32 v184, v106, v107
    v_cvt_pk_bf16_f32 v185, v108, v109
    v_cvt_pk_bf16_f32 v186, v110, v111
    v_cvt_pk_bf16_f32 v187, v112, v113
    ds_write_b128 v204, v[184:187] offset:13312
    v_pk_fma_f32 v[122:123], v[122:123], v[216:217], v[232:233]
    v_pk_fma_f32 v[124:125], v[124:125], v[218:219], v[234:235]
    v_pk_fma_f32 v[126:127], v[126:127], v[220:221], v[236:237]
    v_pk_fma_f32 v[128:129], v[128:129], v[222:223], v[238:239]
    v_cvt_pk_bf16_f32 v188, v122, v123
    v_cvt_pk_bf16_f32 v189, v124, v125
    v_cvt_pk_bf16_f32 v190, v126, v127
    v_cvt_pk_bf16_f32 v191, v128, v129
    ds_write_b128 v204, v[188:191] offset:13440
    v_pk_fma_f32 v[138:139], v[138:139], v[216:217], v[232:233]
    v_pk_fma_f32 v[140:141], v[140:141], v[218:219], v[234:235]
    v_pk_fma_f32 v[142:143], v[142:143], v[220:221], v[236:237]
    v_pk_fma_f32 v[144:145], v[144:145], v[222:223], v[238:239]
    v_cvt_pk_bf16_f32 v184, v138, v139
    v_cvt_pk_bf16_f32 v185, v140, v141
    v_cvt_pk_bf16_f32 v186, v142, v143
    v_cvt_pk_bf16_f32 v187, v144, v145
    ds_write_b128 v204, v[184:187] offset:14336
    v_pk_fma_f32 v[154:155], v[154:155], v[216:217], v[232:233]
    v_pk_fma_f32 v[156:157], v[156:157], v[218:219], v[234:235]
    v_pk_fma_f32 v[158:159], v[158:159], v[220:221], v[236:237]
    v_pk_fma_f32 v[160:161], v[160:161], v[222:223], v[238:239]
    v_cvt_pk_bf16_f32 v188, v154, v155
    v_cvt_pk_bf16_f32 v189, v156, v157
    v_cvt_pk_bf16_f32 v190, v158, v159
    v_cvt_pk_bf16_f32 v191, v160, v161
    ds_write_b128 v204, v[188:191] offset:14464
    v_mov_b32 v200, 163332
    v_mov_b32 v201, s49
    ds_write_b32 v200, v201
    s_waitcnt lgkmcnt(0)
    s_barrier
    v_lshrrev_b32 v200, 4, v1
    v_and_b32 v201, 15, v1
    v_xor_b32 v202, v201, v200
    v_lshlrev_b32 v202, 4, v202
    v_lshl_add_u32 v130, v200, 8, v202
    v_add_u32 v203, 4, v200
    v_xor_b32 v202, v201, v203
    v_lshlrev_b32 v202, 4, v202
    v_lshl_add_u32 v131, v200, 8, v202

    v_add_u32 v132, 61440, v130
    v_add_u32 v133, 61440, v131
    v_lshrrev_b32 v202, 2, v201
    v_and_b32 v203, 3, v1
    v_mul_u32_u24 v204, 3072, v200
    v_lshl_add_u32 v204, v202, 7, v204
    v_and_b32 v205, 1, v203
    v_lshl_add_u32 v204, v205, 3, v204
    v_lshrrev_b32 v205, 1, v203
    s_lshl_b32 s53, s44, 1
    v_add_u32 v205, s53, v205
    v_lshrrev_b32 v206, 1, v202
    v_lshlrev_b32 v206, 1, v206
    v_and_b32 v207, 1, v200
    v_lshl_add_u32 v206, v207, 2, v206
    v_xor_b32 v205, v205, v206
    v_lshl_add_u32 v134, v205, 4, v204
    v_add_u32 v134, 81920, v134

    ds_read_b64_tr_b16 v[104:105], v134 offset:0
    ds_read_b64_tr_b16 v[106:107], v134 offset:512
    ds_read_b64_tr_b16 v[108:109], v134 offset:1024
    ds_read_b64_tr_b16 v[110:111], v134 offset:1536
    ds_read_b64_tr_b16 v[112:113], v134 offset:2048
    ds_read_b64_tr_b16 v[114:115], v134 offset:2560
    ds_read_b128 v[64:67], v130 offset:0
    ds_read_b128 v[68:71], v130 offset:1024
    ds_read_b128 v[72:75], v130 offset:2048
    ds_read_b128 v[76:79], v130 offset:3072
    ds_read_b128 v[80:83], v130 offset:4096
    s_waitcnt lgkmcnt(0)
    s_barrier
    v_mfma_f32_16x16x32_bf16 v[20:23], v[108:111], v[64:67], 0
    ds_read_b64_tr_b16 v[120:121], v134 offset:13312
    ds_read_b64_tr_b16 v[122:123], v134 offset:13824
    v_mfma_f32_16x16x32_bf16 v[40:43], v[64:67], v[112:115], 0
    ds_read_b64_tr_b16 v[124:125], v134 offset:14336
    ds_read_b64_tr_b16 v[126:127], v134 offset:14848
    v_mfma_f32_16x16x32_bf16 v[24:27], v[108:111], v[68:71], 0
    ds_read_b128 v[84:87], v131 offset:5120
    ds_read_b128 v[88:91], v131 offset:6144
    v_mfma_f32_16x16x32_bf16 v[44:47], v[68:71], v[112:115], 0
    ds_read_b64_tr_b16 v[116:117], v134 offset:12288
    ds_read_b64_tr_b16 v[118:119], v134 offset:12800
    v_mfma_f32_16x16x32_bf16 v[4:7], v[104:107], v[68:71], 0
    ds_read_b128 v[92:95], v131 offset:7168
    ds_read_b128 v[96:99], v131 offset:8192
    v_mfma_f32_16x16x32_bf16 v[28:31], v[108:111], v[72:75], 0
    ds_read_b128 v[100:103], v131 offset:9216
    v_mfma_f32_16x16x32_bf16 v[48:51], v[72:75], v[112:115], 0
    v_mfma_f32_16x16x32_bf16 v[8:11], v[104:107], v[72:75], 0
    v_mfma_f32_16x16x32_bf16 v[32:35], v[108:111], v[76:79], 0
    v_mfma_f32_16x16x32_bf16 v[52:55], v[76:79], v[112:115], 0
    v_mfma_f32_16x16x32_bf16 v[12:15], v[104:107], v[76:79], 0
    v_mfma_f32_16x16x32_bf16 v[36:39], v[108:111], v[80:83], 0
    v_mfma_f32_16x16x32_bf16 v[56:59], v[80:83], v[112:115], 0
    v_mfma_f32_16x16x32_bf16 v[16:19], v[104:107], v[80:83], 0
    s_waitcnt lgkmcnt(0)
    v_mfma_f32_16x16x32_bf16 v[20:23], v[120:123], v[84:87], v[20:23]
    ds_read_b64_tr_b16 v[108:109], v134 offset:25600
    ds_read_b64_tr_b16 v[110:111], v134 offset:26112
    v_mfma_f32_16x16x32_bf16 v[40:43], v[84:87], v[124:127], v[40:43]
    ds_read_b64_tr_b16 v[112:113], v134 offset:26624
    ds_read_b64_tr_b16 v[114:115], v134 offset:27136
    v_mfma_f32_16x16x32_bf16 v[24:27], v[120:123], v[88:91], v[24:27]
    ds_read_b128 v[64:67], v130 offset:10240
    ds_read_b128 v[68:71], v130 offset:11264
    v_mfma_f32_16x16x32_bf16 v[44:47], v[88:91], v[124:127], v[44:47]
    ds_read_b64_tr_b16 v[104:105], v134 offset:24576
    ds_read_b64_tr_b16 v[106:107], v134 offset:25088
    v_mfma_f32_16x16x32_bf16 v[4:7], v[116:119], v[88:91], v[4:7]
    ds_read_b128 v[72:75], v130 offset:12288
    ds_read_b128 v[76:79], v130 offset:13312
    v_mfma_f32_16x16x32_bf16 v[28:31], v[120:123], v[92:95], v[28:31]
    ds_read_b128 v[80:83], v130 offset:14336
    v_mfma_f32_16x16x32_bf16 v[48:51], v[92:95], v[124:127], v[48:51]
    v_and_b32 v136, 15, v1
    v_lshrrev_b32 v137, 4, v1
    v_mfma_f32_16x16x32_bf16 v[8:11], v[116:119], v[92:95], v[8:11]
    v_and_b32 v138, 1, v136
    v_lshlrev_b32 v139, 2, v137
    v_mfma_f32_16x16x32_bf16 v[32:35], v[120:123], v[96:99], v[32:35]
    v_add_u32 v139, v139, v138
    v_cmp_eq_u32 s[80:81], 1, v138
    v_mfma_f32_16x16x32_bf16 v[52:55], v[96:99], v[124:127], v[52:55]
    v_cmp_le_u32 s[82:83], v139, v136
    v_add_u32 v140, 2, v139
    v_mfma_f32_16x16x32_bf16 v[12:15], v[116:119], v[96:99], v[12:15]
    v_cmp_le_u32 s[84:85], v140, v136
    v_mfma_f32_16x16x32_bf16 v[36:39], v[120:123], v[100:103], v[36:39]
    v_mov_b32 v141, 0x0c0c0100
    v_mfma_f32_16x16x32_bf16 v[56:59], v[100:103], v[124:127], v[56:59]
    v_mov_b32 v142, 0x01000c0c
    v_mfma_f32_16x16x32_bf16 v[16:19], v[116:119], v[100:103], v[16:19]
    v_mov_b32 v143, 0x0c0c0302
    s_waitcnt lgkmcnt(0)
    s_barrier
    v_mfma_f32_16x16x32_bf16 v[20:23], v[108:111], v[64:67], v[20:23]
    ds_read_b64_tr_b16 v[120:121], v134 offset:37888
    ds_read_b64_tr_b16 v[122:123], v134 offset:38400
    v_mfma_f32_16x16x32_bf16 v[40:43], v[64:67], v[112:115], v[40:43]
    ds_read_b64_tr_b16 v[124:125], v134 offset:38912
    ds_read_b64_tr_b16 v[126:127], v134 offset:39424
    v_mfma_f32_16x16x32_bf16 v[24:27], v[108:111], v[68:71], v[24:27]
    ds_read_b128 v[84:87], v131 offset:15360
    ds_read_b128 v[88:91], v131 offset:16384
    v_mfma_f32_16x16x32_bf16 v[44:47], v[68:71], v[112:115], v[44:47]
    ds_read_b64_tr_b16 v[116:117], v134 offset:36864
    ds_read_b64_tr_b16 v[118:119], v134 offset:37376
    v_mfma_f32_16x16x32_bf16 v[4:7], v[104:107], v[68:71], v[4:7]
    ds_read_b128 v[92:95], v131 offset:17408
    ds_read_b128 v[96:99], v131 offset:18432
    v_mfma_f32_16x16x32_bf16 v[28:31], v[108:111], v[72:75], v[28:31]
    ds_read_b128 v[100:103], v131 offset:19456
    v_mfma_f32_16x16x32_bf16 v[48:51], v[72:75], v[112:115], v[48:51]
    v_mov_b32 v144, 0x03020c0c
    v_mov_b32 v145, 0x0c0c0c0c
    v_mfma_f32_16x16x32_bf16 v[8:11], v[104:107], v[72:75], v[8:11]
    v_cndmask_b32 v141, v141, v142, s[80:81]
    v_cndmask_b32 v143, v143, v144, s[80:81]
    v_mfma_f32_16x16x32_bf16 v[32:35], v[108:111], v[76:79], v[32:35]
    v_cndmask_b32 v146, v141, v145, s[82:83]
    v_cndmask_b32 v147, v143, v145, s[84:85]
    v_mfma_f32_16x16x32_bf16 v[52:55], v[76:79], v[112:115], v[52:55]
    v_cndmask_b32 v148, v145, v141, s[82:83]
    v_cndmask_b32 v149, v145, v143, s[84:85]
    v_mfma_f32_16x16x32_bf16 v[12:15], v[104:107], v[76:79], v[12:15]
    s_or_b32 s53, s45, s47
    v_mfma_f32_16x16x32_bf16 v[36:39], v[108:111], v[80:83], v[36:39]
    s_cmp_eq_u32 s53, 0
    v_mfma_f32_16x16x32_bf16 v[56:59], v[80:83], v[112:115], v[56:59]
    s_cselect_b32 s54, 0xf149f2ca, 0
    v_mfma_f32_16x16x32_bf16 v[16:19], v[104:107], v[80:83], v[16:19]
    v_mov_b32 v150, s54
    s_waitcnt lgkmcnt(0)
    v_mfma_f32_16x16x32_bf16 v[20:23], v[120:123], v[84:87], v[20:23]
    ds_read_b64_tr_b16 v[108:109], v134 offset:50176
    ds_read_b64_tr_b16 v[110:111], v134 offset:50688
    v_mfma_f32_16x16x32_bf16 v[40:43], v[84:87], v[124:127], v[40:43]
    ds_read_b64_tr_b16 v[112:113], v134 offset:51200
    ds_read_b64_tr_b16 v[114:115], v134 offset:51712
    v_mfma_f32_16x16x32_bf16 v[24:27], v[120:123], v[88:91], v[24:27]
    ds_read_b128 v[64:67], v130 offset:20480
    ds_read_b128 v[68:71], v130 offset:21504
    v_mfma_f32_16x16x32_bf16 v[44:47], v[88:91], v[124:127], v[44:47]
    ds_read_b64_tr_b16 v[104:105], v134 offset:49152
    ds_read_b64_tr_b16 v[106:107], v134 offset:49664
    v_mfma_f32_16x16x32_bf16 v[4:7], v[116:119], v[88:91], v[4:7]
    ds_read_b128 v[72:75], v130 offset:22528
    ds_read_b128 v[76:79], v130 offset:23552
    v_mfma_f32_16x16x32_bf16 v[28:31], v[120:123], v[92:95], v[28:31]
    ds_read_b128 v[80:83], v130 offset:24576
    v_mfma_f32_16x16x32_bf16 v[48:51], v[92:95], v[124:127], v[48:51]
    v_mov_b32 v151, 0
    v_cndmask_b32 v152, v150, v151, s[82:83]
    v_mfma_f32_16x16x32_bf16 v[8:11], v[116:119], v[92:95], v[8:11]
    v_cndmask_b32 v153, v150, v151, s[84:85]
    v_and_b32 v154, 1, v137
    v_mfma_f32_16x16x32_bf16 v[32:35], v[120:123], v[96:99], v[32:35]
    v_lshlrev_b32 v154, 9, v154
    v_lshl_add_u32 v154, v136, 4, v154
    v_mfma_f32_16x16x32_bf16 v[52:55], v[96:99], v[124:127], v[52:55]
    v_lshrrev_b32 v155, 1, v137
    v_lshl_add_u32 v154, v155, 3, v154
    v_mfma_f32_16x16x32_bf16 v[12:15], v[116:119], v[96:99], v[12:15]
    s_lshl_b32 s53, s45, 3
    v_mfma_f32_16x16x32_bf16 v[36:39], v[120:123], v[100:103], v[36:39]
    s_lshl_b32 s54, s47, 1
    v_mfma_f32_16x16x32_bf16 v[56:59], v[100:103], v[124:127], v[56:59]
    s_add_u32 s53, s53, s54
    v_mfma_f32_16x16x32_bf16 v[16:19], v[116:119], v[100:103], v[16:19]
    s_lshl_b32 s53, s53, 5
    s_waitcnt lgkmcnt(0)
    s_barrier
    v_mfma_f32_16x16x32_bf16 v[20:23], v[108:111], v[64:67], v[20:23]
    ds_read_b64_tr_b16 v[120:121], v134 offset:62464
    ds_read_b64_tr_b16 v[122:123], v134 offset:62976
    v_mfma_f32_16x16x32_bf16 v[40:43], v[64:67], v[112:115], v[40:43]
    ds_read_b64_tr_b16 v[124:125], v134 offset:63488
    ds_read_b64_tr_b16 v[126:127], v134 offset:64000
    v_mfma_f32_16x16x32_bf16 v[24:27], v[108:111], v[68:71], v[24:27]
    ds_read_b128 v[84:87], v131 offset:25600
    ds_read_b128 v[88:91], v131 offset:26624
    v_mfma_f32_16x16x32_bf16 v[44:47], v[68:71], v[112:115], v[44:47]
    ds_read_b64_tr_b16 v[116:117], v134 offset:61440
    ds_read_b64_tr_b16 v[118:119], v134 offset:61952
    v_mfma_f32_16x16x32_bf16 v[4:7], v[104:107], v[68:71], v[4:7]
    ds_read_b128 v[92:95], v131 offset:27648
    ds_read_b128 v[96:99], v131 offset:28672
    v_mfma_f32_16x16x32_bf16 v[28:31], v[108:111], v[72:75], v[28:31]
    ds_read_b128 v[100:103], v131 offset:29696
    v_mfma_f32_16x16x32_bf16 v[48:51], v[72:75], v[112:115], v[48:51]
    s_lshl_b32 s54, s48, 2
    s_add_u32 s53, s53, s54
    v_mfma_f32_16x16x32_bf16 v[8:11], v[104:107], v[72:75], v[8:11]
    s_add_u32 s53, s53, s44
    s_lshl_b32 s53, s53, 10
    v_mfma_f32_16x16x32_bf16 v[32:35], v[108:111], v[76:79], v[32:35]
    s_add_u32 s60, s53, 1048576
    s_add_u32 s61, s60, 32768
    v_mfma_f32_16x16x32_bf16 v[52:55], v[76:79], v[112:115], v[52:55]
    s_lshl_b32 s52, s45, 8
    s_lshl_b32 s53, s47, 6
    v_mfma_f32_16x16x32_bf16 v[12:15], v[104:107], v[76:79], v[12:15]
    s_add_u32 s52, s52, s53
    v_mfma_f32_16x16x32_bf16 v[36:39], v[108:111], v[80:83], v[36:39]
    s_lshr_b32 s53, s44, 1
    v_mfma_f32_16x16x32_bf16 v[56:59], v[80:83], v[112:115], v[56:59]
    s_lshl_b32 s53, s53, 5
    v_mfma_f32_16x16x32_bf16 v[16:19], v[104:107], v[80:83], v[16:19]
    s_add_u32 s52, s52, s53
    s_waitcnt lgkmcnt(0)
    v_mfma_f32_16x16x32_bf16 v[20:23], v[120:123], v[84:87], v[20:23]
    ds_read_b64_tr_b16 v[108:109], v134 offset:1024
    ds_read_b64_tr_b16 v[110:111], v134 offset:1536
    v_mfma_f32_16x16x32_bf16 v[40:43], v[84:87], v[124:127], v[40:43]
    ds_read_b64_tr_b16 v[112:113], v134 offset:2048
    ds_read_b64_tr_b16 v[114:115], v134 offset:2560
    v_mfma_f32_16x16x32_bf16 v[24:27], v[120:123], v[88:91], v[24:27]
    ds_read_b128 v[64:67], v130 offset:30720
    ds_read_b128 v[68:71], v130 offset:31744
    v_mfma_f32_16x16x32_bf16 v[44:47], v[88:91], v[124:127], v[44:47]
    ds_read_b64_tr_b16 v[104:105], v134 offset:0
    ds_read_b64_tr_b16 v[106:107], v134 offset:512
    v_mfma_f32_16x16x32_bf16 v[4:7], v[116:119], v[88:91], v[4:7]
    ds_read_b128 v[72:75], v130 offset:32768
    ds_read_b128 v[76:79], v130 offset:33792
    v_mfma_f32_16x16x32_bf16 v[28:31], v[120:123], v[92:95], v[28:31]
    ds_read_b128 v[80:83], v130 offset:34816
    v_mfma_f32_16x16x32_bf16 v[48:51], v[92:95], v[124:127], v[48:51]
    v_and_b32 v236, 31, v1
    v_add_u32 v236, s52, v236
    v_mfma_f32_16x16x32_bf16 v[8:11], v[116:119], v[92:95], v[8:11]
    v_lshlrev_b32 v236, 10, v236
    v_lshrrev_b32 v237, 5, v1
    v_mfma_f32_16x16x32_bf16 v[32:35], v[120:123], v[96:99], v[32:35]
    v_lshl_add_u32 v236, v237, 3, v236
    s_lshl_b32 s52, s48, 7
    v_mfma_f32_16x16x32_bf16 v[52:55], v[96:99], v[124:127], v[52:55]
    s_and_b32 s53, s44, 1
    s_lshl_b32 s53, s53, 6
    v_mfma_f32_16x16x32_bf16 v[12:15], v[116:119], v[96:99], v[12:15]
    s_add_u32 s52, s52, s53
    v_mfma_f32_16x16x32_bf16 v[36:39], v[120:123], v[100:103], v[36:39]
    v_add_u32 v236, s52, v236
    v_mfma_f32_16x16x32_bf16 v[56:59], v[100:103], v[124:127], v[56:59]
    buffer_load_dwordx2 v[240:241], v236, s[36:39], 0 offen offset:0
    v_mfma_f32_16x16x32_bf16 v[16:19], v[116:119], v[100:103], v[16:19]
    buffer_load_dwordx2 v[242:243], v236, s[36:39], 0 offen offset:16
    s_waitcnt lgkmcnt(0)
    s_barrier
    v_mfma_f32_16x16x32_bf16 v[20:23], v[108:111], v[64:67], v[20:23]
    ds_read_b64_tr_b16 v[120:121], v134 offset:13312
    ds_read_b64_tr_b16 v[122:123], v134 offset:13824
    v_mfma_f32_16x16x32_bf16 v[40:43], v[64:67], v[112:115], v[40:43]
    ds_read_b64_tr_b16 v[124:125], v134 offset:14336
    ds_read_b64_tr_b16 v[126:127], v134 offset:14848
    v_mfma_f32_16x16x32_bf16 v[24:27], v[108:111], v[68:71], v[24:27]
    ds_read_b128 v[84:87], v131 offset:35840
    ds_read_b128 v[88:91], v131 offset:36864
    v_mfma_f32_16x16x32_bf16 v[44:47], v[68:71], v[112:115], v[44:47]
    ds_read_b64_tr_b16 v[116:117], v134 offset:12288
    ds_read_b64_tr_b16 v[118:119], v134 offset:12800
    v_mfma_f32_16x16x32_bf16 v[4:7], v[104:107], v[68:71], v[4:7]
    ds_read_b128 v[92:95], v131 offset:37888
    ds_read_b128 v[96:99], v131 offset:38912
    v_mfma_f32_16x16x32_bf16 v[28:31], v[108:111], v[72:75], v[28:31]
    ds_read_b128 v[100:103], v131 offset:39936
    v_mfma_f32_16x16x32_bf16 v[48:51], v[72:75], v[112:115], v[48:51]
    buffer_load_dwordx2 v[244:245], v236, s[36:39], 0 offen offset:32
    buffer_load_dwordx2 v[246:247], v236, s[36:39], 0 offen offset:48
    v_mfma_f32_16x16x32_bf16 v[8:11], v[104:107], v[72:75], v[8:11]
    s_and_b32 s57, s44, 1
    s_lshr_b32 s58, s44, 1
    v_mfma_f32_16x16x32_bf16 v[32:35], v[108:111], v[76:79], v[32:35]
    s_lshl_b32 s52, s45, 12
    s_lshl_b32 s53, s47, 7
    v_mfma_f32_16x16x32_bf16 v[52:55], v[76:79], v[112:115], v[52:55]
    s_add_u32 s52, s52, s53
    s_lshl_b32 s53, s57, 6
    v_mfma_f32_16x16x32_bf16 v[12:15], v[104:107], v[76:79], v[12:15]
    s_add_u32 s52, s52, s53
    v_mfma_f32_16x16x32_bf16 v[36:39], v[108:111], v[80:83], v[36:39]
    s_add_u32 s52, s52, 65536
    v_mfma_f32_16x16x32_bf16 v[56:59], v[80:83], v[112:115], v[56:59]
    v_lshlrev_b32 v157, 2, v1
    v_mfma_f32_16x16x32_bf16 v[16:19], v[104:107], v[80:83], v[16:19]
    v_add_u32 v157, s52, v157
    s_waitcnt lgkmcnt(0)
    v_mfma_f32_16x16x32_bf16 v[20:23], v[120:123], v[84:87], v[20:23]
    ds_read_b64_tr_b16 v[108:109], v134 offset:25600
    ds_read_b64_tr_b16 v[110:111], v134 offset:26112
    v_mfma_f32_16x16x32_bf16 v[40:43], v[84:87], v[124:127], v[40:43]
    ds_read_b64_tr_b16 v[112:113], v134 offset:26624
    ds_read_b64_tr_b16 v[114:115], v134 offset:27136
    v_mfma_f32_16x16x32_bf16 v[24:27], v[120:123], v[88:91], v[24:27]
    ds_read_b128 v[64:67], v130 offset:40960
    ds_read_b128 v[68:71], v130 offset:41984
    v_mfma_f32_16x16x32_bf16 v[44:47], v[88:91], v[124:127], v[44:47]
    ds_read_b64_tr_b16 v[104:105], v134 offset:24576
    ds_read_b64_tr_b16 v[106:107], v134 offset:25088
    v_mfma_f32_16x16x32_bf16 v[4:7], v[116:119], v[88:91], v[4:7]
    ds_read_b128 v[72:75], v130 offset:43008
    ds_read_b128 v[76:79], v130 offset:44032
    v_mfma_f32_16x16x32_bf16 v[28:31], v[120:123], v[92:95], v[28:31]
    ds_read_b128 v[80:83], v130 offset:45056
    v_mfma_f32_16x16x32_bf16 v[48:51], v[92:95], v[124:127], v[48:51]
    s_lshl_b32 s52, s45, 3
    s_lshl_b32 s53, s47, 1
    v_mfma_f32_16x16x32_bf16 v[8:11], v[116:119], v[92:95], v[8:11]
    s_add_u32 s52, s52, s53
    s_add_u32 s59, s52, s58
    v_mfma_f32_16x16x32_bf16 v[32:35], v[120:123], v[96:99], v[32:35]
    s_lshl_b32 s52, s59, 5
    s_lshl_b32 s53, s57, 4
    v_mfma_f32_16x16x32_bf16 v[52:55], v[96:99], v[124:127], v[52:55]
    s_add_u32 s52, s52, s53
    s_lshl_b32 s52, s52, 10
    v_mfma_f32_16x16x32_bf16 v[12:15], v[116:119], v[96:99], v[12:15]
    s_add_u32 s62, s52, 1048576
    v_mfma_f32_16x16x32_bf16 v[36:39], v[120:123], v[100:103], v[36:39]
    v_lshlrev_b32 v0, 4, v1
    v_mfma_f32_16x16x32_bf16 v[56:59], v[100:103], v[124:127], v[56:59]
    v_lshrrev_b32 v200, 4, v1
    v_mfma_f32_16x16x32_bf16 v[16:19], v[116:119], v[100:103], v[16:19]
    v_and_b32 v201, 1, v200
    s_waitcnt lgkmcnt(0)
    s_barrier
    v_mfma_f32_16x16x32_bf16 v[20:23], v[108:111], v[64:67], v[20:23]
    ds_read_b64_tr_b16 v[120:121], v134 offset:37888
    ds_read_b64_tr_b16 v[122:123], v134 offset:38400
    v_mfma_f32_16x16x32_bf16 v[40:43], v[64:67], v[112:115], v[40:43]
    ds_read_b64_tr_b16 v[124:125], v134 offset:38912
    ds_read_b64_tr_b16 v[126:127], v134 offset:39424
    v_mfma_f32_16x16x32_bf16 v[24:27], v[108:111], v[68:71], v[24:27]
    ds_read_b128 v[84:87], v131 offset:46080
    ds_read_b128 v[88:91], v131 offset:47104
    v_mfma_f32_16x16x32_bf16 v[44:47], v[68:71], v[112:115], v[44:47]
    ds_read_b64_tr_b16 v[116:117], v134 offset:36864
    ds_read_b64_tr_b16 v[118:119], v134 offset:37376
    v_mfma_f32_16x16x32_bf16 v[4:7], v[104:107], v[68:71], v[4:7]
    ds_read_b128 v[92:95], v131 offset:48128
    ds_read_b128 v[96:99], v131 offset:49152
    v_mfma_f32_16x16x32_bf16 v[28:31], v[108:111], v[72:75], v[28:31]
    ds_read_b128 v[100:103], v131 offset:50176
    v_mfma_f32_16x16x32_bf16 v[48:51], v[72:75], v[112:115], v[48:51]
    v_lshrrev_b32 v200, 1, v200
    v_and_b32 v202, 15, v1
    v_mfma_f32_16x16x32_bf16 v[8:11], v[104:107], v[72:75], v[8:11]
    v_lshrrev_b32 v203, 2, v202
    v_and_b32 v204, 3, v1
    v_mfma_f32_16x16x32_bf16 v[32:35], v[108:111], v[76:79], v[32:35]
    v_lshl_add_u32 v205, v200, 2, v203
    v_lshlrev_b32 v205, 7, v205
    v_mfma_f32_16x16x32_bf16 v[52:55], v[76:79], v[112:115], v[52:55]
    v_and_b32 v206, 1, v204
    v_lshl_add_u32 v205, v206, 3, v205
    v_mfma_f32_16x16x32_bf16 v[12:15], v[104:107], v[76:79], v[12:15]
    v_lshrrev_b32 v206, 1, v204
    v_mfma_f32_16x16x32_bf16 v[36:39], v[108:111], v[80:83], v[36:39]
    v_lshl_add_u32 v206, v201, 1, v206
    v_mfma_f32_16x16x32_bf16 v[56:59], v[80:83], v[112:115], v[56:59]
    v_lshrrev_b32 v207, 1, v203
    v_mfma_f32_16x16x32_bf16 v[16:19], v[104:107], v[80:83], v[16:19]
    v_lshlrev_b32 v207, 2, v207
    s_waitcnt lgkmcnt(0)
    v_mfma_f32_16x16x32_bf16 v[20:23], v[120:123], v[84:87], v[20:23]
    ds_read_b64_tr_b16 v[108:109], v134 offset:50176
    ds_read_b64_tr_b16 v[110:111], v134 offset:50688
    v_mfma_f32_16x16x32_bf16 v[40:43], v[84:87], v[124:127], v[40:43]
    ds_read_b64_tr_b16 v[112:113], v134 offset:51200
    ds_read_b64_tr_b16 v[114:115], v134 offset:51712
    v_mfma_f32_16x16x32_bf16 v[24:27], v[120:123], v[88:91], v[24:27]
    ds_read_b128 v[64:67], v130 offset:51200
    ds_read_b128 v[68:71], v130 offset:52224
    v_mfma_f32_16x16x32_bf16 v[44:47], v[88:91], v[124:127], v[44:47]
    ds_read_b64_tr_b16 v[104:105], v134 offset:49152
    ds_read_b64_tr_b16 v[106:107], v134 offset:49664
    v_mfma_f32_16x16x32_bf16 v[4:7], v[116:119], v[88:91], v[4:7]
    ds_read_b128 v[72:75], v130 offset:53248
    ds_read_b128 v[76:79], v130 offset:54272
    v_mfma_f32_16x16x32_bf16 v[28:31], v[120:123], v[92:95], v[28:31]
    ds_read_b128 v[80:83], v130 offset:55296
    v_mfma_f32_16x16x32_bf16 v[48:51], v[92:95], v[124:127], v[48:51]
    v_xor_b32 v208, v206, v207
    v_lshl_add_u32 v232, v208, 4, v205
    v_mfma_f32_16x16x32_bf16 v[8:11], v[116:119], v[92:95], v[8:11]
    v_add_u32 v206, 4, v206
    v_xor_b32 v208, v206, v207
    v_mfma_f32_16x16x32_bf16 v[32:35], v[120:123], v[96:99], v[32:35]
    v_lshl_add_u32 v233, v208, 4, v205
    s_lshl_b32 s53, s57, 15
    v_mfma_f32_16x16x32_bf16 v[52:55], v[96:99], v[124:127], v[52:55]
    v_add_u32 v234, s53, v232
    v_add_u32 v235, s53, v233
    v_mfma_f32_16x16x32_bf16 v[12:15], v[116:119], v[96:99], v[12:15]
    v_mfma_f32_16x16x32_bf16 v[36:39], v[120:123], v[100:103], v[36:39]
    v_mfma_f32_16x16x32_bf16 v[56:59], v[100:103], v[124:127], v[56:59]
    v_mfma_f32_16x16x32_bf16 v[16:19], v[116:119], v[100:103], v[16:19]
    s_waitcnt lgkmcnt(0)
    s_barrier
    v_mfma_f32_16x16x32_bf16 v[20:23], v[108:111], v[64:67], v[20:23]
    ds_read_b64_tr_b16 v[120:121], v134 offset:62464
    ds_read_b64_tr_b16 v[122:123], v134 offset:62976
    v_mfma_f32_16x16x32_bf16 v[40:43], v[64:67], v[112:115], v[40:43]
    ds_read_b64_tr_b16 v[124:125], v134 offset:63488
    ds_read_b64_tr_b16 v[126:127], v134 offset:64000
    v_mfma_f32_16x16x32_bf16 v[24:27], v[108:111], v[68:71], v[24:27]
    ds_read_b128 v[84:87], v131 offset:56320
    ds_read_b128 v[88:91], v131 offset:57344
    v_mfma_f32_16x16x32_bf16 v[44:47], v[68:71], v[112:115], v[44:47]
    ds_read_b64_tr_b16 v[116:117], v134 offset:61440
    ds_read_b64_tr_b16 v[118:119], v134 offset:61952
    v_mfma_f32_16x16x32_bf16 v[4:7], v[104:107], v[68:71], v[4:7]
    ds_read_b128 v[92:95], v131 offset:58368
    ds_read_b128 v[96:99], v131 offset:59392
    v_mfma_f32_16x16x32_bf16 v[28:31], v[108:111], v[72:75], v[28:31]
    ds_read_b128 v[100:103], v131 offset:60416
    v_mfma_f32_16x16x32_bf16 v[48:51], v[72:75], v[112:115], v[48:51]
    v_mfma_f32_16x16x32_bf16 v[8:11], v[104:107], v[72:75], v[8:11]
    v_mfma_f32_16x16x32_bf16 v[32:35], v[108:111], v[76:79], v[32:35]
    v_mfma_f32_16x16x32_bf16 v[52:55], v[76:79], v[112:115], v[52:55]
    v_mfma_f32_16x16x32_bf16 v[12:15], v[104:107], v[76:79], v[12:15]
    v_mfma_f32_16x16x32_bf16 v[36:39], v[108:111], v[80:83], v[36:39]
    v_mfma_f32_16x16x32_bf16 v[56:59], v[80:83], v[112:115], v[56:59]
    v_mfma_f32_16x16x32_bf16 v[16:19], v[104:107], v[80:83], v[16:19]
    s_waitcnt lgkmcnt(0)
    v_mfma_f32_16x16x32_bf16 v[20:23], v[120:123], v[84:87], v[20:23]
    ds_read_b64_tr_b16 v[108:109], v134 offset:1024
    ds_read_b64_tr_b16 v[110:111], v134 offset:1536
    v_mfma_f32_16x16x32_bf16 v[40:43], v[84:87], v[124:127], v[40:43]
    ds_read_b64_tr_b16 v[112:113], v134 offset:2048
    ds_read_b64_tr_b16 v[114:115], v134 offset:2560
    v_mfma_f32_16x16x32_bf16 v[24:27], v[120:123], v[88:91], v[24:27]
    ds_read_b128 v[64:67], v132 offset:0
    ds_read_b128 v[68:71], v132 offset:1024
    v_mfma_f32_16x16x32_bf16 v[44:47], v[88:91], v[124:127], v[44:47]
    ds_read_b64_tr_b16 v[104:105], v134 offset:0
    ds_read_b64_tr_b16 v[106:107], v134 offset:512
    v_mfma_f32_16x16x32_bf16 v[4:7], v[116:119], v[88:91], v[4:7]
    ds_read_b128 v[72:75], v132 offset:2048
    ds_read_b128 v[76:79], v132 offset:3072
    v_mfma_f32_16x16x32_bf16 v[28:31], v[120:123], v[92:95], v[28:31]
    ds_read_b128 v[80:83], v132 offset:4096
    v_mfma_f32_16x16x32_bf16 v[48:51], v[92:95], v[124:127], v[48:51]
    v_mfma_f32_16x16x32_bf16 v[8:11], v[116:119], v[92:95], v[8:11]
    v_mfma_f32_16x16x32_bf16 v[32:35], v[120:123], v[96:99], v[32:35]
    v_mfma_f32_16x16x32_bf16 v[52:55], v[96:99], v[124:127], v[52:55]
    v_mfma_f32_16x16x32_bf16 v[12:15], v[116:119], v[96:99], v[12:15]
    v_mfma_f32_16x16x32_bf16 v[36:39], v[120:123], v[100:103], v[36:39]
    v_mfma_f32_16x16x32_bf16 v[56:59], v[100:103], v[124:127], v[56:59]
    v_mfma_f32_16x16x32_bf16 v[16:19], v[116:119], v[100:103], v[16:19]
    s_waitcnt lgkmcnt(0)
    s_barrier
    v_mfma_f32_16x16x32_bf16 v[20:23], v[108:111], v[64:67], v[20:23]
    ds_read_b64_tr_b16 v[120:121], v134 offset:13312
    ds_read_b64_tr_b16 v[122:123], v134 offset:13824
    v_mfma_f32_16x16x32_bf16 v[40:43], v[64:67], v[112:115], v[40:43]
    ds_read_b64_tr_b16 v[124:125], v134 offset:14336
    ds_read_b64_tr_b16 v[126:127], v134 offset:14848
    v_mfma_f32_16x16x32_bf16 v[24:27], v[108:111], v[68:71], v[24:27]
    ds_read_b128 v[84:87], v133 offset:5120
    ds_read_b128 v[88:91], v133 offset:6144
    v_mfma_f32_16x16x32_bf16 v[44:47], v[68:71], v[112:115], v[44:47]
    ds_read_b64_tr_b16 v[116:117], v134 offset:12288
    ds_read_b64_tr_b16 v[118:119], v134 offset:12800
    v_mfma_f32_16x16x32_bf16 v[4:7], v[104:107], v[68:71], v[4:7]
    ds_read_b128 v[92:95], v133 offset:7168
    ds_read_b128 v[96:99], v133 offset:8192
    v_mfma_f32_16x16x32_bf16 v[28:31], v[108:111], v[72:75], v[28:31]
    ds_read_b128 v[100:103], v133 offset:9216
    v_mfma_f32_16x16x32_bf16 v[48:51], v[72:75], v[112:115], v[48:51]
    v_mfma_f32_16x16x32_bf16 v[8:11], v[104:107], v[72:75], v[8:11]
    v_mfma_f32_16x16x32_bf16 v[32:35], v[108:111], v[76:79], v[32:35]
    v_mfma_f32_16x16x32_bf16 v[52:55], v[76:79], v[112:115], v[52:55]
    v_mfma_f32_16x16x32_bf16 v[12:15], v[104:107], v[76:79], v[12:15]
    v_mfma_f32_16x16x32_bf16 v[36:39], v[108:111], v[80:83], v[36:39]
    v_mfma_f32_16x16x32_bf16 v[56:59], v[80:83], v[112:115], v[56:59]
    v_mfma_f32_16x16x32_bf16 v[16:19], v[104:107], v[80:83], v[16:19]
    s_waitcnt lgkmcnt(0)
    v_mfma_f32_16x16x32_bf16 v[20:23], v[120:123], v[84:87], v[20:23]
    ds_read_b64_tr_b16 v[108:109], v134 offset:25600
    ds_read_b64_tr_b16 v[110:111], v134 offset:26112
    v_mfma_f32_16x16x32_bf16 v[40:43], v[84:87], v[124:127], v[40:43]
    ds_read_b64_tr_b16 v[112:113], v134 offset:26624
    ds_read_b64_tr_b16 v[114:115], v134 offset:27136
    v_mfma_f32_16x16x32_bf16 v[24:27], v[120:123], v[88:91], v[24:27]
    ds_read_b128 v[64:67], v132 offset:10240
    ds_read_b128 v[68:71], v132 offset:11264
    v_mfma_f32_16x16x32_bf16 v[44:47], v[88:91], v[124:127], v[44:47]
    ds_read_b64_tr_b16 v[104:105], v134 offset:24576
    ds_read_b64_tr_b16 v[106:107], v134 offset:25088
    v_mfma_f32_16x16x32_bf16 v[4:7], v[116:119], v[88:91], v[4:7]
    ds_read_b128 v[72:75], v132 offset:12288
    ds_read_b128 v[76:79], v132 offset:13312
    v_mfma_f32_16x16x32_bf16 v[28:31], v[120:123], v[92:95], v[28:31]
    ds_read_b128 v[80:83], v132 offset:14336
    v_mfma_f32_16x16x32_bf16 v[48:51], v[92:95], v[124:127], v[48:51]
    v_mfma_f32_16x16x32_bf16 v[8:11], v[116:119], v[92:95], v[8:11]
    v_mfma_f32_16x16x32_bf16 v[32:35], v[120:123], v[96:99], v[32:35]
    v_mfma_f32_16x16x32_bf16 v[52:55], v[96:99], v[124:127], v[52:55]
    v_mfma_f32_16x16x32_bf16 v[12:15], v[116:119], v[96:99], v[12:15]
    v_mfma_f32_16x16x32_bf16 v[36:39], v[120:123], v[100:103], v[36:39]
    v_mfma_f32_16x16x32_bf16 v[56:59], v[100:103], v[124:127], v[56:59]
    v_mfma_f32_16x16x32_bf16 v[16:19], v[116:119], v[100:103], v[16:19]
    s_waitcnt lgkmcnt(0)
    s_barrier
    v_mfma_f32_16x16x32_bf16 v[20:23], v[108:111], v[64:67], v[20:23]
    ds_read_b64_tr_b16 v[120:121], v134 offset:37888
    ds_read_b64_tr_b16 v[122:123], v134 offset:38400
    v_mfma_f32_16x16x32_bf16 v[40:43], v[64:67], v[112:115], v[40:43]
    ds_read_b64_tr_b16 v[124:125], v134 offset:38912
    ds_read_b64_tr_b16 v[126:127], v134 offset:39424
    v_mfma_f32_16x16x32_bf16 v[24:27], v[108:111], v[68:71], v[24:27]
    ds_read_b128 v[84:87], v133 offset:15360
    ds_read_b128 v[88:91], v133 offset:16384
    v_mfma_f32_16x16x32_bf16 v[44:47], v[68:71], v[112:115], v[44:47]
    ds_read_b64_tr_b16 v[116:117], v134 offset:36864
    ds_read_b64_tr_b16 v[118:119], v134 offset:37376
    v_mfma_f32_16x16x32_bf16 v[4:7], v[104:107], v[68:71], v[4:7]
    ds_read_b128 v[92:95], v133 offset:17408
    ds_read_b128 v[96:99], v133 offset:18432
    v_mfma_f32_16x16x32_bf16 v[28:31], v[108:111], v[72:75], v[28:31]
    ds_read_b128 v[100:103], v133 offset:19456
    v_mfma_f32_16x16x32_bf16 v[48:51], v[72:75], v[112:115], v[48:51]
    v_mfma_f32_16x16x32_bf16 v[8:11], v[104:107], v[72:75], v[8:11]
    v_mfma_f32_16x16x32_bf16 v[32:35], v[108:111], v[76:79], v[32:35]
    v_mfma_f32_16x16x32_bf16 v[52:55], v[76:79], v[112:115], v[52:55]
    v_mfma_f32_16x16x32_bf16 v[12:15], v[104:107], v[76:79], v[12:15]
    v_mfma_f32_16x16x32_bf16 v[36:39], v[108:111], v[80:83], v[36:39]
    v_mfma_f32_16x16x32_bf16 v[56:59], v[80:83], v[112:115], v[56:59]
    v_mfma_f32_16x16x32_bf16 v[16:19], v[104:107], v[80:83], v[16:19]
    s_waitcnt lgkmcnt(0)
    s_barrier
    v_mfma_f32_16x16x32_bf16 v[20:23], v[120:123], v[84:87], v[20:23]
    v_mov_b32 v158, 163328
    ds_read_b32 v159, v158
    v_mfma_f32_16x16x32_bf16 v[40:43], v[84:87], v[124:127], v[40:43]
    v_mfma_f32_16x16x32_bf16 v[24:27], v[120:123], v[88:91], v[24:27]
    v_mfma_f32_16x16x32_bf16 v[44:47], v[88:91], v[124:127], v[44:47]
    v_mfma_f32_16x16x32_bf16 v[4:7], v[116:119], v[88:91], v[4:7]
    v_mfma_f32_16x16x32_bf16 v[28:31], v[120:123], v[92:95], v[28:31]
    v_mfma_f32_16x16x32_bf16 v[48:51], v[92:95], v[124:127], v[48:51]
    v_mfma_f32_16x16x32_bf16 v[8:11], v[116:119], v[92:95], v[8:11]
    v_mfma_f32_16x16x32_bf16 v[32:35], v[120:123], v[96:99], v[32:35]
    v_mfma_f32_16x16x32_bf16 v[52:55], v[96:99], v[124:127], v[52:55]
    v_mfma_f32_16x16x32_bf16 v[12:15], v[116:119], v[96:99], v[12:15]
    v_mfma_f32_16x16x32_bf16 v[36:39], v[120:123], v[100:103], v[36:39]
    v_mfma_f32_16x16x32_bf16 v[56:59], v[100:103], v[124:127], v[56:59]
    v_mfma_f32_16x16x32_bf16 v[16:19], v[116:119], v[100:103], v[16:19]
    s_waitcnt lgkmcnt(0)
    v_readfirstlane_b32 s51, v159
    s_nop 3
    s_cmp_eq_u32 s51, 0
    s_cbranch_scc1 L_c_global
    v_cvt_pk_bf16_f32 v72, v20, v21
    v_cvt_pk_bf16_f32 v73, v22, v23
    v_cvt_pk_bf16_f32 v84, v40, v41
    v_cvt_pk_bf16_f32 v85, v42, v43
    v_cvt_pk_bf16_f32 v74, v24, v25
    v_cvt_pk_bf16_f32 v75, v26, v27
    v_cvt_pk_bf16_f32 v86, v44, v45
    v_cvt_pk_bf16_f32 v87, v46, v47
    v_cvt_pk_bf16_f32 v64, v4, v5
    v_cvt_pk_bf16_f32 v65, v6, v7
    v_cvt_pk_bf16_f32 v76, v28, v29
    v_cvt_pk_bf16_f32 v77, v30, v31
    v_cvt_pk_bf16_f32 v88, v48, v49
    v_cvt_pk_bf16_f32 v89, v50, v51
    v_cvt_pk_bf16_f32 v66, v8, v9
    v_cvt_pk_bf16_f32 v67, v10, v11
    v_cvt_pk_bf16_f32 v78, v32, v33
    v_cvt_pk_bf16_f32 v79, v34, v35
    v_cvt_pk_bf16_f32 v90, v52, v53
    v_cvt_pk_bf16_f32 v91, v54, v55
    v_cvt_pk_bf16_f32 v68, v12, v13
    v_cvt_pk_bf16_f32 v69, v14, v15
    v_cvt_pk_bf16_f32 v80, v36, v37
    v_cvt_pk_bf16_f32 v81, v38, v39
    v_cvt_pk_bf16_f32 v92, v56, v57
    v_cvt_pk_bf16_f32 v93, v58, v59
    v_cvt_pk_bf16_f32 v70, v16, v17
    v_cvt_pk_bf16_f32 v71, v18, v19
    s_nop 1
    v_mfma_f32_16x16x16_bf16 v[4:7], v[74:75], v[64:65], 0
    v_mfma_f32_16x16x16_bf16 v[20:23], v[72:73], v[64:65], 0
    v_mfma_f32_16x16x16_bf16 v[8:11], v[76:77], v[66:67], 0
    v_mfma_f32_16x16x16_bf16 v[24:27], v[74:75], v[66:67], 0
    v_mfma_f32_16x16x16_bf16 v[12:15], v[78:79], v[68:69], 0
    v_mfma_f32_16x16x16_bf16 v[28:31], v[76:77], v[68:69], 0
    v_mfma_f32_16x16x16_bf16 v[16:19], v[80:81], v[70:71], 0
    v_mfma_f32_16x16x16_bf16 v[32:35], v[78:79], v[70:71], 0
    s_nop 4
    v_cndmask_b32 v36, v4, v5, s[80:81]
    v_cndmask_b32 v48, v20, v21, s[80:81]
    v_cndmask_b32 v40, v6, v7, s[80:81]
    v_cndmask_b32 v52, v22, v23, s[80:81]
    v_cndmask_b32 v37, v8, v9, s[80:81]
    v_cndmask_b32 v49, v24, v25, s[80:81]
    v_cndmask_b32 v41, v10, v11, s[80:81]
    v_cndmask_b32 v53, v26, v27, s[80:81]
    v_cndmask_b32 v38, v12, v13, s[80:81]
    v_cndmask_b32 v50, v28, v29, s[80:81]
    v_cndmask_b32 v42, v14, v15, s[80:81]
    v_cndmask_b32 v54, v30, v31, s[80:81]
    v_cndmask_b32 v39, v16, v17, s[80:81]
    v_cndmask_b32 v51, v32, v33, s[80:81]
    v_cndmask_b32 v43, v18, v19, s[80:81]
    v_cndmask_b32 v55, v34, v35, s[80:81]
    v_cndmask_b32 v36, v48, v36, s[82:83]
    v_cndmask_b32 v40, v52, v40, s[84:85]
    v_cndmask_b32 v37, v49, v37, s[82:83]
    v_cndmask_b32 v41, v53, v41, s[84:85]
    v_cndmask_b32 v38, v50, v38, s[82:83]
    v_cndmask_b32 v42, v54, v42, s[84:85]
    v_cndmask_b32 v39, v51, v39, s[82:83]
    v_cndmask_b32 v43, v55, v43, s[84:85]
    v_add_f32 v36, v36, v152
    v_add_f32 v40, v40, v153
    v_max_f32 v44, v36, v40
    v_max_f32 v45, v37, v41
    v_max_f32 v46, v38, v42
    v_max_f32 v47, v39, v43
    v_mov_b32 v48, v44
    v_mov_b32 v49, v45
    v_mov_b32 v50, v46
    v_mov_b32 v51, v47
    s_nop 0
    v_permlane16_swap_b32 v44, v48
    v_permlane16_swap_b32 v45, v49
    v_permlane16_swap_b32 v46, v50
    v_permlane16_swap_b32 v47, v51
    s_nop 0
    v_max_f32 v44, v44, v48
    v_max_f32 v45, v45, v49
    v_max_f32 v46, v46, v50
    v_max_f32 v47, v47, v51
    v_mov_b32 v48, v44
    v_mov_b32 v49, v45
    v_mov_b32 v50, v46
    v_mov_b32 v51, v47
    s_nop 0
    v_permlane32_swap_b32 v44, v48
    v_permlane32_swap_b32 v45, v49
    v_permlane32_swap_b32 v46, v50
    v_permlane32_swap_b32 v47, v51
    s_nop 0
    v_max_f32 v44, v44, v48
    v_max_f32 v45, v45, v49
    v_max_f32 v46, v46, v50
    v_max_f32 v47, v47, v51
    s_mov_b32 s54, 0x3eb8aa3b
    v_mul_f32 v44, s54, v44
    v_mul_f32 v45, s54, v45
    v_mul_f32 v46, s54, v46
    v_mul_f32 v47, s54, v47
    v_fma_f32 v36, v36, s54, -v44
    v_fma_f32 v40, v40, s54, -v44
    v_fma_f32 v37, v37, s54, -v45
    v_fma_f32 v41, v41, s54, -v45
    v_fma_f32 v38, v38, s54, -v46
    v_fma_f32 v42, v42, s54, -v46
    v_fma_f32 v39, v39, s54, -v47
    v_fma_f32 v43, v43, s54, -v47
    v_exp_f32 v36, v36
    v_exp_f32 v40, v40
    v_exp_f32 v37, v37
    v_exp_f32 v41, v41
    v_exp_f32 v38, v38
    v_exp_f32 v42, v42
    v_exp_f32 v39, v39
    v_exp_f32 v43, v43
    s_nop 0
    v_add_f32 v44, v36, v40
    v_add_f32 v45, v37, v41
    v_add_f32 v46, v38, v42
    v_add_f32 v47, v39, v43
    v_mov_b32 v48, v44
    v_mov_b32 v49, v45
    v_mov_b32 v50, v46
    v_mov_b32 v51, v47
    s_nop 0
    v_permlane16_swap_b32 v44, v48
    v_permlane16_swap_b32 v45, v49
    v_permlane16_swap_b32 v46, v50
    v_permlane16_swap_b32 v47, v51
    s_nop 0
    v_add_f32 v44, v44, v48
    v_add_f32 v45, v45, v49
    v_add_f32 v46, v46, v50
    v_add_f32 v47, v47, v51
    v_mov_b32 v48, v44
    v_mov_b32 v49, v45
    v_mov_b32 v50, v46
    v_mov_b32 v51, v47
    s_nop 0
    v_permlane32_swap_b32 v44, v48
    v_permlane32_swap_b32 v45, v49
    v_permlane32_swap_b32 v46, v50
    v_permlane32_swap_b32 v47, v51
    s_nop 0
    v_add_f32 v44, v44, v48
    v_add_f32 v45, v45, v49
    v_add_f32 v46, v46, v50
    v_add_f32 v47, v47, v51
    v_rcp_f32 v44, v44
    v_rcp_f32 v45, v45
    v_rcp_f32 v46, v46
    v_rcp_f32 v47, v47
    s_nop 0
    v_mul_f32 v36, v36, v44
    v_mul_f32 v40, v40, v44
    v_mul_f32 v37, v37, v45
    v_mul_f32 v41, v41, v45
    v_mul_f32 v38, v38, v46
    v_mul_f32 v42, v42, v46
    v_mul_f32 v39, v39, v47
    v_mul_f32 v43, v43, v47
    v_cvt_pk_bf16_f32 v48, v36, v40
    v_cvt_pk_bf16_f32 v49, v37, v41
    v_cvt_pk_bf16_f32 v50, v38, v42
    v_cvt_pk_bf16_f32 v51, v39, v43
    s_nop 0
    v_perm_b32 v4, v48, v48, v146
    v_perm_b32 v5, v48, v48, v147
    v_perm_b32 v6, v48, v48, v148
    v_perm_b32 v7, v48, v48, v149
    v_perm_b32 v8, v49, v49, v146
    v_perm_b32 v9, v49, v49, v147
    v_perm_b32 v10, v49, v49, v148
    v_perm_b32 v11, v49, v49, v149
    v_perm_b32 v12, v50, v50, v146
    v_perm_b32 v13, v50, v50, v147
    v_perm_b32 v14, v50, v50, v148
    v_perm_b32 v15, v50, v50, v149
    v_perm_b32 v16, v51, v51, v146
    v_perm_b32 v17, v51, v51, v147
    v_perm_b32 v18, v51, v51, v148
    v_perm_b32 v19, v51, v51, v149
    s_nop 1
    v_mfma_f32_16x16x32_bf16 v[20:23], v[84:87], v[4:7], 0
    v_mfma_f32_16x16x32_bf16 v[24:27], v[86:89], v[8:11], 0
    v_mfma_f32_16x16x32_bf16 v[28:31], v[88:91], v[12:15], 0
    v_mfma_f32_16x16x32_bf16 v[32:35], v[90:93], v[16:19], 0
    s_nop 4
    v_cvt_pk_bf16_f32 v36, v20, v21
    v_cvt_pk_bf16_f32 v37, v22, v23
    v_cvt_pk_bf16_f32 v38, v24, v25
    v_cvt_pk_bf16_f32 v39, v26, v27
    v_cvt_pk_bf16_f32 v40, v28, v29
    v_cvt_pk_bf16_f32 v41, v30, v31
    v_cvt_pk_bf16_f32 v42, v32, v33
    v_cvt_pk_bf16_f32 v43, v34, v35
    buffer_store_dwordx2 v[36:37], v154, s[32:35], s60 offen offset:0
    buffer_store_dwordx2 v[38:39], v154, s[32:35], s60 offen offset:256
    buffer_store_dwordx2 v[40:41], v154, s[32:35], s61 offen offset:0
    buffer_store_dwordx2 v[42:43], v154, s[32:35], s61 offen offset:256
    s_barrier
    s_waitcnt vmcnt(0)
    s_lshl_b32 s53, s45, 12
    s_lshl_b32 s54, s46, 4
    s_add_u32 s53, s53, s54
    s_lshl_b32 s54, s44, 2
    s_add_u32 s53, s53, s54
    s_add_u32 s53, s53, 65536
    v_mov_b32 v252, s49
    v_mov_b32 v253, 0
    s_mov_b64 exec, 1

    buffer_store_dword v252, v253, s[32:35], s53 offen
    s_mov_b64 exec, -1
    s_barrier
    v_mov_b32 v253, v157
    s_mov_b32 s72, 0
    s_mov_b64 exec, 0xffff
L_f1_L:
    buffer_load_dword v252, v253, s[32:35], 0 offen sc1
    s_add_u32 s72, s72, 1
    s_waitcnt vmcnt(0)
    v_cmp_ne_u32 vcc, s49, v252
    s_cmp_gt_u32 s72, 0x100000
    s_cbranch_scc1 L_f1_L_out
    s_cbranch_vccnz L_f1_L
L_f1_L_out:
    s_mov_b64 exec, -1
    buffer_load_dwordx4 v[64:67], v0, s[32:35], s62 offen offset:0 sc1
    buffer_load_dwordx4 v[68:71], v0, s[32:35], s62 offen offset:1024 sc1
    buffer_load_dwordx4 v[72:75], v0, s[32:35], s62 offen offset:2048 sc1
    buffer_load_dwordx4 v[76:79], v0, s[32:35], s62 offen offset:3072 sc1
    s_barrier
    ds_read_b64_tr_b16 v[128:129], v234 offset:0
    ds_read_b64_tr_b16 v[130:131], v234 offset:1024
    ds_read_b64_tr_b16 v[132:133], v235 offset:0
    ds_read_b64_tr_b16 v[134:135], v235 offset:1024
    ds_read_b64_tr_b16 v[136:137], v234 offset:2048
    ds_read_b64_tr_b16 v[138:139], v234 offset:3072
    ds_read_b64_tr_b16 v[140:141], v235 offset:2048
    ds_read_b64_tr_b16 v[142:143], v235 offset:3072
    ds_read_b64_tr_b16 v[144:145], v234 offset:4096
    ds_read_b64_tr_b16 v[146:147], v234 offset:5120
    s_add_u32 s62, s62, 4096
    buffer_load_dwordx4 v[80:83], v0, s[32:35], s62 offen offset:0 sc1
    s_waitcnt vmcnt(4)
    s_waitcnt lgkmcnt(8)
    v_mfma_f32_32x32x16_bf16 v[4:19], v[128:131], v[64:67], 0
    ds_read_b64_tr_b16 v[148:149], v235 offset:4096
    ds_read_b64_tr_b16 v[150:151], v235 offset:5120
    s_waitcnt lgkmcnt(8)
    v_mfma_f32_32x32x16_bf16 v[20:35], v[132:135], v[64:67], 0
    ds_read_b64_tr_b16 v[128:129], v234 offset:6144
    ds_read_b64_tr_b16 v[130:131], v234 offset:7168
    buffer_load_dwordx4 v[84:87], v0, s[32:35], s62 offen offset:1024 sc1
    s_waitcnt vmcnt(4)
    s_waitcnt lgkmcnt(8)
    v_mfma_f32_32x32x16_bf16 v[4:19], v[136:139], v[68:71], v[4:19]
    ds_read_b64_tr_b16 v[132:133], v235 offset:6144
    ds_read_b64_tr_b16 v[134:135], v235 offset:7168
    s_waitcnt lgkmcnt(8)
    v_mfma_f32_32x32x16_bf16 v[20:35], v[140:143], v[68:71], v[20:35]
    ds_read_b64_tr_b16 v[136:137], v234 offset:8192
    ds_read_b64_tr_b16 v[138:139], v234 offset:9216
    buffer_load_dwordx4 v[88:91], v0, s[32:35], s62 offen offset:2048 sc1
    s_waitcnt vmcnt(4)
    s_waitcnt lgkmcnt(8)
    v_mfma_f32_32x32x16_bf16 v[4:19], v[144:147], v[72:75], v[4:19]
    ds_read_b64_tr_b16 v[140:141], v235 offset:8192
    ds_read_b64_tr_b16 v[142:143], v235 offset:9216
    s_waitcnt lgkmcnt(8)
    v_mfma_f32_32x32x16_bf16 v[20:35], v[148:151], v[72:75], v[20:35]
    ds_read_b64_tr_b16 v[144:145], v234 offset:10240
    ds_read_b64_tr_b16 v[146:147], v234 offset:11264
    buffer_load_dwordx4 v[92:95], v0, s[32:35], s62 offen offset:3072 sc1
    s_waitcnt vmcnt(4)
    s_waitcnt lgkmcnt(8)
    v_mfma_f32_32x32x16_bf16 v[4:19], v[128:131], v[76:79], v[4:19]
    ds_read_b64_tr_b16 v[148:149], v235 offset:10240
    ds_read_b64_tr_b16 v[150:151], v235 offset:11264
    s_waitcnt lgkmcnt(8)
    v_mfma_f32_32x32x16_bf16 v[20:35], v[132:135], v[76:79], v[20:35]
    ds_read_b64_tr_b16 v[128:129], v234 offset:12288
    ds_read_b64_tr_b16 v[130:131], v234 offset:13312
    s_add_u32 s62, s62, 4096
    buffer_load_dwordx4 v[96:99], v0, s[32:35], s62 offen offset:0 sc1
    s_waitcnt vmcnt(4)
    s_waitcnt lgkmcnt(8)
    v_mfma_f32_32x32x16_bf16 v[4:19], v[136:139], v[80:83], v[4:19]
    ds_read_b64_tr_b16 v[132:133], v235 offset:12288
    ds_read_b64_tr_b16 v[134:135], v235 offset:13312
    s_waitcnt lgkmcnt(8)
    v_mfma_f32_32x32x16_bf16 v[20:35], v[140:143], v[80:83], v[20:35]
    ds_read_b64_tr_b16 v[136:137], v234 offset:14336
    ds_read_b64_tr_b16 v[138:139], v234 offset:15360
    buffer_load_dwordx4 v[100:103], v0, s[32:35], s62 offen offset:1024 sc1
    s_waitcnt vmcnt(4)
    s_waitcnt lgkmcnt(8)
    v_mfma_f32_32x32x16_bf16 v[4:19], v[144:147], v[84:87], v[4:19]
    ds_read_b64_tr_b16 v[140:141], v235 offset:14336
    ds_read_b64_tr_b16 v[142:143], v235 offset:15360
    s_waitcnt lgkmcnt(8)
    v_mfma_f32_32x32x16_bf16 v[20:35], v[148:151], v[84:87], v[20:35]
    ds_read_b64_tr_b16 v[144:145], v234 offset:16384
    ds_read_b64_tr_b16 v[146:147], v234 offset:17408
    buffer_load_dwordx4 v[104:107], v0, s[32:35], s62 offen offset:2048 sc1
    s_waitcnt vmcnt(4)
    s_waitcnt lgkmcnt(8)
    v_mfma_f32_32x32x16_bf16 v[4:19], v[128:131], v[88:91], v[4:19]
    ds_read_b64_tr_b16 v[148:149], v235 offset:16384
    ds_read_b64_tr_b16 v[150:151], v235 offset:17408
    s_waitcnt lgkmcnt(8)
    v_mfma_f32_32x32x16_bf16 v[20:35], v[132:135], v[88:91], v[20:35]
    ds_read_b64_tr_b16 v[128:129], v234 offset:18432
    ds_read_b64_tr_b16 v[130:131], v234 offset:19456
    buffer_load_dwordx4 v[108:111], v0, s[32:35], s62 offen offset:3072 sc1
    s_waitcnt vmcnt(4)
    s_waitcnt lgkmcnt(8)
    v_mfma_f32_32x32x16_bf16 v[4:19], v[136:139], v[92:95], v[4:19]
    ds_read_b64_tr_b16 v[132:133], v235 offset:18432
    ds_read_b64_tr_b16 v[134:135], v235 offset:19456
    s_waitcnt lgkmcnt(8)
    v_mfma_f32_32x32x16_bf16 v[20:35], v[140:143], v[92:95], v[20:35]
    ds_read_b64_tr_b16 v[136:137], v234 offset:20480
    ds_read_b64_tr_b16 v[138:139], v234 offset:21504
    s_add_u32 s62, s62, 4096
    buffer_load_dwordx4 v[112:115], v0, s[32:35], s62 offen offset:0 sc1
    s_waitcnt vmcnt(4)
    s_waitcnt lgkmcnt(8)
    v_mfma_f32_32x32x16_bf16 v[4:19], v[144:147], v[96:99], v[4:19]
    ds_read_b64_tr_b16 v[140:141], v235 offset:20480
    ds_read_b64_tr_b16 v[142:143], v235 offset:21504
    s_waitcnt lgkmcnt(8)
    v_mfma_f32_32x32x16_bf16 v[20:35], v[148:151], v[96:99], v[20:35]
    ds_read_b64_tr_b16 v[144:145], v234 offset:22528
    ds_read_b64_tr_b16 v[146:147], v234 offset:23552
    buffer_load_dwordx4 v[116:119], v0, s[32:35], s62 offen offset:1024 sc1
    s_waitcnt vmcnt(4)
    s_waitcnt lgkmcnt(8)
    v_mfma_f32_32x32x16_bf16 v[4:19], v[128:131], v[100:103], v[4:19]
    ds_read_b64_tr_b16 v[148:149], v235 offset:22528
    ds_read_b64_tr_b16 v[150:151], v235 offset:23552
    s_waitcnt lgkmcnt(8)
    v_mfma_f32_32x32x16_bf16 v[20:35], v[132:135], v[100:103], v[20:35]
    ds_read_b64_tr_b16 v[128:129], v234 offset:24576
    ds_read_b64_tr_b16 v[130:131], v234 offset:25600
    buffer_load_dwordx4 v[120:123], v0, s[32:35], s62 offen offset:2048 sc1
    s_waitcnt vmcnt(4)
    s_waitcnt lgkmcnt(8)
    v_mfma_f32_32x32x16_bf16 v[4:19], v[136:139], v[104:107], v[4:19]
    ds_read_b64_tr_b16 v[132:133], v235 offset:24576
    ds_read_b64_tr_b16 v[134:135], v235 offset:25600
    s_waitcnt lgkmcnt(8)
    v_mfma_f32_32x32x16_bf16 v[20:35], v[140:143], v[104:107], v[20:35]
    ds_read_b64_tr_b16 v[136:137], v234 offset:26624
    ds_read_b64_tr_b16 v[138:139], v234 offset:27648
    buffer_load_dwordx4 v[124:127], v0, s[32:35], s62 offen offset:3072 sc1
    s_waitcnt vmcnt(4)
    s_waitcnt lgkmcnt(8)
    v_mfma_f32_32x32x16_bf16 v[4:19], v[144:147], v[108:111], v[4:19]
    ds_read_b64_tr_b16 v[140:141], v235 offset:26624
    ds_read_b64_tr_b16 v[142:143], v235 offset:27648
    s_waitcnt lgkmcnt(8)
    v_mfma_f32_32x32x16_bf16 v[20:35], v[148:151], v[108:111], v[20:35]
    s_barrier
    ds_read_b64_tr_b16 v[144:145], v234 offset:28672
    ds_read_b64_tr_b16 v[146:147], v234 offset:29696
    s_waitcnt vmcnt(3)
    s_waitcnt lgkmcnt(8)
    v_mfma_f32_32x32x16_bf16 v[4:19], v[128:131], v[112:115], v[4:19]
    ds_read_b64_tr_b16 v[148:149], v235 offset:28672
    ds_read_b64_tr_b16 v[150:151], v235 offset:29696
    s_waitcnt lgkmcnt(8)
    v_mfma_f32_32x32x16_bf16 v[20:35], v[132:135], v[112:115], v[20:35]
    ds_read_b64_tr_b16 v[128:129], v234 offset:30720
    ds_read_b64_tr_b16 v[130:131], v234 offset:31744
    s_waitcnt vmcnt(2)
    s_waitcnt lgkmcnt(8)
    v_mfma_f32_32x32x16_bf16 v[4:19], v[136:139], v[116:119], v[4:19]
    ds_read_b64_tr_b16 v[132:133], v235 offset:30720
    ds_read_b64_tr_b16 v[134:135], v235 offset:31744
    s_waitcnt lgkmcnt(8)
    v_mfma_f32_32x32x16_bf16 v[20:35], v[140:143], v[116:119], v[20:35]
    s_waitcnt vmcnt(1)
    s_waitcnt lgkmcnt(6)
    v_mfma_f32_32x32x16_bf16 v[4:19], v[144:147], v[120:123], v[4:19]
    s_waitcnt lgkmcnt(4)
    v_mfma_f32_32x32x16_bf16 v[20:35], v[148:151], v[120:123], v[20:35]
    s_waitcnt vmcnt(0)
    s_waitcnt lgkmcnt(2)
    v_mfma_f32_32x32x16_bf16 v[4:19], v[128:131], v[124:127], v[4:19]
    s_waitcnt lgkmcnt(0)
    v_mfma_f32_32x32x16_bf16 v[20:35], v[132:135], v[124:127], v[20:35]
    s_lshl_b32 s52, s44, 12
    s_add_u32 s52, s52, 65536
    v_add_u32 v200, s52, v0
    s_xor_b32 s53, s44, 1
    s_lshl_b32 s53, s53, 12
    s_add_u32 s53, s53, 65536
    v_add_u32 v201, s53, v0
    s_cmp_eq_u32 s57, 0
    s_nop 7

    s_cbranch_scc1 L_kr_1_a
    ds_write_b128 v200, v[4:7] offset:0
    ds_write_b128 v200, v[8:11] offset:1024
    ds_write_b128 v200, v[12:15] offset:2048
    ds_write_b128 v200, v[16:19] offset:3072
    v_mov_b32 v36, v20
    v_mov_b32 v37, v21
    v_mov_b32 v38, v22
    v_mov_b32 v39, v23
    v_mov_b32 v40, v24
    v_mov_b32 v41, v25
    v_mov_b32 v42, v26
    v_mov_b32 v43, v27
    v_mov_b32 v44, v28
    v_mov_b32 v45, v29
    v_mov_b32 v46, v30
    v_mov_b32 v47, v31
    v_mov_b32 v48, v32
    v_mov_b32 v49, v33
    v_mov_b32 v50, v34
    v_mov_b32 v51, v35
    s_branch L_kr_1_b
L_kr_1_a:
    ds_write_b128 v200, v[20:23] offset:0
    ds_write_b128 v200, v[24:27] offset:1024
    ds_write_b128 v200, v[28:31] offset:2048
    ds_write_b128 v200, v[32:35] offset:3072
    v_mov_b32 v36, v4
    v_mov_b32 v37, v5
    v_mov_b32 v38, v6
    v_mov_b32 v39, v7
    v_mov_b32 v40, v8
    v_mov_b32 v41, v9
    v_mov_b32 v42, v10
    v_mov_b32 v43, v11
    v_mov_b32 v44, v12
    v_mov_b32 v45, v13
    v_mov_b32 v46, v14
    v_mov_b32 v47, v15
    v_mov_b32 v48, v16
    v_mov_b32 v49, v17
    v_mov_b32 v50, v18
    v_mov_b32 v51, v19
L_kr_1_b:
    v_lshrrev_b32 v200, 5, v1
    v_lshlrev_b32 v200, 4, v200
    s_lshl_b32 s53, s57, 7
    s_add_u32 s53, s53, 162304
    v_add_u32 v238, s53, v200

    ds_read_b128 v[64:67], v238 offset:0
    ds_read_b128 v[68:71], v238 offset:32
    ds_read_b128 v[72:75], v238 offset:64
    ds_read_b128 v[76:79], v238 offset:96
    ds_read_b128 v[80:83], v238 offset:256
    ds_read_b128 v[84:87], v238 offset:288
    ds_read_b128 v[88:91], v238 offset:320
    ds_read_b128 v[92:95], v238 offset:352
    ds_read_b128 v[96:99], v238 offset:512
    ds_read_b128 v[100:103], v238 offset:544
    ds_read_b128 v[104:107], v238 offset:576
    ds_read_b128 v[108:111], v238 offset:608
    s_mov_b32 s56, 0xffff0000
    v_lshlrev_b32 v112, 16, v240
    v_and_b32 v113, s56, v240
    v_lshlrev_b32 v114, 16, v241
    v_and_b32 v115, s56, v241
    v_lshlrev_b32 v116, 16, v242
    v_and_b32 v117, s56, v242
    v_lshlrev_b32 v118, 16, v243
    v_and_b32 v119, s56, v243
    v_lshlrev_b32 v120, 16, v244
    v_and_b32 v121, s56, v244
    v_lshlrev_b32 v122, 16, v245
    v_and_b32 v123, s56, v245
    v_lshlrev_b32 v124, 16, v246
    v_and_b32 v125, s56, v246
    v_lshlrev_b32 v126, 16, v247
    v_and_b32 v127, s56, v247
    s_waitcnt lgkmcnt(0)
    s_barrier
    ds_read_b128 v[208:211], v201 offset:0
    ds_read_b128 v[212:215], v201 offset:1024
    ds_read_b128 v[216:219], v201 offset:2048
    ds_read_b128 v[220:223], v201 offset:3072
    s_waitcnt lgkmcnt(3)
    v_pk_add_f32 v[36:37], v[36:37], v[208:209]
    v_pk_add_f32 v[38:39], v[38:39], v[210:211]
    s_waitcnt lgkmcnt(2)
    v_pk_add_f32 v[40:41], v[40:41], v[212:213]
    v_pk_add_f32 v[42:43], v[42:43], v[214:215]
    s_waitcnt lgkmcnt(1)
    v_pk_add_f32 v[44:45], v[44:45], v[216:217]
    v_pk_add_f32 v[46:47], v[46:47], v[218:219]
    s_waitcnt lgkmcnt(0)
    v_pk_add_f32 v[48:49], v[48:49], v[220:221]
    v_pk_add_f32 v[50:51], v[50:51], v[222:223]
    v_pk_fma_f32 v[36:37], v[36:37], v[64:65], v[112:113]
    v_pk_fma_f32 v[38:39], v[38:39], v[66:67], v[114:115]
    v_pk_fma_f32 v[40:41], v[40:41], v[68:69], v[116:117]
    v_pk_fma_f32 v[42:43], v[42:43], v[70:71], v[118:119]
    v_pk_fma_f32 v[44:45], v[44:45], v[72:73], v[120:121]
    v_pk_fma_f32 v[46:47], v[46:47], v[74:75], v[122:123]
    v_pk_fma_f32 v[48:49], v[48:49], v[76:77], v[124:125]
    v_pk_fma_f32 v[50:51], v[50:51], v[78:79], v[126:127]
    v_pk_mul_f32 v[4:5], v[36:37], v[36:37]
    v_pk_add_f32 v[6:7], v[36:37], v[38:39]
    v_pk_fma_f32 v[4:5], v[38:39], v[38:39], v[4:5]
    v_pk_fma_f32 v[4:5], v[40:41], v[40:41], v[4:5]
    v_pk_fma_f32 v[4:5], v[42:43], v[42:43], v[4:5]
    v_pk_fma_f32 v[4:5], v[44:45], v[44:45], v[4:5]
    v_pk_fma_f32 v[4:5], v[46:47], v[46:47], v[4:5]
    v_pk_fma_f32 v[4:5], v[48:49], v[48:49], v[4:5]
    v_pk_fma_f32 v[4:5], v[50:51], v[50:51], v[4:5]
    v_pk_add_f32 v[6:7], v[6:7], v[40:41]
    v_pk_add_f32 v[6:7], v[6:7], v[42:43]
    v_pk_add_f32 v[6:7], v[6:7], v[44:45]
    v_pk_add_f32 v[6:7], v[6:7], v[46:47]
    v_pk_add_f32 v[6:7], v[6:7], v[48:49]
    v_pk_add_f32 v[6:7], v[6:7], v[50:51]
    v_add_f32 v8, v6, v7
    v_add_f32 v9, v4, v5
    v_mov_b32 v10, v8
    v_mov_b32 v11, v9
    s_nop 1
    v_permlane32_swap_b32 v8, v10
    v_permlane32_swap_b32 v9, v11
    s_nop 0
    v_add_f32 v8, v8, v10
    v_add_f32 v9, v9, v11

    s_lshl_b32 s52, s45, 2
    s_add_u32 s52, s52, s47
    s_lshl_b32 s52, s52, 14
    s_add_u32 s60, s52, 3145728
    s_lshl_b32 s53, s58, 9
    s_add_u32 s60, s60, s53
    s_lshl_b32 s52, s48, 1
    s_add_u32 s52, s52, s57
    s_lshl_b32 s52, s52, 10
    s_add_u32 s61, s60, s52
    v_and_b32 v12, 31, v1
    v_lshlrev_b32 v12, 4, v12
    v_mov_b32 v10, s49
    v_mov_b32 v11, s49
    s_mov_b32 exec_hi, 0

    buffer_store_dwordx4 v[8:11], v12, s[32:35], s61 offen
    s_mov_b64 exec, -1
    s_barrier
    v_cvt_pk_bf16_f32 v244, v36, v37
    v_cvt_pk_bf16_f32 v245, v38, v39
    v_cvt_pk_bf16_f32 v246, v40, v41
    v_cvt_pk_bf16_f32 v247, v42, v43
    v_cvt_pk_bf16_f32 v248, v44, v45
    v_cvt_pk_bf16_f32 v249, v46, v47
    v_cvt_pk_bf16_f32 v250, v48, v49
    v_cvt_pk_bf16_f32 v251, v50, v51
    v_lshrrev_b32 v13, 5, v1
    v_lshl_add_u32 v12, v13, 13, v12
    s_add_u32 s61, s60, 4096
    s_mov_b32 s72, 0

L_f2a_L:
    buffer_load_dwordx4 v[160:163], v12, s[32:35], s60 offen offset:0 sc1
    buffer_load_dwordx4 v[164:167], v12, s[32:35], s60 offen offset:1024 sc1
    buffer_load_dwordx4 v[168:171], v12, s[32:35], s60 offen offset:2048 sc1
    buffer_load_dwordx4 v[172:175], v12, s[32:35], s60 offen offset:3072 sc1
    buffer_load_dwordx4 v[176:179], v12, s[32:35], s61 offen offset:0 sc1
    buffer_load_dwordx4 v[180:183], v12, s[32:35], s61 offen offset:1024 sc1
    buffer_load_dwordx4 v[184:187], v12, s[32:35], s61 offen offset:2048 sc1
    buffer_load_dwordx4 v[188:191], v12, s[32:35], s61 offen offset:3072 sc1
    s_add_u32 s72, s72, 1
    s_waitcnt vmcnt(0)
    v_xor_b32 v14, s49, v162
    v_xor_b32 v15, s49, v166
    v_xor_b32 v16, s49, v170
    v_xor_b32 v17, s49, v174
    v_xor_b32 v18, s49, v178
    v_xor_b32 v19, s49, v182
    v_xor_b32 v20, s49, v186
    v_xor_b32 v21, s49, v190
    v_or3_b32 v14, v14, v15, v16
    v_or3_b32 v17, v17, v18, v19
    v_or3_b32 v14, v14, v20, v21
    v_or_b32 v14, v14, v17
    v_cmp_ne_u32 vcc, 0, v14
    s_cmp_gt_u32 s72, 0x100000
    s_cbranch_scc1 L_f2a_L_out
    s_cbranch_vccnz L_f2a_L

L_f2a_L_out:
    s_barrier
    s_waitcnt lgkmcnt(0)
    v_pk_add_f32 v[160:161], v[160:161], v[164:165]
    v_pk_add_f32 v[160:161], v[160:161], v[168:169]
    v_pk_add_f32 v[160:161], v[160:161], v[172:173]
    v_pk_add_f32 v[160:161], v[160:161], v[176:177]
    v_pk_add_f32 v[160:161], v[160:161], v[180:181]
    v_pk_add_f32 v[160:161], v[160:161], v[184:185]
    v_pk_add_f32 v[160:161], v[160:161], v[188:189]
    v_mov_b32 v14, v160
    v_mov_b32 v15, v161
    v_mov_b32 v16, v14
    v_mov_b32 v17, v15
    s_nop 1
    v_permlane32_swap_b32 v14, v16
    v_permlane32_swap_b32 v15, v17
    s_nop 0
    v_add_f32 v14, v14, v16
    v_add_f32 v15, v15, v17
    s_mov_b32 s54, 0x3b000000
    s_mov_b32 s55, 0x3727c5ac
    v_mul_f32 v14, s54, v14
    v_mul_f32 v15, s54, v15
    v_fma_f32 v15, -v14, v14, v15
    v_max_f32 v15, 0, v15
    v_add_f32 v15, s55, v15
    v_rsq_f32 v16, v15
    s_nop 0
    v_mul_f32 v14, v14, v16
    v_sub_f32 v17, 0, v14

    v_pk_fma_f32 v[36:37], v[36:37], v[16:17], v[16:17] op_sel:[0,0,1] op_sel_hi:[1,0,1]
    v_pk_fma_f32 v[38:39], v[38:39], v[16:17], v[16:17] op_sel:[0,0,1] op_sel_hi:[1,0,1]
    v_pk_fma_f32 v[40:41], v[40:41], v[16:17], v[16:17] op_sel:[0,0,1] op_sel_hi:[1,0,1]
    v_pk_fma_f32 v[42:43], v[42:43], v[16:17], v[16:17] op_sel:[0,0,1] op_sel_hi:[1,0,1]
    v_pk_fma_f32 v[44:45], v[44:45], v[16:17], v[16:17] op_sel:[0,0,1] op_sel_hi:[1,0,1]
    v_pk_fma_f32 v[46:47], v[46:47], v[16:17], v[16:17] op_sel:[0,0,1] op_sel_hi:[1,0,1]
    v_pk_fma_f32 v[48:49], v[48:49], v[16:17], v[16:17] op_sel:[0,0,1] op_sel_hi:[1,0,1]
    v_pk_fma_f32 v[50:51], v[50:51], v[16:17], v[16:17] op_sel:[0,0,1] op_sel_hi:[1,0,1]
    v_pk_fma_f32 v[36:37], v[36:37], v[80:81], v[96:97]
    v_pk_fma_f32 v[38:39], v[38:39], v[82:83], v[98:99]
    v_pk_fma_f32 v[40:41], v[40:41], v[84:85], v[100:101]
    v_pk_fma_f32 v[42:43], v[42:43], v[86:87], v[102:103]
    v_pk_fma_f32 v[44:45], v[44:45], v[88:89], v[104:105]
    v_pk_fma_f32 v[46:47], v[46:47], v[90:91], v[106:107]
    v_pk_fma_f32 v[48:49], v[48:49], v[92:93], v[108:109]
    v_pk_fma_f32 v[50:51], v[50:51], v[94:95], v[110:111]
    v_cvt_pk_bf16_f32 v20, v36, v37
    v_cvt_pk_bf16_f32 v21, v38, v39
    v_cvt_pk_bf16_f32 v22, v40, v41
    v_cvt_pk_bf16_f32 v23, v42, v43
    v_cvt_pk_bf16_f32 v24, v44, v45
    v_cvt_pk_bf16_f32 v25, v46, v47
    v_cvt_pk_bf16_f32 v26, v48, v49
    v_cvt_pk_bf16_f32 v27, v50, v51
    s_lshl_b32 s52, s59, 5
    s_lshl_b32 s53, s48, 2
    s_add_u32 s52, s52, s53
    s_lshl_b32 s53, s57, 1
    s_add_u32 s52, s52, s53
    s_lshl_b32 s52, s52, 10
    s_add_u32 s52, s52, 4194304

    buffer_store_dwordx4 v[20:23], v0, s[32:35], s52 offen
    buffer_store_dwordx4 v[24:27], v0, s[32:35], s52 offen offset:1024
    s_barrier
    s_lshl_b32 s53, s57, 11
    v_add_u32 v115, s53, v232
    v_add_u32 v254, s53, v233
    s_lshr_b32 s52, s47, 1
    s_mul_i32 s52, s52, 14
    s_lshl_b32 s52, s52, 4
    s_and_b32 s53, s47, 1
    s_lshl_b32 s53, s53, 1
    s_add_u32 s53, s53, s58
    s_lshl_b32 s53, s53, 2
    s_add_u32 s52, s52, s53
    s_lshl_b32 s53, s45, 12
    s_add_u32 s52, s52, s53
    s_add_u32 s74, s52, 67072
    v_mul_u32_u24 v98, 0x4925, v1
    v_lshrrev_b32 v98, 18, v98
    v_mul_u32_u24 v99, 14, v98
    v_sub_u32 v99, v1, v99
    v_lshlrev_b32 v99, 4, v99
    v_lshl_add_u32 v99, v98, 9, v99
    v_add_u32 v253, s74, v99
    s_lshl_b32 s52, s45, 12
    s_lshl_b32 s53, s46, 4
    s_add_u32 s52, s52, s53
    s_lshl_b32 s53, s44, 2
    s_add_u32 s52, s52, s53
    s_add_u32 s73, s52, 67072

    s_lshl_b32 s52, s45, 3
    s_lshl_b32 s53, s47, 1
    s_add_u32 s52, s52, s53
    s_add_u32 s52, s52, s58
    s_mul_i32 s52, s52, 112
    s_add_u32 s52, s52, s57
    s_lshl_b32 s52, s52, 10
    s_add_u32 s75, s52, 6291456

    v_mov_b32 v113, v253
    s_waitcnt vmcnt(0)
    s_lshl_b32 s53, s45, 12
    s_lshl_b32 s54, s46, 4
    s_add_u32 s53, s53, s54
    s_lshl_b32 s54, s44, 2
    s_add_u32 s53, s53, s54
    s_add_u32 s53, s53, 66560
    v_mov_b32 v252, s49
    v_mov_b32 v253, 0
    s_mov_b64 exec, 1

    buffer_store_dword v252, v253, s[32:35], s53 offen
    s_mov_b64 exec, -1
    v_mov_b32 v253, v113
    s_cmp_ge_u32 s46, 28
    s_cbranch_scc1 L_c_idle_L
    s_cmp_ge_u32 s46, 14
    s_cselect_b32 s66, 1, 0
    s_mul_i32 s53, s66, 14
    s_sub_u32 s67, s46, s53
    s_lshl_b32 s52, s66, 1
    s_lshr_b32 s53, s44, 1
    s_add_u32 s52, s52, s53
    s_lshl_b32 s52, s52, 7
    s_lshl_b32 s53, s45, 12
    s_add_u32 s52, s52, s53
    s_add_u32 s52, s52, 66560
    v_lshlrev_b32 v111, 2, v1
    v_add_u32 v111, s52, v111

    s_lshl_b32 s52, s45, 3
    s_lshl_b32 s53, s66, 2
    s_add_u32 s52, s52, s53
    s_add_u32 s68, s52, s44
    s_lshl_b32 s52, s68, 15
    s_add_u32 s62, s52, 4194304

    s_mul_i32 s69, s68, 112
    s_lshl_b32 s53, s67, 3
    s_add_u32 s69, s69, s53
    s_lshl_b32 s69, s69, 10
    s_add_u32 s69, s69, 6291456
    s_mov_b32 s77, 0x3fb8aa3b

    s_mov_b32 s78, s69
    v_lshrrev_b32 v98, 4, v1
    v_and_b32 v99, 1, v98
    v_lshrrev_b32 v98, 1, v98
    v_and_b32 v100, 15, v1
    v_lshrrev_b32 v101, 2, v100
    v_and_b32 v102, 3, v100
    v_lshl_add_u32 v103, v98, 2, v101
    v_lshlrev_b32 v103, 7, v103
    v_lshl_add_u32 v103, v99, 11, v103
    v_and_b32 v104, 1, v102
    v_lshl_add_u32 v103, v104, 3, v103
    v_lshrrev_b32 v104, 1, v102
    v_lshl_add_u32 v103, v104, 4, v103
    v_lshrrev_b32 v105, 1, v101
    v_lshlrev_b32 v105, 1, v105
    v_lshl_add_u32 v105, v99, 2, v105

    v_xor_b32 v106, 0, v105
    v_lshl_add_u32 v2, v106, 4, v103
    v_xor_b32 v106, 2, v105
    v_lshl_add_u32 v3, v106, 4, v103
    v_xor_b32 v106, 4, v105
    v_lshl_add_u32 v4, v106, 4, v103
    v_xor_b32 v106, 6, v105
    v_lshl_add_u32 v5, v106, 4, v103
    v_mov_b32 v114, s49
    v_add_u32 v6, 0x10000, v2
    v_add_u32 v7, 0x10000, v3
    v_add_u32 v8, 0x20000, v2
    v_add_u32 v9, 0x20000, v3
    s_mov_b32 s72, 0
    s_mov_b32 exec_lo, -1
    s_mov_b32 exec_hi, 0x0
L_f2b_L:
    buffer_load_dword v110, v111, s[32:35], 0 offen sc1
    s_add_u32 s72, s72, 1
    s_waitcnt vmcnt(0)
    v_cmp_ne_u32 vcc, s49, v110
    s_cmp_gt_u32 s72, 0x100000
    s_cbranch_scc1 L_f2b_L_out
    s_cbranch_vccnz L_f2b_L
L_f2b_L_out:
    s_mov_b64 exec, -1
    buffer_load_dwordx4 v[116:119], v0, s[32:35], s62 offen offset:0 sc1
    buffer_load_dwordx4 v[120:123], v0, s[32:35], s62 offen offset:1024 sc1
    buffer_load_dwordx4 v[124:127], v0, s[32:35], s62 offen offset:2048 sc1
    buffer_load_dwordx4 v[128:131], v0, s[32:35], s62 offen offset:3072 sc1
    s_add_u32 s62, s62, 4096
    buffer_load_dwordx4 v[132:135], v0, s[32:35], s62 offen offset:0 sc1
    buffer_load_dwordx4 v[136:139], v0, s[32:35], s62 offen offset:1024 sc1
    buffer_load_dwordx4 v[140:143], v0, s[32:35], s62 offen offset:2048 sc1
    buffer_load_dwordx4 v[144:147], v0, s[32:35], s62 offen offset:3072 sc1
    s_barrier
    ds_read_b64_tr_b16 v[74:75], v6 offset:16384
    ds_read_b64_tr_b16 v[76:77], v6 offset:17408
    ds_read_b64_tr_b16 v[78:79], v7 offset:16384
    ds_read_b64_tr_b16 v[80:81], v7 offset:17408
    ds_read_b64_tr_b16 v[82:83], v6 offset:20480
    ds_read_b64_tr_b16 v[84:85], v6 offset:21504
    ds_read_b64_tr_b16 v[86:87], v7 offset:20480
    ds_read_b64_tr_b16 v[88:89], v7 offset:21504
    ds_read_b64_tr_b16 v[90:91], v6 offset:24576
    ds_read_b64_tr_b16 v[92:93], v6 offset:25600
    s_add_u32 s62, s62, 4096
    buffer_load_dwordx4 v[148:151], v0, s[32:35], s62 offen offset:0 sc1
    s_waitcnt vmcnt(8)
    s_waitcnt lgkmcnt(6)
    v_mfma_f32_32x32x16_bf16 v[10:25], v[74:77], v[116:119], 0
    ds_read_b64_tr_b16 v[94:95], v7 offset:24576
    ds_read_b64_tr_b16 v[96:97], v7 offset:25600
    v_mfma_f32_32x32x16_bf16 v[26:41], v[78:81], v[116:119], 0
    ds_read_b64_tr_b16 v[74:75], v6 offset:28672
    ds_read_b64_tr_b16 v[76:77], v6 offset:29696
    buffer_load_dwordx4 v[152:155], v0, s[32:35], s62 offen offset:1024 sc1
    s_waitcnt vmcnt(8)
    s_waitcnt lgkmcnt(6)
    v_mfma_f32_32x32x16_bf16 v[10:25], v[82:85], v[120:123], v[10:25]
    ds_read_b64_tr_b16 v[78:79], v7 offset:28672
    ds_read_b64_tr_b16 v[80:81], v7 offset:29696
    v_mfma_f32_32x32x16_bf16 v[26:41], v[86:89], v[120:123], v[26:41]
    ds_read_b64_tr_b16 v[82:83], v6 offset:32768
    ds_read_b64_tr_b16 v[84:85], v6 offset:33792
    buffer_load_dwordx4 v[156:159], v0, s[32:35], s62 offen offset:2048 sc1
    s_waitcnt vmcnt(8)
    s_waitcnt lgkmcnt(6)
    v_mfma_f32_32x32x16_bf16 v[10:25], v[90:93], v[124:127], v[10:25]
    ds_read_b64_tr_b16 v[86:87], v7 offset:32768
    ds_read_b64_tr_b16 v[88:89], v7 offset:33792
    v_mfma_f32_32x32x16_bf16 v[26:41], v[94:97], v[124:127], v[26:41]
    ds_read_b64_tr_b16 v[90:91], v6 offset:36864
    ds_read_b64_tr_b16 v[92:93], v6 offset:37888
    buffer_load_dwordx4 v[160:163], v0, s[32:35], s62 offen offset:3072 sc1
    s_waitcnt vmcnt(8)
    s_waitcnt lgkmcnt(6)
    v_mfma_f32_32x32x16_bf16 v[10:25], v[74:77], v[128:131], v[10:25]
    ds_read_b64_tr_b16 v[94:95], v7 offset:36864
    ds_read_b64_tr_b16 v[96:97], v7 offset:37888
    v_mfma_f32_32x32x16_bf16 v[26:41], v[78:81], v[128:131], v[26:41]
    ds_read_b64_tr_b16 v[74:75], v6 offset:40960
    ds_read_b64_tr_b16 v[76:77], v6 offset:41984
    s_add_u32 s62, s62, 4096
    buffer_load_dwordx4 v[164:167], v0, s[32:35], s62 offen offset:0 sc1
    s_waitcnt vmcnt(8)
    s_waitcnt lgkmcnt(6)
    v_mfma_f32_32x32x16_bf16 v[10:25], v[82:85], v[132:135], v[10:25]
    ds_read_b64_tr_b16 v[78:79], v7 offset:40960
    ds_read_b64_tr_b16 v[80:81], v7 offset:41984
    v_mfma_f32_32x32x16_bf16 v[26:41], v[86:89], v[132:135], v[26:41]
    ds_read_b64_tr_b16 v[82:83], v6 offset:45056
    ds_read_b64_tr_b16 v[84:85], v6 offset:46080
    buffer_load_dwordx4 v[168:171], v0, s[32:35], s62 offen offset:1024 sc1
    s_waitcnt vmcnt(8)
    s_waitcnt lgkmcnt(6)
    v_mfma_f32_32x32x16_bf16 v[10:25], v[90:93], v[136:139], v[10:25]
    ds_read_b64_tr_b16 v[86:87], v7 offset:45056
    ds_read_b64_tr_b16 v[88:89], v7 offset:46080
    v_mfma_f32_32x32x16_bf16 v[26:41], v[94:97], v[136:139], v[26:41]
    ds_read_b64_tr_b16 v[90:91], v6 offset:49152
    ds_read_b64_tr_b16 v[92:93], v6 offset:50176
    buffer_load_dwordx4 v[172:175], v0, s[32:35], s62 offen offset:2048 sc1
    s_waitcnt vmcnt(8)
    s_waitcnt lgkmcnt(6)
    v_mfma_f32_32x32x16_bf16 v[10:25], v[74:77], v[140:143], v[10:25]
    ds_read_b64_tr_b16 v[94:95], v7 offset:49152
    ds_read_b64_tr_b16 v[96:97], v7 offset:50176
    v_mfma_f32_32x32x16_bf16 v[26:41], v[78:81], v[140:143], v[26:41]
    ds_read_b64_tr_b16 v[74:75], v6 offset:53248
    ds_read_b64_tr_b16 v[76:77], v6 offset:54272
    buffer_load_dwordx4 v[176:179], v0, s[32:35], s62 offen offset:3072 sc1
    s_waitcnt vmcnt(8)
    s_waitcnt lgkmcnt(6)
    v_mfma_f32_32x32x16_bf16 v[10:25], v[82:85], v[144:147], v[10:25]
    ds_read_b64_tr_b16 v[78:79], v7 offset:53248
    ds_read_b64_tr_b16 v[80:81], v7 offset:54272
    v_mfma_f32_32x32x16_bf16 v[26:41], v[86:89], v[144:147], v[26:41]
    ds_read_b64_tr_b16 v[82:83], v6 offset:57344
    ds_read_b64_tr_b16 v[84:85], v6 offset:58368
    s_add_u32 s62, s62, 4096
    buffer_load_dwordx4 v[180:183], v0, s[32:35], s62 offen offset:0 sc1
    s_waitcnt vmcnt(8)
    s_waitcnt lgkmcnt(6)
    v_mfma_f32_32x32x16_bf16 v[10:25], v[90:93], v[148:151], v[10:25]
    ds_read_b64_tr_b16 v[86:87], v7 offset:57344
    ds_read_b64_tr_b16 v[88:89], v7 offset:58368
    v_mfma_f32_32x32x16_bf16 v[26:41], v[94:97], v[148:151], v[26:41]
    ds_read_b64_tr_b16 v[90:91], v6 offset:61440
    ds_read_b64_tr_b16 v[92:93], v6 offset:62464
    buffer_load_dwordx4 v[184:187], v0, s[32:35], s62 offen offset:1024 sc1
    s_waitcnt vmcnt(8)
    s_waitcnt lgkmcnt(6)
    v_mfma_f32_32x32x16_bf16 v[10:25], v[74:77], v[152:155], v[10:25]
    ds_read_b64_tr_b16 v[94:95], v7 offset:61440
    ds_read_b64_tr_b16 v[96:97], v7 offset:62464
    v_mfma_f32_32x32x16_bf16 v[26:41], v[78:81], v[152:155], v[26:41]
    ds_read_b64_tr_b16 v[74:75], v8 offset:0
    ds_read_b64_tr_b16 v[76:77], v8 offset:1024
    buffer_load_dwordx4 v[188:191], v0, s[32:35], s62 offen offset:2048 sc1
    s_waitcnt vmcnt(8)
    s_waitcnt lgkmcnt(6)
    v_mfma_f32_32x32x16_bf16 v[10:25], v[82:85], v[156:159], v[10:25]
    ds_read_b64_tr_b16 v[78:79], v9 offset:0
    ds_read_b64_tr_b16 v[80:81], v9 offset:1024
    v_mfma_f32_32x32x16_bf16 v[26:41], v[86:89], v[156:159], v[26:41]
    ds_read_b64_tr_b16 v[82:83], v8 offset:4096
    ds_read_b64_tr_b16 v[84:85], v8 offset:5120
    buffer_load_dwordx4 v[192:195], v0, s[32:35], s62 offen offset:3072 sc1
    s_waitcnt vmcnt(8)
    s_waitcnt lgkmcnt(6)
    v_mfma_f32_32x32x16_bf16 v[10:25], v[90:93], v[160:163], v[10:25]
    ds_read_b64_tr_b16 v[86:87], v9 offset:4096
    ds_read_b64_tr_b16 v[88:89], v9 offset:5120
    v_mfma_f32_32x32x16_bf16 v[26:41], v[94:97], v[160:163], v[26:41]
    ds_read_b64_tr_b16 v[90:91], v8 offset:8192
    ds_read_b64_tr_b16 v[92:93], v8 offset:9216
    s_add_u32 s62, s62, 4096
    buffer_load_dwordx4 v[196:199], v0, s[32:35], s62 offen offset:0 sc1
    s_waitcnt vmcnt(8)
    s_waitcnt lgkmcnt(6)
    v_mfma_f32_32x32x16_bf16 v[10:25], v[74:77], v[164:167], v[10:25]
    ds_read_b64_tr_b16 v[94:95], v9 offset:8192
    ds_read_b64_tr_b16 v[96:97], v9 offset:9216
    v_mfma_f32_32x32x16_bf16 v[26:41], v[78:81], v[164:167], v[26:41]
    ds_read_b64_tr_b16 v[74:75], v8 offset:12288
    ds_read_b64_tr_b16 v[76:77], v8 offset:13312
    buffer_load_dwordx4 v[200:203], v0, s[32:35], s62 offen offset:1024 sc1
    s_waitcnt vmcnt(8)
    s_waitcnt lgkmcnt(6)
    v_mfma_f32_32x32x16_bf16 v[10:25], v[82:85], v[168:171], v[10:25]
    ds_read_b64_tr_b16 v[78:79], v9 offset:12288
    ds_read_b64_tr_b16 v[80:81], v9 offset:13312
    v_mfma_f32_32x32x16_bf16 v[26:41], v[86:89], v[168:171], v[26:41]
    ds_read_b64_tr_b16 v[82:83], v8 offset:16384
    ds_read_b64_tr_b16 v[84:85], v8 offset:17408
    buffer_load_dwordx4 v[204:207], v0, s[32:35], s62 offen offset:2048 sc1
    s_waitcnt vmcnt(8)
    s_waitcnt lgkmcnt(6)
    v_mfma_f32_32x32x16_bf16 v[10:25], v[90:93], v[172:175], v[10:25]
    ds_read_b64_tr_b16 v[86:87], v9 offset:16384
    ds_read_b64_tr_b16 v[88:89], v9 offset:17408
    v_mfma_f32_32x32x16_bf16 v[26:41], v[94:97], v[172:175], v[26:41]
    ds_read_b64_tr_b16 v[90:91], v8 offset:20480
    ds_read_b64_tr_b16 v[92:93], v8 offset:21504
    buffer_load_dwordx4 v[208:211], v0, s[32:35], s62 offen offset:3072 sc1
    s_waitcnt vmcnt(8)
    s_waitcnt lgkmcnt(6)
    v_mfma_f32_32x32x16_bf16 v[10:25], v[74:77], v[176:179], v[10:25]
    ds_read_b64_tr_b16 v[94:95], v9 offset:20480
    ds_read_b64_tr_b16 v[96:97], v9 offset:21504
    v_mfma_f32_32x32x16_bf16 v[26:41], v[78:81], v[176:179], v[26:41]
    ds_read_b64_tr_b16 v[74:75], v8 offset:24576
    ds_read_b64_tr_b16 v[76:77], v8 offset:25600
    s_add_u32 s62, s62, 4096
    buffer_load_dwordx4 v[212:215], v0, s[32:35], s62 offen offset:0 sc1
    s_waitcnt vmcnt(8)
    s_waitcnt lgkmcnt(6)
    v_mfma_f32_32x32x16_bf16 v[10:25], v[82:85], v[180:183], v[10:25]
    ds_read_b64_tr_b16 v[78:79], v9 offset:24576
    ds_read_b64_tr_b16 v[80:81], v9 offset:25600
    v_mfma_f32_32x32x16_bf16 v[26:41], v[86:89], v[180:183], v[26:41]
    ds_read_b64_tr_b16 v[82:83], v2 offset:0
    ds_read_b64_tr_b16 v[84:85], v2 offset:1024
    buffer_load_dwordx4 v[216:219], v0, s[32:35], s62 offen offset:1024 sc1
    s_waitcnt vmcnt(8)
    s_waitcnt lgkmcnt(6)
    v_mfma_f32_32x32x16_bf16 v[10:25], v[90:93], v[184:187], v[10:25]
    ds_read_b64_tr_b16 v[86:87], v3 offset:0
    ds_read_b64_tr_b16 v[88:89], v3 offset:1024
    v_mfma_f32_32x32x16_bf16 v[26:41], v[94:97], v[184:187], v[26:41]
    ds_read_b64_tr_b16 v[90:91], v2 offset:4096
    ds_read_b64_tr_b16 v[92:93], v2 offset:5120
    buffer_load_dwordx4 v[220:223], v0, s[32:35], s62 offen offset:2048 sc1
    s_waitcnt vmcnt(8)
    s_waitcnt lgkmcnt(6)
    v_mfma_f32_32x32x16_bf16 v[10:25], v[74:77], v[188:191], v[10:25]
    ds_read_b64_tr_b16 v[94:95], v3 offset:4096
    ds_read_b64_tr_b16 v[96:97], v3 offset:5120
    v_mfma_f32_32x32x16_bf16 v[26:41], v[78:81], v[188:191], v[26:41]
    ds_read_b64_tr_b16 v[74:75], v2 offset:8192
    ds_read_b64_tr_b16 v[76:77], v2 offset:9216
    buffer_load_dwordx4 v[224:227], v0, s[32:35], s62 offen offset:3072 sc1
    s_waitcnt vmcnt(8)
    s_waitcnt lgkmcnt(6)
    v_mfma_f32_32x32x16_bf16 v[10:25], v[82:85], v[192:195], v[10:25]
    ds_read_b64_tr_b16 v[78:79], v3 offset:8192
    ds_read_b64_tr_b16 v[80:81], v3 offset:9216
    v_mfma_f32_32x32x16_bf16 v[26:41], v[86:89], v[192:195], v[26:41]
    ds_read_b64_tr_b16 v[82:83], v2 offset:12288
    ds_read_b64_tr_b16 v[84:85], v2 offset:13312
    s_add_u32 s62, s62, 4096
    buffer_load_dwordx4 v[228:231], v0, s[32:35], s62 offen offset:0 sc1
    s_waitcnt vmcnt(8)
    s_waitcnt lgkmcnt(6)
    v_mfma_f32_32x32x16_bf16 v[10:25], v[90:93], v[196:199], v[10:25]
    ds_read_b64_tr_b16 v[86:87], v3 offset:12288
    ds_read_b64_tr_b16 v[88:89], v3 offset:13312
    v_mfma_f32_32x32x16_bf16 v[26:41], v[94:97], v[196:199], v[26:41]
    ds_read_b64_tr_b16 v[90:91], v2 offset:16384
    ds_read_b64_tr_b16 v[92:93], v2 offset:17408
    buffer_load_dwordx4 v[232:235], v0, s[32:35], s62 offen offset:1024 sc1
    s_waitcnt vmcnt(8)
    s_waitcnt lgkmcnt(6)
    v_mfma_f32_32x32x16_bf16 v[10:25], v[74:77], v[200:203], v[10:25]
    ds_read_b64_tr_b16 v[94:95], v3 offset:16384
    ds_read_b64_tr_b16 v[96:97], v3 offset:17408
    v_mfma_f32_32x32x16_bf16 v[26:41], v[78:81], v[200:203], v[26:41]
    ds_read_b64_tr_b16 v[74:75], v2 offset:20480
    ds_read_b64_tr_b16 v[76:77], v2 offset:21504
    buffer_load_dwordx4 v[236:239], v0, s[32:35], s62 offen offset:2048 sc1
    s_waitcnt vmcnt(8)
    s_waitcnt lgkmcnt(6)
    v_mfma_f32_32x32x16_bf16 v[10:25], v[82:85], v[204:207], v[10:25]
    ds_read_b64_tr_b16 v[78:79], v3 offset:20480
    ds_read_b64_tr_b16 v[80:81], v3 offset:21504
    v_mfma_f32_32x32x16_bf16 v[26:41], v[86:89], v[204:207], v[26:41]
    ds_read_b64_tr_b16 v[82:83], v2 offset:24576
    ds_read_b64_tr_b16 v[84:85], v2 offset:25600
    buffer_load_dwordx4 v[240:243], v0, s[32:35], s62 offen offset:3072 sc1
    s_waitcnt vmcnt(8)
    s_waitcnt lgkmcnt(6)
    v_mfma_f32_32x32x16_bf16 v[10:25], v[90:93], v[208:211], v[10:25]
    ds_read_b64_tr_b16 v[86:87], v3 offset:24576
    ds_read_b64_tr_b16 v[88:89], v3 offset:25600
    v_mfma_f32_32x32x16_bf16 v[26:41], v[94:97], v[208:211], v[26:41]
    ds_read_b64_tr_b16 v[90:91], v2 offset:28672
    ds_read_b64_tr_b16 v[92:93], v2 offset:29696
    s_waitcnt vmcnt(7)
    s_waitcnt lgkmcnt(6)
    v_mfma_f32_32x32x16_bf16 v[10:25], v[74:77], v[212:215], v[10:25]
    ds_read_b64_tr_b16 v[94:95], v3 offset:28672
    ds_read_b64_tr_b16 v[96:97], v3 offset:29696
    v_mfma_f32_32x32x16_bf16 v[26:41], v[78:81], v[212:215], v[26:41]
    ds_read_b64_tr_b16 v[74:75], v2 offset:32768
    ds_read_b64_tr_b16 v[76:77], v2 offset:33792
    s_waitcnt vmcnt(6)
    s_waitcnt lgkmcnt(6)
    v_mfma_f32_32x32x16_bf16 v[10:25], v[82:85], v[216:219], v[10:25]
    ds_read_b64_tr_b16 v[78:79], v3 offset:32768
    ds_read_b64_tr_b16 v[80:81], v3 offset:33792
    v_mfma_f32_32x32x16_bf16 v[26:41], v[86:89], v[216:219], v[26:41]
    ds_read_b64_tr_b16 v[82:83], v2 offset:36864
    ds_read_b64_tr_b16 v[84:85], v2 offset:37888
    s_waitcnt vmcnt(5)
    s_waitcnt lgkmcnt(6)
    v_mfma_f32_32x32x16_bf16 v[10:25], v[90:93], v[220:223], v[10:25]
    ds_read_b64_tr_b16 v[86:87], v3 offset:36864
    ds_read_b64_tr_b16 v[88:89], v3 offset:37888
    v_mfma_f32_32x32x16_bf16 v[26:41], v[94:97], v[220:223], v[26:41]
    ds_read_b64_tr_b16 v[90:91], v2 offset:40960
    ds_read_b64_tr_b16 v[92:93], v2 offset:41984
    s_waitcnt vmcnt(4)
    s_waitcnt lgkmcnt(6)
    v_mfma_f32_32x32x16_bf16 v[10:25], v[74:77], v[224:227], v[10:25]
    ds_read_b64_tr_b16 v[94:95], v3 offset:40960
    ds_read_b64_tr_b16 v[96:97], v3 offset:41984
    v_mfma_f32_32x32x16_bf16 v[26:41], v[78:81], v[224:227], v[26:41]
    ds_read_b64_tr_b16 v[74:75], v2 offset:45056
    ds_read_b64_tr_b16 v[76:77], v2 offset:46080
    s_waitcnt vmcnt(3)
    s_waitcnt lgkmcnt(6)
    v_mfma_f32_32x32x16_bf16 v[10:25], v[82:85], v[228:231], v[10:25]
    ds_read_b64_tr_b16 v[78:79], v3 offset:45056
    ds_read_b64_tr_b16 v[80:81], v3 offset:46080
    v_mfma_f32_32x32x16_bf16 v[26:41], v[86:89], v[228:231], v[26:41]
    ds_read_b64_tr_b16 v[82:83], v2 offset:49152
    ds_read_b64_tr_b16 v[84:85], v2 offset:50176
    s_waitcnt vmcnt(2)
    s_waitcnt lgkmcnt(6)
    v_mfma_f32_32x32x16_bf16 v[10:25], v[90:93], v[232:235], v[10:25]
    ds_read_b64_tr_b16 v[86:87], v3 offset:49152
    ds_read_b64_tr_b16 v[88:89], v3 offset:50176
    v_mfma_f32_32x32x16_bf16 v[26:41], v[94:97], v[232:235], v[26:41]
    v_add_u32 v6, 0x10000, v4
    v_add_u32 v7, 0x10000, v5
    v_add_u32 v8, 0x20000, v4
    v_add_u32 v9, 0x20000, v5
    ds_read_b64_tr_b16 v[90:91], v6 offset:16384
    ds_read_b64_tr_b16 v[92:93], v6 offset:17408
    s_waitcnt vmcnt(1)
    s_waitcnt lgkmcnt(6)
    v_mfma_f32_32x32x16_bf16 v[10:25], v[74:77], v[236:239], v[10:25]
    ds_read_b64_tr_b16 v[94:95], v7 offset:16384
    ds_read_b64_tr_b16 v[96:97], v7 offset:17408
    v_mfma_f32_32x32x16_bf16 v[26:41], v[78:81], v[236:239], v[26:41]
    ds_read_b64_tr_b16 v[74:75], v6 offset:20480
    ds_read_b64_tr_b16 v[76:77], v6 offset:21504
    s_waitcnt vmcnt(0)
    s_waitcnt lgkmcnt(6)
    v_mfma_f32_32x32x16_bf16 v[10:25], v[82:85], v[240:243], v[10:25]
    ds_read_b64_tr_b16 v[78:79], v7 offset:20480
    ds_read_b64_tr_b16 v[80:81], v7 offset:21504
    v_mfma_f32_32x32x16_bf16 v[26:41], v[86:89], v[240:243], v[26:41]
    ds_read_b64_tr_b16 v[82:83], v6 offset:24576
    ds_read_b64_tr_b16 v[84:85], v6 offset:25600
    s_waitcnt lgkmcnt(6)
    v_mfma_f32_32x32x16_bf16 v[42:57], v[90:93], v[116:119], 0
    ds_read_b64_tr_b16 v[86:87], v7 offset:24576
    ds_read_b64_tr_b16 v[88:89], v7 offset:25600
    v_mfma_f32_32x32x16_bf16 v[58:73], v[94:97], v[116:119], 0
    ds_read_b64_tr_b16 v[90:91], v6 offset:28672
    ds_read_b64_tr_b16 v[92:93], v6 offset:29696
    s_waitcnt lgkmcnt(6)
    v_mfma_f32_32x32x16_bf16 v[42:57], v[74:77], v[120:123], v[42:57]
    ds_read_b64_tr_b16 v[94:95], v7 offset:28672
    ds_read_b64_tr_b16 v[96:97], v7 offset:29696
    v_exp_f32 v98, -v10
    v_exp_f32 v99, -v11
    v_mfma_f32_32x32x16_bf16 v[58:73], v[78:81], v[120:123], v[58:73]
    ds_read_b64_tr_b16 v[74:75], v6 offset:32768
    ds_read_b64_tr_b16 v[76:77], v6 offset:33792
    v_fma_f32 v98, v98, s77, s77
    v_fma_f32 v99, v99, s77, s77
    s_waitcnt lgkmcnt(6)
    v_mfma_f32_32x32x16_bf16 v[42:57], v[82:85], v[124:127], v[42:57]
    ds_read_b64_tr_b16 v[78:79], v7 offset:32768
    ds_read_b64_tr_b16 v[80:81], v7 offset:33792
    v_rcp_f32 v98, v98
    v_rcp_f32 v99, v99
    v_mfma_f32_32x32x16_bf16 v[58:73], v[86:89], v[124:127], v[58:73]
    ds_read_b64_tr_b16 v[82:83], v6 offset:36864
    ds_read_b64_tr_b16 v[84:85], v6 offset:37888
    v_mul_f32 v98, v98, v18
    v_mul_f32 v99, v99, v19
    v_cvt_pk_bf16_f32 v106, v98, v99
    s_waitcnt lgkmcnt(6)
    v_mfma_f32_32x32x16_bf16 v[42:57], v[90:93], v[128:131], v[42:57]
    ds_read_b64_tr_b16 v[86:87], v7 offset:36864
    ds_read_b64_tr_b16 v[88:89], v7 offset:37888
    v_exp_f32 v100, -v12
    v_exp_f32 v101, -v13
    v_mfma_f32_32x32x16_bf16 v[58:73], v[94:97], v[128:131], v[58:73]
    s_barrier
    ds_read_b64_tr_b16 v[90:91], v6 offset:40960
    ds_read_b64_tr_b16 v[92:93], v6 offset:41984
    v_fma_f32 v100, v100, s77, s77
    v_fma_f32 v101, v101, s77, s77
    s_waitcnt lgkmcnt(6)
    v_mfma_f32_32x32x16_bf16 v[42:57], v[74:77], v[132:135], v[42:57]
    ds_read_b64_tr_b16 v[94:95], v7 offset:40960
    ds_read_b64_tr_b16 v[96:97], v7 offset:41984
    v_rcp_f32 v100, v100
    v_rcp_f32 v101, v101
    v_mfma_f32_32x32x16_bf16 v[58:73], v[78:81], v[132:135], v[58:73]
    ds_read_b64_tr_b16 v[74:75], v6 offset:45056
    ds_read_b64_tr_b16 v[76:77], v6 offset:46080
    v_mul_f32 v100, v100, v20
    v_mul_f32 v101, v101, v21
    v_cvt_pk_bf16_f32 v107, v100, v101
    s_waitcnt lgkmcnt(6)
    v_mfma_f32_32x32x16_bf16 v[42:57], v[82:85], v[136:139], v[42:57]
    ds_read_b64_tr_b16 v[78:79], v7 offset:45056
    ds_read_b64_tr_b16 v[80:81], v7 offset:46080
    v_exp_f32 v102, -v14
    v_exp_f32 v103, -v15
    v_mfma_f32_32x32x16_bf16 v[58:73], v[86:89], v[136:139], v[58:73]
    ds_read_b64_tr_b16 v[82:83], v6 offset:49152
    ds_read_b64_tr_b16 v[84:85], v6 offset:50176
    v_fma_f32 v102, v102, s77, s77
    v_fma_f32 v103, v103, s77, s77
    s_waitcnt lgkmcnt(6)
    v_mfma_f32_32x32x16_bf16 v[42:57], v[90:93], v[140:143], v[42:57]
    ds_read_b64_tr_b16 v[86:87], v7 offset:49152
    ds_read_b64_tr_b16 v[88:89], v7 offset:50176
    v_rcp_f32 v102, v102
    v_rcp_f32 v103, v103
    v_mfma_f32_32x32x16_bf16 v[58:73], v[94:97], v[140:143], v[58:73]
    ds_read_b64_tr_b16 v[90:91], v6 offset:53248
    ds_read_b64_tr_b16 v[92:93], v6 offset:54272
    v_mul_f32 v102, v102, v22
    v_mul_f32 v103, v103, v23
    v_cvt_pk_bf16_f32 v108, v102, v103
    s_waitcnt lgkmcnt(6)
    v_mfma_f32_32x32x16_bf16 v[42:57], v[74:77], v[144:147], v[42:57]
    ds_read_b64_tr_b16 v[94:95], v7 offset:53248
    ds_read_b64_tr_b16 v[96:97], v7 offset:54272
    v_exp_f32 v104, -v16
    v_exp_f32 v105, -v17
    v_mfma_f32_32x32x16_bf16 v[58:73], v[78:81], v[144:147], v[58:73]
    ds_read_b64_tr_b16 v[74:75], v6 offset:57344
    ds_read_b64_tr_b16 v[76:77], v6 offset:58368
    v_fma_f32 v104, v104, s77, s77
    v_fma_f32 v105, v105, s77, s77
    s_waitcnt lgkmcnt(6)
    v_mfma_f32_32x32x16_bf16 v[42:57], v[82:85], v[148:151], v[42:57]
    ds_read_b64_tr_b16 v[78:79], v7 offset:57344
    ds_read_b64_tr_b16 v[80:81], v7 offset:58368
    v_rcp_f32 v104, v104
    v_rcp_f32 v105, v105
    v_mfma_f32_32x32x16_bf16 v[58:73], v[86:89], v[148:151], v[58:73]
    ds_read_b64_tr_b16 v[82:83], v6 offset:61440
    ds_read_b64_tr_b16 v[84:85], v6 offset:62464
    v_mul_f32 v104, v104, v24
    v_mul_f32 v105, v105, v25
    v_cvt_pk_bf16_f32 v109, v104, v105
    s_waitcnt lgkmcnt(6)
    v_mfma_f32_32x32x16_bf16 v[42:57], v[90:93], v[152:155], v[42:57]
    ds_read_b64_tr_b16 v[86:87], v7 offset:61440
    ds_read_b64_tr_b16 v[88:89], v7 offset:62464
    s_add_u32 s70, s69, 0
    buffer_store_dwordx4 v[106:109], v0, s[32:35], s70 offen sc1
    v_exp_f32 v98, -v26
    v_mfma_f32_32x32x16_bf16 v[58:73], v[94:97], v[152:155], v[58:73]
    ds_read_b64_tr_b16 v[90:91], v8 offset:0
    ds_read_b64_tr_b16 v[92:93], v8 offset:1024
    v_exp_f32 v99, -v27
    v_fma_f32 v98, v98, s77, s77
    s_waitcnt lgkmcnt(6)
    v_mfma_f32_32x32x16_bf16 v[42:57], v[74:77], v[156:159], v[42:57]
    ds_read_b64_tr_b16 v[94:95], v9 offset:0
    ds_read_b64_tr_b16 v[96:97], v9 offset:1024
    v_fma_f32 v99, v99, s77, s77
    v_rcp_f32 v98, v98
    v_mfma_f32_32x32x16_bf16 v[58:73], v[78:81], v[156:159], v[58:73]
    ds_read_b64_tr_b16 v[74:75], v8 offset:4096
    ds_read_b64_tr_b16 v[76:77], v8 offset:5120
    v_rcp_f32 v99, v99
    v_mul_f32 v98, v98, v34
    s_waitcnt lgkmcnt(6)
    v_mfma_f32_32x32x16_bf16 v[42:57], v[82:85], v[160:163], v[42:57]
    ds_read_b64_tr_b16 v[78:79], v9 offset:4096
    ds_read_b64_tr_b16 v[80:81], v9 offset:5120
    v_mul_f32 v99, v99, v35
    v_cvt_pk_bf16_f32 v110, v98, v99
    v_exp_f32 v100, -v28
    v_mfma_f32_32x32x16_bf16 v[58:73], v[86:89], v[160:163], v[58:73]
    s_barrier
    ds_read_b64_tr_b16 v[82:83], v8 offset:8192
    ds_read_b64_tr_b16 v[84:85], v8 offset:9216
    v_exp_f32 v101, -v29
    s_waitcnt lgkmcnt(6)
    v_mfma_f32_32x32x16_bf16 v[42:57], v[90:93], v[164:167], v[42:57]
    ds_read_b64_tr_b16 v[86:87], v9 offset:8192
    ds_read_b64_tr_b16 v[88:89], v9 offset:9216
    v_fma_f32 v100, v100, s77, s77
    v_fma_f32 v101, v101, s77, s77
    v_rcp_f32 v100, v100
    v_mfma_f32_32x32x16_bf16 v[58:73], v[94:97], v[164:167], v[58:73]
    ds_read_b64_tr_b16 v[90:91], v8 offset:12288
    ds_read_b64_tr_b16 v[92:93], v8 offset:13312
    v_rcp_f32 v101, v101
    v_mul_f32 v100, v100, v36
    s_waitcnt lgkmcnt(6)
    v_mfma_f32_32x32x16_bf16 v[42:57], v[74:77], v[168:171], v[42:57]
    ds_read_b64_tr_b16 v[94:95], v9 offset:12288
    ds_read_b64_tr_b16 v[96:97], v9 offset:13312
    v_mul_f32 v101, v101, v37
    v_cvt_pk_bf16_f32 v111, v100, v101
    v_exp_f32 v102, -v30
    v_mfma_f32_32x32x16_bf16 v[58:73], v[78:81], v[168:171], v[58:73]
    ds_read_b64_tr_b16 v[74:75], v8 offset:16384
    ds_read_b64_tr_b16 v[76:77], v8 offset:17408
    v_exp_f32 v103, -v31
    v_fma_f32 v102, v102, s77, s77
    s_waitcnt lgkmcnt(6)
    v_mfma_f32_32x32x16_bf16 v[42:57], v[82:85], v[172:175], v[42:57]
    ds_read_b64_tr_b16 v[78:79], v9 offset:16384
    ds_read_b64_tr_b16 v[80:81], v9 offset:17408
    v_fma_f32 v103, v103, s77, s77
    v_rcp_f32 v102, v102
    v_mfma_f32_32x32x16_bf16 v[58:73], v[86:89], v[172:175], v[58:73]
    ds_read_b64_tr_b16 v[82:83], v8 offset:20480
    ds_read_b64_tr_b16 v[84:85], v8 offset:21504
    v_rcp_f32 v103, v103
    v_mul_f32 v102, v102, v38
    s_waitcnt lgkmcnt(6)
    v_mfma_f32_32x32x16_bf16 v[42:57], v[90:93], v[176:179], v[42:57]
    ds_read_b64_tr_b16 v[86:87], v9 offset:20480
    ds_read_b64_tr_b16 v[88:89], v9 offset:21504
    v_mul_f32 v103, v103, v39
    v_cvt_pk_bf16_f32 v112, v102, v103
    v_exp_f32 v104, -v32
    v_mfma_f32_32x32x16_bf16 v[58:73], v[94:97], v[176:179], v[58:73]
    ds_read_b64_tr_b16 v[90:91], v8 offset:24576
    ds_read_b64_tr_b16 v[92:93], v8 offset:25600
    v_exp_f32 v105, -v33
    v_fma_f32 v104, v104, s77, s77
    s_waitcnt lgkmcnt(6)
    v_mfma_f32_32x32x16_bf16 v[42:57], v[74:77], v[180:183], v[42:57]
    ds_read_b64_tr_b16 v[94:95], v9 offset:24576
    ds_read_b64_tr_b16 v[96:97], v9 offset:25600
    v_fma_f32 v105, v105, s77, s77
    v_rcp_f32 v104, v104
    v_mfma_f32_32x32x16_bf16 v[58:73], v[78:81], v[180:183], v[58:73]
    ds_read_b64_tr_b16 v[74:75], v4 offset:0
    ds_read_b64_tr_b16 v[76:77], v4 offset:1024
    v_rcp_f32 v105, v105
    v_mul_f32 v104, v104, v40
    s_waitcnt lgkmcnt(6)
    v_mfma_f32_32x32x16_bf16 v[42:57], v[82:85], v[184:187], v[42:57]
    ds_read_b64_tr_b16 v[78:79], v5 offset:0
    ds_read_b64_tr_b16 v[80:81], v5 offset:1024
    v_mul_f32 v105, v105, v41
    v_cvt_pk_bf16_f32 v113, v104, v105
    s_add_u32 s70, s69, 1024
    buffer_store_dwordx4 v[110:113], v0, s[32:35], s70 offen sc1
    v_mfma_f32_32x32x16_bf16 v[58:73], v[86:89], v[184:187], v[58:73]
    ds_read_b64_tr_b16 v[82:83], v4 offset:4096
    ds_read_b64_tr_b16 v[84:85], v4 offset:5120
    s_waitcnt lgkmcnt(6)
    v_mfma_f32_32x32x16_bf16 v[42:57], v[90:93], v[188:191], v[42:57]
    ds_read_b64_tr_b16 v[86:87], v5 offset:4096
    ds_read_b64_tr_b16 v[88:89], v5 offset:5120
    v_mfma_f32_32x32x16_bf16 v[58:73], v[94:97], v[188:191], v[58:73]
    ds_read_b64_tr_b16 v[90:91], v4 offset:8192
    ds_read_b64_tr_b16 v[92:93], v4 offset:9216
    s_waitcnt lgkmcnt(6)
    v_mfma_f32_32x32x16_bf16 v[42:57], v[74:77], v[192:195], v[42:57]
    ds_read_b64_tr_b16 v[94:95], v5 offset:8192
    ds_read_b64_tr_b16 v[96:97], v5 offset:9216
    v_mfma_f32_32x32x16_bf16 v[58:73], v[78:81], v[192:195], v[58:73]
    s_barrier
    ds_read_b64_tr_b16 v[74:75], v4 offset:12288
    ds_read_b64_tr_b16 v[76:77], v4 offset:13312
    s_waitcnt lgkmcnt(6)
    v_mfma_f32_32x32x16_bf16 v[42:57], v[82:85], v[196:199], v[42:57]
    ds_read_b64_tr_b16 v[78:79], v5 offset:12288
    ds_read_b64_tr_b16 v[80:81], v5 offset:13312
    v_mfma_f32_32x32x16_bf16 v[58:73], v[86:89], v[196:199], v[58:73]
    ds_read_b64_tr_b16 v[82:83], v4 offset:16384
    ds_read_b64_tr_b16 v[84:85], v4 offset:17408
    s_waitcnt lgkmcnt(6)
    v_mfma_f32_32x32x16_bf16 v[42:57], v[90:93], v[200:203], v[42:57]
    ds_read_b64_tr_b16 v[86:87], v5 offset:16384
    ds_read_b64_tr_b16 v[88:89], v5 offset:17408
    v_mfma_f32_32x32x16_bf16 v[58:73], v[94:97], v[200:203], v[58:73]
    ds_read_b64_tr_b16 v[90:91], v4 offset:20480
    ds_read_b64_tr_b16 v[92:93], v4 offset:21504
    s_waitcnt lgkmcnt(6)
    v_mfma_f32_32x32x16_bf16 v[42:57], v[74:77], v[204:207], v[42:57]
    ds_read_b64_tr_b16 v[94:95], v5 offset:20480
    ds_read_b64_tr_b16 v[96:97], v5 offset:21504
    v_mfma_f32_32x32x16_bf16 v[58:73], v[78:81], v[204:207], v[58:73]
    ds_read_b64_tr_b16 v[74:75], v4 offset:24576
    ds_read_b64_tr_b16 v[76:77], v4 offset:25600
    s_waitcnt lgkmcnt(6)
    v_mfma_f32_32x32x16_bf16 v[42:57], v[82:85], v[208:211], v[42:57]
    ds_read_b64_tr_b16 v[78:79], v5 offset:24576
    ds_read_b64_tr_b16 v[80:81], v5 offset:25600
    v_mfma_f32_32x32x16_bf16 v[58:73], v[86:89], v[208:211], v[58:73]
    ds_read_b64_tr_b16 v[82:83], v4 offset:28672
    ds_read_b64_tr_b16 v[84:85], v4 offset:29696
    s_waitcnt lgkmcnt(6)
    v_mfma_f32_32x32x16_bf16 v[42:57], v[90:93], v[212:215], v[42:57]
    ds_read_b64_tr_b16 v[86:87], v5 offset:28672
    ds_read_b64_tr_b16 v[88:89], v5 offset:29696
    v_mfma_f32_32x32x16_bf16 v[58:73], v[94:97], v[212:215], v[58:73]
    ds_read_b64_tr_b16 v[90:91], v4 offset:32768
    ds_read_b64_tr_b16 v[92:93], v4 offset:33792
    s_waitcnt lgkmcnt(6)
    v_mfma_f32_32x32x16_bf16 v[42:57], v[74:77], v[216:219], v[42:57]
    ds_read_b64_tr_b16 v[94:95], v5 offset:32768
    ds_read_b64_tr_b16 v[96:97], v5 offset:33792
    v_mfma_f32_32x32x16_bf16 v[58:73], v[78:81], v[216:219], v[58:73]
    ds_read_b64_tr_b16 v[74:75], v4 offset:36864
    ds_read_b64_tr_b16 v[76:77], v4 offset:37888
    s_waitcnt lgkmcnt(6)
    v_mfma_f32_32x32x16_bf16 v[42:57], v[82:85], v[220:223], v[42:57]
    ds_read_b64_tr_b16 v[78:79], v5 offset:36864
    ds_read_b64_tr_b16 v[80:81], v5 offset:37888
    v_mfma_f32_32x32x16_bf16 v[58:73], v[86:89], v[220:223], v[58:73]
    ds_read_b64_tr_b16 v[82:83], v4 offset:40960
    ds_read_b64_tr_b16 v[84:85], v4 offset:41984
    s_waitcnt lgkmcnt(6)
    v_mfma_f32_32x32x16_bf16 v[42:57], v[90:93], v[224:227], v[42:57]
    ds_read_b64_tr_b16 v[86:87], v5 offset:40960
    ds_read_b64_tr_b16 v[88:89], v5 offset:41984
    v_mfma_f32_32x32x16_bf16 v[58:73], v[94:97], v[224:227], v[58:73]
    s_barrier
    ds_read_b64_tr_b16 v[90:91], v4 offset:45056
    ds_read_b64_tr_b16 v[92:93], v4 offset:46080
    s_waitcnt lgkmcnt(6)
    v_mfma_f32_32x32x16_bf16 v[42:57], v[74:77], v[228:231], v[42:57]
    ds_read_b64_tr_b16 v[94:95], v5 offset:45056
    ds_read_b64_tr_b16 v[96:97], v5 offset:46080
    v_mfma_f32_32x32x16_bf16 v[58:73], v[78:81], v[228:231], v[58:73]
    ds_read_b64_tr_b16 v[74:75], v4 offset:49152
    ds_read_b64_tr_b16 v[76:77], v4 offset:50176
    s_waitcnt lgkmcnt(6)
    v_mfma_f32_32x32x16_bf16 v[42:57], v[82:85], v[232:235], v[42:57]
    ds_read_b64_tr_b16 v[78:79], v5 offset:49152
    ds_read_b64_tr_b16 v[80:81], v5 offset:50176
    v_mfma_f32_32x32x16_bf16 v[58:73], v[86:89], v[232:235], v[58:73]
    v_add_u32 v6, 0x10000, v2
    v_add_u32 v7, 0x10000, v3
    v_add_u32 v8, 0x20000, v2
    v_add_u32 v9, 0x20000, v3
    ds_read_b64_tr_b16 v[82:83], v2 offset:53248
    ds_read_b64_tr_b16 v[84:85], v2 offset:54272
    s_waitcnt lgkmcnt(6)
    v_mfma_f32_32x32x16_bf16 v[42:57], v[90:93], v[236:239], v[42:57]
    ds_read_b64_tr_b16 v[86:87], v3 offset:53248
    ds_read_b64_tr_b16 v[88:89], v3 offset:54272
    v_mfma_f32_32x32x16_bf16 v[58:73], v[94:97], v[236:239], v[58:73]
    ds_read_b64_tr_b16 v[90:91], v2 offset:57344
    ds_read_b64_tr_b16 v[92:93], v2 offset:58368
    s_waitcnt lgkmcnt(6)
    v_mfma_f32_32x32x16_bf16 v[42:57], v[74:77], v[240:243], v[42:57]
    ds_read_b64_tr_b16 v[94:95], v3 offset:57344
    ds_read_b64_tr_b16 v[96:97], v3 offset:58368
    v_mfma_f32_32x32x16_bf16 v[58:73], v[78:81], v[240:243], v[58:73]
    ds_read_b64_tr_b16 v[74:75], v2 offset:61440
    ds_read_b64_tr_b16 v[76:77], v2 offset:62464
    s_waitcnt lgkmcnt(6)
    v_mfma_f32_32x32x16_bf16 v[10:25], v[82:85], v[116:119], 0
    ds_read_b64_tr_b16 v[78:79], v3 offset:61440
    ds_read_b64_tr_b16 v[80:81], v3 offset:62464
    v_mfma_f32_32x32x16_bf16 v[26:41], v[86:89], v[116:119], 0
    ds_read_b64_tr_b16 v[82:83], v6 offset:0
    ds_read_b64_tr_b16 v[84:85], v6 offset:1024
    s_waitcnt lgkmcnt(6)
    v_mfma_f32_32x32x16_bf16 v[10:25], v[90:93], v[120:123], v[10:25]
    ds_read_b64_tr_b16 v[86:87], v7 offset:0
    ds_read_b64_tr_b16 v[88:89], v7 offset:1024
    v_exp_f32 v98, -v42
    v_exp_f32 v99, -v43
    v_mfma_f32_32x32x16_bf16 v[26:41], v[94:97], v[120:123], v[26:41]
    ds_read_b64_tr_b16 v[90:91], v6 offset:4096
    ds_read_b64_tr_b16 v[92:93], v6 offset:5120
    v_fma_f32 v98, v98, s77, s77
    v_fma_f32 v99, v99, s77, s77
    s_waitcnt lgkmcnt(6)
    v_mfma_f32_32x32x16_bf16 v[10:25], v[74:77], v[124:127], v[10:25]
    ds_read_b64_tr_b16 v[94:95], v7 offset:4096
    ds_read_b64_tr_b16 v[96:97], v7 offset:5120
    v_rcp_f32 v98, v98
    v_rcp_f32 v99, v99
    v_mfma_f32_32x32x16_bf16 v[26:41], v[78:81], v[124:127], v[26:41]
    ds_read_b64_tr_b16 v[74:75], v6 offset:8192
    ds_read_b64_tr_b16 v[76:77], v6 offset:9216
    v_mul_f32 v98, v98, v50
    v_mul_f32 v99, v99, v51
    v_cvt_pk_bf16_f32 v106, v98, v99
    s_waitcnt lgkmcnt(6)
    v_mfma_f32_32x32x16_bf16 v[10:25], v[82:85], v[128:131], v[10:25]
    ds_read_b64_tr_b16 v[78:79], v7 offset:8192
    ds_read_b64_tr_b16 v[80:81], v7 offset:9216
    v_exp_f32 v100, -v44
    v_exp_f32 v101, -v45
    v_mfma_f32_32x32x16_bf16 v[26:41], v[86:89], v[128:131], v[26:41]
    s_barrier
    ds_read_b64_tr_b16 v[82:83], v6 offset:12288
    ds_read_b64_tr_b16 v[84:85], v6 offset:13312
    v_fma_f32 v100, v100, s77, s77
    v_fma_f32 v101, v101, s77, s77
    s_waitcnt lgkmcnt(6)
    v_mfma_f32_32x32x16_bf16 v[10:25], v[90:93], v[132:135], v[10:25]
    ds_read_b64_tr_b16 v[86:87], v7 offset:12288
    ds_read_b64_tr_b16 v[88:89], v7 offset:13312
    v_rcp_f32 v100, v100
    v_rcp_f32 v101, v101
    v_mfma_f32_32x32x16_bf16 v[26:41], v[94:97], v[132:135], v[26:41]
    ds_read_b64_tr_b16 v[90:91], v6 offset:16384
    ds_read_b64_tr_b16 v[92:93], v6 offset:17408
    v_mul_f32 v100, v100, v52
    v_mul_f32 v101, v101, v53
    v_cvt_pk_bf16_f32 v107, v100, v101
    s_waitcnt lgkmcnt(6)
    v_mfma_f32_32x32x16_bf16 v[10:25], v[74:77], v[136:139], v[10:25]
    ds_read_b64_tr_b16 v[94:95], v7 offset:16384
    ds_read_b64_tr_b16 v[96:97], v7 offset:17408
    v_exp_f32 v102, -v46
    v_exp_f32 v103, -v47
    v_mfma_f32_32x32x16_bf16 v[26:41], v[78:81], v[136:139], v[26:41]
    ds_read_b64_tr_b16 v[74:75], v6 offset:20480
    ds_read_b64_tr_b16 v[76:77], v6 offset:21504
    v_fma_f32 v102, v102, s77, s77
    v_fma_f32 v103, v103, s77, s77
    s_waitcnt lgkmcnt(6)
    v_mfma_f32_32x32x16_bf16 v[10:25], v[82:85], v[140:143], v[10:25]
    ds_read_b64_tr_b16 v[78:79], v7 offset:20480
    ds_read_b64_tr_b16 v[80:81], v7 offset:21504
    v_rcp_f32 v102, v102
    v_rcp_f32 v103, v103
    s_waitcnt vmcnt(0)
    s_add_u32 s71, s73, 0
    s_mov_b64 exec, 1
    buffer_store_dword v114, v0, s[32:35], s71 offen
    s_mov_b64 exec, -1
    v_mfma_f32_32x32x16_bf16 v[26:41], v[86:89], v[140:143], v[26:41]
    ds_read_b64_tr_b16 v[82:83], v6 offset:24576
    ds_read_b64_tr_b16 v[84:85], v6 offset:25600
    v_mul_f32 v102, v102, v54
    v_mul_f32 v103, v103, v55
    v_cvt_pk_bf16_f32 v108, v102, v103
    s_waitcnt lgkmcnt(6)
    v_mfma_f32_32x32x16_bf16 v[10:25], v[90:93], v[144:147], v[10:25]
    ds_read_b64_tr_b16 v[86:87], v7 offset:24576
    ds_read_b64_tr_b16 v[88:89], v7 offset:25600
    v_exp_f32 v104, -v48
    v_exp_f32 v105, -v49
    v_mfma_f32_32x32x16_bf16 v[26:41], v[94:97], v[144:147], v[26:41]
    ds_read_b64_tr_b16 v[90:91], v6 offset:28672
    ds_read_b64_tr_b16 v[92:93], v6 offset:29696
    v_fma_f32 v104, v104, s77, s77
    v_fma_f32 v105, v105, s77, s77
    s_waitcnt lgkmcnt(6)
    v_mfma_f32_32x32x16_bf16 v[10:25], v[74:77], v[148:151], v[10:25]
    ds_read_b64_tr_b16 v[94:95], v7 offset:28672
    ds_read_b64_tr_b16 v[96:97], v7 offset:29696
    v_rcp_f32 v104, v104
    v_rcp_f32 v105, v105
    v_mfma_f32_32x32x16_bf16 v[26:41], v[78:81], v[148:151], v[26:41]
    ds_read_b64_tr_b16 v[74:75], v6 offset:32768
    ds_read_b64_tr_b16 v[76:77], v6 offset:33792
    v_mul_f32 v104, v104, v56
    v_mul_f32 v105, v105, v57
    v_cvt_pk_bf16_f32 v109, v104, v105
    s_waitcnt lgkmcnt(6)
    v_mfma_f32_32x32x16_bf16 v[10:25], v[82:85], v[152:155], v[10:25]
    ds_read_b64_tr_b16 v[78:79], v7 offset:32768
    ds_read_b64_tr_b16 v[80:81], v7 offset:33792
    s_add_u32 s70, s69, 2048
    buffer_store_dwordx4 v[106:109], v0, s[32:35], s70 offen sc1
    v_exp_f32 v98, -v58
    v_mfma_f32_32x32x16_bf16 v[26:41], v[86:89], v[152:155], v[26:41]
    ds_read_b64_tr_b16 v[82:83], v6 offset:36864
    ds_read_b64_tr_b16 v[84:85], v6 offset:37888
    v_exp_f32 v99, -v59
    v_fma_f32 v98, v98, s77, s77
    s_waitcnt lgkmcnt(6)
    v_mfma_f32_32x32x16_bf16 v[10:25], v[90:93], v[156:159], v[10:25]
    ds_read_b64_tr_b16 v[86:87], v7 offset:36864
    ds_read_b64_tr_b16 v[88:89], v7 offset:37888
    v_fma_f32 v99, v99, s77, s77
    v_rcp_f32 v98, v98
    v_mfma_f32_32x32x16_bf16 v[26:41], v[94:97], v[156:159], v[26:41]
    ds_read_b64_tr_b16 v[90:91], v6 offset:40960
    ds_read_b64_tr_b16 v[92:93], v6 offset:41984
    v_rcp_f32 v99, v99
    v_mul_f32 v98, v98, v66
    s_waitcnt lgkmcnt(6)
    v_mfma_f32_32x32x16_bf16 v[10:25], v[74:77], v[160:163], v[10:25]
    ds_read_b64_tr_b16 v[94:95], v7 offset:40960
    ds_read_b64_tr_b16 v[96:97], v7 offset:41984
    v_mul_f32 v99, v99, v67
    v_cvt_pk_bf16_f32 v110, v98, v99
    v_exp_f32 v100, -v60
    v_mfma_f32_32x32x16_bf16 v[26:41], v[78:81], v[160:163], v[26:41]
    s_barrier
    ds_read_b64_tr_b16 v[74:75], v6 offset:45056
    ds_read_b64_tr_b16 v[76:77], v6 offset:46080
    v_exp_f32 v101, -v61
    s_waitcnt lgkmcnt(6)
    v_mfma_f32_32x32x16_bf16 v[10:25], v[82:85], v[164:167], v[10:25]
    ds_read_b64_tr_b16 v[78:79], v7 offset:45056
    ds_read_b64_tr_b16 v[80:81], v7 offset:46080
    v_fma_f32 v100, v100, s77, s77
    v_fma_f32 v101, v101, s77, s77
    v_rcp_f32 v100, v100
    v_mfma_f32_32x32x16_bf16 v[26:41], v[86:89], v[164:167], v[26:41]
    ds_read_b64_tr_b16 v[82:83], v6 offset:49152
    ds_read_b64_tr_b16 v[84:85], v6 offset:50176
    v_rcp_f32 v101, v101
    v_mul_f32 v100, v100, v68
    s_waitcnt lgkmcnt(6)
    v_mfma_f32_32x32x16_bf16 v[10:25], v[90:93], v[168:171], v[10:25]
    ds_read_b64_tr_b16 v[86:87], v7 offset:49152
    ds_read_b64_tr_b16 v[88:89], v7 offset:50176
    v_mul_f32 v101, v101, v69
    v_cvt_pk_bf16_f32 v111, v100, v101
    v_exp_f32 v102, -v62
    v_mfma_f32_32x32x16_bf16 v[26:41], v[94:97], v[168:171], v[26:41]
    ds_read_b64_tr_b16 v[90:91], v6 offset:53248
    ds_read_b64_tr_b16 v[92:93], v6 offset:54272
    v_exp_f32 v103, -v63
    v_fma_f32 v102, v102, s77, s77
    s_waitcnt lgkmcnt(6)
    v_mfma_f32_32x32x16_bf16 v[10:25], v[74:77], v[172:175], v[10:25]
    ds_read_b64_tr_b16 v[94:95], v7 offset:53248
    ds_read_b64_tr_b16 v[96:97], v7 offset:54272
    v_fma_f32 v103, v103, s77, s77
    v_rcp_f32 v102, v102
    v_mfma_f32_32x32x16_bf16 v[26:41], v[78:81], v[172:175], v[26:41]
    ds_read_b64_tr_b16 v[74:75], v6 offset:57344
    ds_read_b64_tr_b16 v[76:77], v6 offset:58368
    v_rcp_f32 v103, v103
    v_mul_f32 v102, v102, v70
    s_waitcnt lgkmcnt(6)
    v_mfma_f32_32x32x16_bf16 v[10:25], v[82:85], v[176:179], v[10:25]
    ds_read_b64_tr_b16 v[78:79], v7 offset:57344
    ds_read_b64_tr_b16 v[80:81], v7 offset:58368
    v_mul_f32 v103, v103, v71
    v_cvt_pk_bf16_f32 v112, v102, v103
    v_exp_f32 v104, -v64
    v_mfma_f32_32x32x16_bf16 v[26:41], v[86:89], v[176:179], v[26:41]
    ds_read_b64_tr_b16 v[82:83], v6 offset:61440
    ds_read_b64_tr_b16 v[84:85], v6 offset:62464
    v_exp_f32 v105, -v65
    v_fma_f32 v104, v104, s77, s77
    s_waitcnt lgkmcnt(6)
    v_mfma_f32_32x32x16_bf16 v[10:25], v[90:93], v[180:183], v[10:25]
    ds_read_b64_tr_b16 v[86:87], v7 offset:61440
    ds_read_b64_tr_b16 v[88:89], v7 offset:62464
    v_fma_f32 v105, v105, s77, s77
    v_rcp_f32 v104, v104
    v_mfma_f32_32x32x16_bf16 v[26:41], v[94:97], v[180:183], v[26:41]
    ds_read_b64_tr_b16 v[90:91], v8 offset:0
    ds_read_b64_tr_b16 v[92:93], v8 offset:1024
    v_rcp_f32 v105, v105
    v_mul_f32 v104, v104, v72
    s_waitcnt lgkmcnt(6)
    v_mfma_f32_32x32x16_bf16 v[10:25], v[74:77], v[184:187], v[10:25]
    ds_read_b64_tr_b16 v[94:95], v9 offset:0
    ds_read_b64_tr_b16 v[96:97], v9 offset:1024
    v_mul_f32 v105, v105, v73
    v_cvt_pk_bf16_f32 v113, v104, v105
    s_add_u32 s70, s69, 3072
    buffer_store_dwordx4 v[110:113], v0, s[32:35], s70 offen sc1
    v_mfma_f32_32x32x16_bf16 v[26:41], v[78:81], v[184:187], v[26:41]
    ds_read_b64_tr_b16 v[74:75], v8 offset:4096
    ds_read_b64_tr_b16 v[76:77], v8 offset:5120
    s_waitcnt lgkmcnt(6)
    v_mfma_f32_32x32x16_bf16 v[10:25], v[82:85], v[188:191], v[10:25]
    ds_read_b64_tr_b16 v[78:79], v9 offset:4096
    ds_read_b64_tr_b16 v[80:81], v9 offset:5120
    v_mfma_f32_32x32x16_bf16 v[26:41], v[86:89], v[188:191], v[26:41]
    ds_read_b64_tr_b16 v[82:83], v8 offset:8192
    ds_read_b64_tr_b16 v[84:85], v8 offset:9216
    s_waitcnt lgkmcnt(6)
    v_mfma_f32_32x32x16_bf16 v[10:25], v[90:93], v[192:195], v[10:25]
    ds_read_b64_tr_b16 v[86:87], v9 offset:8192
    ds_read_b64_tr_b16 v[88:89], v9 offset:9216
    v_mfma_f32_32x32x16_bf16 v[26:41], v[94:97], v[192:195], v[26:41]
    s_barrier
    ds_read_b64_tr_b16 v[90:91], v8 offset:12288
    ds_read_b64_tr_b16 v[92:93], v8 offset:13312
    s_waitcnt lgkmcnt(6)
    v_mfma_f32_32x32x16_bf16 v[10:25], v[74:77], v[196:199], v[10:25]
    ds_read_b64_tr_b16 v[94:95], v9 offset:12288
    ds_read_b64_tr_b16 v[96:97], v9 offset:13312
    v_mfma_f32_32x32x16_bf16 v[26:41], v[78:81], v[196:199], v[26:41]
    ds_read_b64_tr_b16 v[74:75], v8 offset:16384
    ds_read_b64_tr_b16 v[76:77], v8 offset:17408
    s_waitcnt lgkmcnt(6)
    v_mfma_f32_32x32x16_bf16 v[10:25], v[82:85], v[200:203], v[10:25]
    ds_read_b64_tr_b16 v[78:79], v9 offset:16384
    ds_read_b64_tr_b16 v[80:81], v9 offset:17408
    v_mfma_f32_32x32x16_bf16 v[26:41], v[86:89], v[200:203], v[26:41]
    ds_read_b64_tr_b16 v[82:83], v8 offset:20480
    ds_read_b64_tr_b16 v[84:85], v8 offset:21504
    s_waitcnt lgkmcnt(6)
    v_mfma_f32_32x32x16_bf16 v[10:25], v[90:93], v[204:207], v[10:25]
    ds_read_b64_tr_b16 v[86:87], v9 offset:20480
    ds_read_b64_tr_b16 v[88:89], v9 offset:21504
    v_mfma_f32_32x32x16_bf16 v[26:41], v[94:97], v[204:207], v[26:41]
    ds_read_b64_tr_b16 v[90:91], v8 offset:24576
    ds_read_b64_tr_b16 v[92:93], v8 offset:25600
    s_waitcnt lgkmcnt(6)
    v_mfma_f32_32x32x16_bf16 v[10:25], v[74:77], v[208:211], v[10:25]
    ds_read_b64_tr_b16 v[94:95], v9 offset:24576
    ds_read_b64_tr_b16 v[96:97], v9 offset:25600
    v_mfma_f32_32x32x16_bf16 v[26:41], v[78:81], v[208:211], v[26:41]
    ds_read_b64_tr_b16 v[74:75], v2 offset:0
    ds_read_b64_tr_b16 v[76:77], v2 offset:1024
    s_waitcnt lgkmcnt(6)
    v_mfma_f32_32x32x16_bf16 v[10:25], v[82:85], v[212:215], v[10:25]
    ds_read_b64_tr_b16 v[78:79], v3 offset:0
    ds_read_b64_tr_b16 v[80:81], v3 offset:1024
    v_mfma_f32_32x32x16_bf16 v[26:41], v[86:89], v[212:215], v[26:41]
    ds_read_b64_tr_b16 v[82:83], v2 offset:4096
    ds_read_b64_tr_b16 v[84:85], v2 offset:5120
    s_waitcnt lgkmcnt(6)
    v_mfma_f32_32x32x16_bf16 v[10:25], v[90:93], v[216:219], v[10:25]
    ds_read_b64_tr_b16 v[86:87], v3 offset:4096
    ds_read_b64_tr_b16 v[88:89], v3 offset:5120
    v_mfma_f32_32x32x16_bf16 v[26:41], v[94:97], v[216:219], v[26:41]
    ds_read_b64_tr_b16 v[90:91], v2 offset:8192
    ds_read_b64_tr_b16 v[92:93], v2 offset:9216
    s_waitcnt lgkmcnt(6)
    v_mfma_f32_32x32x16_bf16 v[10:25], v[74:77], v[220:223], v[10:25]
    ds_read_b64_tr_b16 v[94:95], v3 offset:8192
    ds_read_b64_tr_b16 v[96:97], v3 offset:9216
    v_mfma_f32_32x32x16_bf16 v[26:41], v[78:81], v[220:223], v[26:41]
    ds_read_b64_tr_b16 v[74:75], v2 offset:12288
    ds_read_b64_tr_b16 v[76:77], v2 offset:13312
    s_waitcnt lgkmcnt(6)
    v_mfma_f32_32x32x16_bf16 v[10:25], v[82:85], v[224:227], v[10:25]
    ds_read_b64_tr_b16 v[78:79], v3 offset:12288
    ds_read_b64_tr_b16 v[80:81], v3 offset:13312
    v_mfma_f32_32x32x16_bf16 v[26:41], v[86:89], v[224:227], v[26:41]
    ds_read_b64_tr_b16 v[82:83], v2 offset:16384
    ds_read_b64_tr_b16 v[84:85], v2 offset:17408
    s_waitcnt lgkmcnt(6)
    v_mfma_f32_32x32x16_bf16 v[10:25], v[90:93], v[228:231], v[10:25]
    ds_read_b64_tr_b16 v[86:87], v3 offset:16384
    ds_read_b64_tr_b16 v[88:89], v3 offset:17408
    v_mfma_f32_32x32x16_bf16 v[26:41], v[94:97], v[228:231], v[26:41]
    ds_read_b64_tr_b16 v[90:91], v2 offset:20480
    ds_read_b64_tr_b16 v[92:93], v2 offset:21504
    s_waitcnt lgkmcnt(6)
    v_mfma_f32_32x32x16_bf16 v[10:25], v[74:77], v[232:235], v[10:25]
    ds_read_b64_tr_b16 v[94:95], v3 offset:20480
    ds_read_b64_tr_b16 v[96:97], v3 offset:21504
    v_mfma_f32_32x32x16_bf16 v[26:41], v[78:81], v[232:235], v[26:41]
    v_add_u32 v6, 0x10000, v4
    v_add_u32 v7, 0x10000, v5
    v_add_u32 v8, 0x20000, v4
    v_add_u32 v9, 0x20000, v5
    ds_read_b64_tr_b16 v[74:75], v4 offset:53248
    ds_read_b64_tr_b16 v[76:77], v4 offset:54272
    s_waitcnt lgkmcnt(6)
    v_mfma_f32_32x32x16_bf16 v[10:25], v[82:85], v[236:239], v[10:25]
    ds_read_b64_tr_b16 v[78:79], v5 offset:53248
    ds_read_b64_tr_b16 v[80:81], v5 offset:54272
    v_mfma_f32_32x32x16_bf16 v[26:41], v[86:89], v[236:239], v[26:41]
    ds_read_b64_tr_b16 v[82:83], v4 offset:57344
    ds_read_b64_tr_b16 v[84:85], v4 offset:58368
    s_waitcnt lgkmcnt(6)
    v_mfma_f32_32x32x16_bf16 v[10:25], v[90:93], v[240:243], v[10:25]
    ds_read_b64_tr_b16 v[86:87], v5 offset:57344
    ds_read_b64_tr_b16 v[88:89], v5 offset:58368
    v_mfma_f32_32x32x16_bf16 v[26:41], v[94:97], v[240:243], v[26:41]
    ds_read_b64_tr_b16 v[90:91], v4 offset:61440
    ds_read_b64_tr_b16 v[92:93], v4 offset:62464
    s_waitcnt lgkmcnt(6)
    v_mfma_f32_32x32x16_bf16 v[42:57], v[74:77], v[116:119], 0
    ds_read_b64_tr_b16 v[94:95], v5 offset:61440
    ds_read_b64_tr_b16 v[96:97], v5 offset:62464
    v_mfma_f32_32x32x16_bf16 v[58:73], v[78:81], v[116:119], 0
    ds_read_b64_tr_b16 v[74:75], v6 offset:0
    ds_read_b64_tr_b16 v[76:77], v6 offset:1024
    s_waitcnt lgkmcnt(6)
    v_mfma_f32_32x32x16_bf16 v[42:57], v[82:85], v[120:123], v[42:57]
    ds_read_b64_tr_b16 v[78:79], v7 offset:0
    ds_read_b64_tr_b16 v[80:81], v7 offset:1024
    v_exp_f32 v98, -v10
    v_exp_f32 v99, -v11
    v_mfma_f32_32x32x16_bf16 v[58:73], v[86:89], v[120:123], v[58:73]
    ds_read_b64_tr_b16 v[82:83], v6 offset:4096
    ds_read_b64_tr_b16 v[84:85], v6 offset:5120
    v_fma_f32 v98, v98, s77, s77
    v_fma_f32 v99, v99, s77, s77
    s_waitcnt lgkmcnt(6)
    v_mfma_f32_32x32x16_bf16 v[42:57], v[90:93], v[124:127], v[42:57]
    ds_read_b64_tr_b16 v[86:87], v7 offset:4096
    ds_read_b64_tr_b16 v[88:89], v7 offset:5120
    v_rcp_f32 v98, v98
    v_rcp_f32 v99, v99
    v_mfma_f32_32x32x16_bf16 v[58:73], v[94:97], v[124:127], v[58:73]
    ds_read_b64_tr_b16 v[90:91], v6 offset:8192
    ds_read_b64_tr_b16 v[92:93], v6 offset:9216
    v_mul_f32 v98, v98, v18
    v_mul_f32 v99, v99, v19
    v_cvt_pk_bf16_f32 v106, v98, v99
    s_waitcnt lgkmcnt(6)
    v_mfma_f32_32x32x16_bf16 v[42:57], v[74:77], v[128:131], v[42:57]
    ds_read_b64_tr_b16 v[94:95], v7 offset:8192
    ds_read_b64_tr_b16 v[96:97], v7 offset:9216
    v_exp_f32 v100, -v12
    v_exp_f32 v101, -v13
    v_mfma_f32_32x32x16_bf16 v[58:73], v[78:81], v[128:131], v[58:73]
    s_barrier
    ds_read_b64_tr_b16 v[74:75], v6 offset:12288
    ds_read_b64_tr_b16 v[76:77], v6 offset:13312
    v_fma_f32 v100, v100, s77, s77
    v_fma_f32 v101, v101, s77, s77
    s_waitcnt lgkmcnt(6)
    v_mfma_f32_32x32x16_bf16 v[42:57], v[82:85], v[132:135], v[42:57]
    ds_read_b64_tr_b16 v[78:79], v7 offset:12288
    ds_read_b64_tr_b16 v[80:81], v7 offset:13312
    v_rcp_f32 v100, v100
    v_rcp_f32 v101, v101
    v_mfma_f32_32x32x16_bf16 v[58:73], v[86:89], v[132:135], v[58:73]
    ds_read_b64_tr_b16 v[82:83], v6 offset:16384
    ds_read_b64_tr_b16 v[84:85], v6 offset:17408
    v_mul_f32 v100, v100, v20
    v_mul_f32 v101, v101, v21
    v_cvt_pk_bf16_f32 v107, v100, v101
    s_waitcnt lgkmcnt(6)
    v_mfma_f32_32x32x16_bf16 v[42:57], v[90:93], v[136:139], v[42:57]
    ds_read_b64_tr_b16 v[86:87], v7 offset:16384
    ds_read_b64_tr_b16 v[88:89], v7 offset:17408
    v_exp_f32 v102, -v14
    v_exp_f32 v103, -v15
    v_mfma_f32_32x32x16_bf16 v[58:73], v[94:97], v[136:139], v[58:73]
    ds_read_b64_tr_b16 v[90:91], v6 offset:20480
    ds_read_b64_tr_b16 v[92:93], v6 offset:21504
    v_fma_f32 v102, v102, s77, s77
    v_fma_f32 v103, v103, s77, s77
    s_waitcnt lgkmcnt(6)
    v_mfma_f32_32x32x16_bf16 v[42:57], v[74:77], v[140:143], v[42:57]
    ds_read_b64_tr_b16 v[94:95], v7 offset:20480
    ds_read_b64_tr_b16 v[96:97], v7 offset:21504
    v_rcp_f32 v102, v102
    v_rcp_f32 v103, v103
    s_waitcnt vmcnt(0)
    s_add_u32 s71, s73, 512
    s_mov_b64 exec, 1
    buffer_store_dword v114, v0, s[32:35], s71 offen
    s_mov_b64 exec, -1
    v_mfma_f32_32x32x16_bf16 v[58:73], v[78:81], v[140:143], v[58:73]
    ds_read_b64_tr_b16 v[74:75], v6 offset:24576
    ds_read_b64_tr_b16 v[76:77], v6 offset:25600
    v_mul_f32 v102, v102, v22
    v_mul_f32 v103, v103, v23
    v_cvt_pk_bf16_f32 v108, v102, v103
    s_waitcnt lgkmcnt(6)
    v_mfma_f32_32x32x16_bf16 v[42:57], v[82:85], v[144:147], v[42:57]
    ds_read_b64_tr_b16 v[78:79], v7 offset:24576
    ds_read_b64_tr_b16 v[80:81], v7 offset:25600
    v_exp_f32 v104, -v16
    v_exp_f32 v105, -v17
    v_mfma_f32_32x32x16_bf16 v[58:73], v[86:89], v[144:147], v[58:73]
    ds_read_b64_tr_b16 v[82:83], v6 offset:28672
    ds_read_b64_tr_b16 v[84:85], v6 offset:29696
    v_fma_f32 v104, v104, s77, s77
    v_fma_f32 v105, v105, s77, s77
    s_waitcnt lgkmcnt(6)
    v_mfma_f32_32x32x16_bf16 v[42:57], v[90:93], v[148:151], v[42:57]
    ds_read_b64_tr_b16 v[86:87], v7 offset:28672
    ds_read_b64_tr_b16 v[88:89], v7 offset:29696
    v_rcp_f32 v104, v104
    v_rcp_f32 v105, v105
    v_mfma_f32_32x32x16_bf16 v[58:73], v[94:97], v[148:151], v[58:73]
    ds_read_b64_tr_b16 v[90:91], v6 offset:32768
    ds_read_b64_tr_b16 v[92:93], v6 offset:33792
    v_mul_f32 v104, v104, v24
    v_mul_f32 v105, v105, v25
    v_cvt_pk_bf16_f32 v109, v104, v105
    s_waitcnt lgkmcnt(6)
    v_mfma_f32_32x32x16_bf16 v[42:57], v[74:77], v[152:155], v[42:57]
    ds_read_b64_tr_b16 v[94:95], v7 offset:32768
    ds_read_b64_tr_b16 v[96:97], v7 offset:33792
    s_add_u32 s70, s78, 4096
    buffer_store_dwordx4 v[106:109], v0, s[32:35], s70 offen sc1
    v_exp_f32 v98, -v26
    v_mfma_f32_32x32x16_bf16 v[58:73], v[78:81], v[152:155], v[58:73]
    ds_read_b64_tr_b16 v[74:75], v6 offset:36864
    ds_read_b64_tr_b16 v[76:77], v6 offset:37888
    v_exp_f32 v99, -v27
    v_fma_f32 v98, v98, s77, s77
    s_waitcnt lgkmcnt(6)
    v_mfma_f32_32x32x16_bf16 v[42:57], v[82:85], v[156:159], v[42:57]
    ds_read_b64_tr_b16 v[78:79], v7 offset:36864
    ds_read_b64_tr_b16 v[80:81], v7 offset:37888
    v_fma_f32 v99, v99, s77, s77
    v_rcp_f32 v98, v98
    v_mfma_f32_32x32x16_bf16 v[58:73], v[86:89], v[156:159], v[58:73]
    ds_read_b64_tr_b16 v[82:83], v6 offset:40960
    ds_read_b64_tr_b16 v[84:85], v6 offset:41984
    v_rcp_f32 v99, v99
    v_mul_f32 v98, v98, v34
    s_waitcnt lgkmcnt(6)
    v_mfma_f32_32x32x16_bf16 v[42:57], v[90:93], v[160:163], v[42:57]
    ds_read_b64_tr_b16 v[86:87], v7 offset:40960
    ds_read_b64_tr_b16 v[88:89], v7 offset:41984
    v_mul_f32 v99, v99, v35
    v_cvt_pk_bf16_f32 v110, v98, v99
    v_exp_f32 v100, -v28
    v_mfma_f32_32x32x16_bf16 v[58:73], v[94:97], v[160:163], v[58:73]
    s_barrier
    ds_read_b64_tr_b16 v[90:91], v6 offset:45056
    ds_read_b64_tr_b16 v[92:93], v6 offset:46080
    v_exp_f32 v101, -v29
    s_waitcnt lgkmcnt(6)
    v_mfma_f32_32x32x16_bf16 v[42:57], v[74:77], v[164:167], v[42:57]
    ds_read_b64_tr_b16 v[94:95], v7 offset:45056
    ds_read_b64_tr_b16 v[96:97], v7 offset:46080
    v_fma_f32 v100, v100, s77, s77
    v_fma_f32 v101, v101, s77, s77
    v_rcp_f32 v100, v100
    v_mfma_f32_32x32x16_bf16 v[58:73], v[78:81], v[164:167], v[58:73]
    ds_read_b64_tr_b16 v[74:75], v6 offset:49152
    ds_read_b64_tr_b16 v[76:77], v6 offset:50176
    v_rcp_f32 v101, v101
    v_mul_f32 v100, v100, v36
    s_waitcnt lgkmcnt(6)
    v_mfma_f32_32x32x16_bf16 v[42:57], v[82:85], v[168:171], v[42:57]
    ds_read_b64_tr_b16 v[78:79], v7 offset:49152
    ds_read_b64_tr_b16 v[80:81], v7 offset:50176
    v_mul_f32 v101, v101, v37
    v_cvt_pk_bf16_f32 v111, v100, v101
    v_exp_f32 v102, -v30
    v_mfma_f32_32x32x16_bf16 v[58:73], v[86:89], v[168:171], v[58:73]
    ds_read_b64_tr_b16 v[82:83], v6 offset:53248
    ds_read_b64_tr_b16 v[84:85], v6 offset:54272
    v_exp_f32 v103, -v31
    v_fma_f32 v102, v102, s77, s77
    s_waitcnt lgkmcnt(6)
    v_mfma_f32_32x32x16_bf16 v[42:57], v[90:93], v[172:175], v[42:57]
    ds_read_b64_tr_b16 v[86:87], v7 offset:53248
    ds_read_b64_tr_b16 v[88:89], v7 offset:54272
    v_fma_f32 v103, v103, s77, s77
    v_rcp_f32 v102, v102
    v_mfma_f32_32x32x16_bf16 v[58:73], v[94:97], v[172:175], v[58:73]
    ds_read_b64_tr_b16 v[90:91], v6 offset:57344
    ds_read_b64_tr_b16 v[92:93], v6 offset:58368
    v_rcp_f32 v103, v103
    v_mul_f32 v102, v102, v38
    s_waitcnt lgkmcnt(6)
    v_mfma_f32_32x32x16_bf16 v[42:57], v[74:77], v[176:179], v[42:57]
    ds_read_b64_tr_b16 v[94:95], v7 offset:57344
    ds_read_b64_tr_b16 v[96:97], v7 offset:58368
    v_mul_f32 v103, v103, v39
    v_cvt_pk_bf16_f32 v112, v102, v103
    v_exp_f32 v104, -v32
    v_mfma_f32_32x32x16_bf16 v[58:73], v[78:81], v[176:179], v[58:73]
    ds_read_b64_tr_b16 v[74:75], v6 offset:61440
    ds_read_b64_tr_b16 v[76:77], v6 offset:62464
    v_exp_f32 v105, -v33
    v_fma_f32 v104, v104, s77, s77
    s_waitcnt lgkmcnt(6)
    v_mfma_f32_32x32x16_bf16 v[42:57], v[82:85], v[180:183], v[42:57]
    ds_read_b64_tr_b16 v[78:79], v7 offset:61440
    ds_read_b64_tr_b16 v[80:81], v7 offset:62464
    v_fma_f32 v105, v105, s77, s77
    v_rcp_f32 v104, v104
    v_mfma_f32_32x32x16_bf16 v[58:73], v[86:89], v[180:183], v[58:73]
    ds_read_b64_tr_b16 v[82:83], v8 offset:0
    ds_read_b64_tr_b16 v[84:85], v8 offset:1024
    v_rcp_f32 v105, v105
    v_mul_f32 v104, v104, v40
    s_waitcnt lgkmcnt(6)
    v_mfma_f32_32x32x16_bf16 v[42:57], v[90:93], v[184:187], v[42:57]
    ds_read_b64_tr_b16 v[86:87], v9 offset:0
    ds_read_b64_tr_b16 v[88:89], v9 offset:1024
    v_mul_f32 v105, v105, v41
    v_cvt_pk_bf16_f32 v113, v104, v105
    s_add_u32 s70, s78, 5120
    buffer_store_dwordx4 v[110:113], v0, s[32:35], s70 offen sc1
    v_mfma_f32_32x32x16_bf16 v[58:73], v[94:97], v[184:187], v[58:73]
    ds_read_b64_tr_b16 v[90:91], v8 offset:4096
    ds_read_b64_tr_b16 v[92:93], v8 offset:5120
    s_waitcnt lgkmcnt(6)
    v_mfma_f32_32x32x16_bf16 v[42:57], v[74:77], v[188:191], v[42:57]
    ds_read_b64_tr_b16 v[94:95], v9 offset:4096
    ds_read_b64_tr_b16 v[96:97], v9 offset:5120
    v_mfma_f32_32x32x16_bf16 v[58:73], v[78:81], v[188:191], v[58:73]
    ds_read_b64_tr_b16 v[74:75], v8 offset:8192
    ds_read_b64_tr_b16 v[76:77], v8 offset:9216
    s_waitcnt lgkmcnt(6)
    v_mfma_f32_32x32x16_bf16 v[42:57], v[82:85], v[192:195], v[42:57]
    ds_read_b64_tr_b16 v[78:79], v9 offset:8192
    ds_read_b64_tr_b16 v[80:81], v9 offset:9216
    v_mfma_f32_32x32x16_bf16 v[58:73], v[86:89], v[192:195], v[58:73]
    s_barrier
    ds_read_b64_tr_b16 v[82:83], v8 offset:12288
    ds_read_b64_tr_b16 v[84:85], v8 offset:13312
    s_waitcnt lgkmcnt(6)
    v_mfma_f32_32x32x16_bf16 v[42:57], v[90:93], v[196:199], v[42:57]
    ds_read_b64_tr_b16 v[86:87], v9 offset:12288
    ds_read_b64_tr_b16 v[88:89], v9 offset:13312
    v_mfma_f32_32x32x16_bf16 v[58:73], v[94:97], v[196:199], v[58:73]
    ds_read_b64_tr_b16 v[90:91], v8 offset:16384
    ds_read_b64_tr_b16 v[92:93], v8 offset:17408
    s_waitcnt lgkmcnt(6)
    v_mfma_f32_32x32x16_bf16 v[42:57], v[74:77], v[200:203], v[42:57]
    ds_read_b64_tr_b16 v[94:95], v9 offset:16384
    ds_read_b64_tr_b16 v[96:97], v9 offset:17408
    v_mfma_f32_32x32x16_bf16 v[58:73], v[78:81], v[200:203], v[58:73]
    ds_read_b64_tr_b16 v[74:75], v8 offset:20480
    ds_read_b64_tr_b16 v[76:77], v8 offset:21504
    s_mov_b64 exec, 0xfffffff
    buffer_load_dword v252, v253, s[32:35], 0 offen sc1
    s_mov_b64 exec, -1
    s_waitcnt lgkmcnt(6)
    v_mfma_f32_32x32x16_bf16 v[42:57], v[82:85], v[204:207], v[42:57]
    ds_read_b64_tr_b16 v[78:79], v9 offset:20480
    ds_read_b64_tr_b16 v[80:81], v9 offset:21504
    v_mfma_f32_32x32x16_bf16 v[58:73], v[86:89], v[204:207], v[58:73]
    ds_read_b64_tr_b16 v[82:83], v8 offset:24576
    ds_read_b64_tr_b16 v[84:85], v8 offset:25600
    s_waitcnt lgkmcnt(6)
    v_mfma_f32_32x32x16_bf16 v[42:57], v[90:93], v[208:211], v[42:57]
    ds_read_b64_tr_b16 v[86:87], v9 offset:24576
    ds_read_b64_tr_b16 v[88:89], v9 offset:25600
    v_mfma_f32_32x32x16_bf16 v[58:73], v[94:97], v[208:211], v[58:73]
    ds_read_b64_tr_b16 v[90:91], v4 offset:0
    ds_read_b64_tr_b16 v[92:93], v4 offset:1024
    s_waitcnt lgkmcnt(6)
    v_mfma_f32_32x32x16_bf16 v[42:57], v[74:77], v[212:215], v[42:57]
    ds_read_b64_tr_b16 v[94:95], v5 offset:0
    ds_read_b64_tr_b16 v[96:97], v5 offset:1024
    v_mfma_f32_32x32x16_bf16 v[58:73], v[78:81], v[212:215], v[58:73]
    ds_read_b64_tr_b16 v[74:75], v4 offset:4096
    ds_read_b64_tr_b16 v[76:77], v4 offset:5120
    s_waitcnt lgkmcnt(6)
    v_mfma_f32_32x32x16_bf16 v[42:57], v[82:85], v[216:219], v[42:57]
    ds_read_b64_tr_b16 v[78:79], v5 offset:4096
    ds_read_b64_tr_b16 v[80:81], v5 offset:5120
    v_mfma_f32_32x32x16_bf16 v[58:73], v[86:89], v[216:219], v[58:73]
    ds_read_b64_tr_b16 v[82:83], v4 offset:8192
    ds_read_b64_tr_b16 v[84:85], v4 offset:9216
    s_waitcnt lgkmcnt(6)
    v_mfma_f32_32x32x16_bf16 v[42:57], v[90:93], v[220:223], v[42:57]
    ds_read_b64_tr_b16 v[86:87], v5 offset:8192
    ds_read_b64_tr_b16 v[88:89], v5 offset:9216
    v_mfma_f32_32x32x16_bf16 v[58:73], v[94:97], v[220:223], v[58:73]
    ds_read_b64_tr_b16 v[90:91], v4 offset:12288
    ds_read_b64_tr_b16 v[92:93], v4 offset:13312
    s_waitcnt lgkmcnt(6)
    v_mfma_f32_32x32x16_bf16 v[42:57], v[74:77], v[224:227], v[42:57]
    ds_read_b64_tr_b16 v[94:95], v5 offset:12288
    ds_read_b64_tr_b16 v[96:97], v5 offset:13312
    v_mfma_f32_32x32x16_bf16 v[58:73], v[78:81], v[224:227], v[58:73]
    s_barrier
    ds_read_b64_tr_b16 v[74:75], v4 offset:16384
    ds_read_b64_tr_b16 v[76:77], v4 offset:17408
    s_waitcnt lgkmcnt(6)
    v_mfma_f32_32x32x16_bf16 v[42:57], v[82:85], v[228:231], v[42:57]
    ds_read_b64_tr_b16 v[78:79], v5 offset:16384
    ds_read_b64_tr_b16 v[80:81], v5 offset:17408
    v_mfma_f32_32x32x16_bf16 v[58:73], v[86:89], v[228:231], v[58:73]
    ds_read_b64_tr_b16 v[82:83], v4 offset:20480
    ds_read_b64_tr_b16 v[84:85], v4 offset:21504
    s_waitcnt lgkmcnt(6)
    v_mfma_f32_32x32x16_bf16 v[42:57], v[90:93], v[232:235], v[42:57]
    ds_read_b64_tr_b16 v[86:87], v5 offset:20480
    ds_read_b64_tr_b16 v[88:89], v5 offset:21504
    v_mfma_f32_32x32x16_bf16 v[58:73], v[94:97], v[232:235], v[58:73]
    s_waitcnt lgkmcnt(4)
    v_mfma_f32_32x32x16_bf16 v[42:57], v[74:77], v[236:239], v[42:57]
    v_mfma_f32_32x32x16_bf16 v[58:73], v[78:81], v[236:239], v[58:73]
    s_waitcnt lgkmcnt(0)
    v_mfma_f32_32x32x16_bf16 v[42:57], v[82:85], v[240:243], v[42:57]
    v_mfma_f32_32x32x16_bf16 v[58:73], v[86:89], v[240:243], v[58:73]
    v_mov_b32 v164, v115
    v_mov_b32 v165, v254
    v_add_u32 v166, 0x10000, v115
    v_add_u32 v167, 0x10000, v254
    v_add_u32 v168, 0x20000, v115
    v_add_u32 v169, 0x20000, v254

    s_waitcnt vmcnt(0)
    s_mov_b64 exec, 0xfffffff
    v_cmp_ne_u32 vcc, s49, v252
    s_cbranch_vccz L_f3_La_ok
    s_mov_b64 exec, -1
    s_mov_b32 s72, 0
    s_mov_b64 exec, 0xfffffff
L_f3_La:
    buffer_load_dword v252, v253, s[32:35], 0 offen sc1
    s_add_u32 s72, s72, 1
    s_waitcnt vmcnt(0)
    v_cmp_ne_u32 vcc, s49, v252
    s_cmp_gt_u32 s72, 0x100000
    s_cbranch_scc1 L_f3_La_out
    s_cbranch_vccnz L_f3_La
L_f3_La_out:
    s_mov_b64 exec, -1
L_f3_La_ok:
    s_mov_b64 exec, -1
    s_nop 3
    v_exp_f32 v98, -v42
    v_exp_f32 v99, -v43
    v_fma_f32 v98, v98, s77, s77
    v_fma_f32 v99, v99, s77, s77
    v_rcp_f32 v98, v98
    v_rcp_f32 v99, v99
    s_add_u32 s76, s75, 0
    buffer_load_dwordx4 v[116:119], v0, s[32:35], s76 offen sc1
    v_mul_f32 v98, v98, v50
    v_mul_f32 v99, v99, v51
    v_cvt_pk_bf16_f32 v106, v98, v99
    v_exp_f32 v100, -v44
    v_exp_f32 v101, -v45
    v_fma_f32 v100, v100, s77, s77
    s_add_u32 s76, s75, 8192
    buffer_load_dwordx4 v[120:123], v0, s[32:35], s76 offen sc1
    v_fma_f32 v101, v101, s77, s77
    v_rcp_f32 v100, v100
    v_rcp_f32 v101, v101
    v_mul_f32 v100, v100, v52
    v_mul_f32 v101, v101, v53
    v_cvt_pk_bf16_f32 v107, v100, v101
    s_add_u32 s76, s75, 16384
    buffer_load_dwordx4 v[124:127], v0, s[32:35], s76 offen sc1
    v_exp_f32 v102, -v46
    v_exp_f32 v103, -v47
    v_fma_f32 v102, v102, s77, s77
    v_fma_f32 v103, v103, s77, s77
    v_rcp_f32 v102, v102
    v_rcp_f32 v103, v103
    s_add_u32 s76, s75, 24576
    buffer_load_dwordx4 v[128:131], v0, s[32:35], s76 offen sc1
    v_mul_f32 v102, v102, v54
    v_mul_f32 v103, v103, v55
    v_cvt_pk_bf16_f32 v108, v102, v103
    v_exp_f32 v104, -v48
    v_exp_f32 v105, -v49
    v_fma_f32 v104, v104, s77, s77
    s_add_u32 s76, s75, 32768
    buffer_load_dwordx4 v[132:135], v0, s[32:35], s76 offen sc1
    v_fma_f32 v105, v105, s77, s77
    v_rcp_f32 v104, v104
    v_rcp_f32 v105, v105
    v_mul_f32 v104, v104, v56
    v_mul_f32 v105, v105, v57
    v_cvt_pk_bf16_f32 v109, v104, v105
    s_add_u32 s76, s75, 40960
    buffer_load_dwordx4 v[136:139], v0, s[32:35], s76 offen sc1
    s_add_u32 s70, s78, 6144
    buffer_store_dwordx4 v[106:109], v0, s[32:35], s70 offen sc1
    v_exp_f32 v98, -v58
    v_exp_f32 v99, -v59
    v_fma_f32 v98, v98, s77, s77
    v_fma_f32 v99, v99, s77, s77
    v_rcp_f32 v98, v98
    v_rcp_f32 v99, v99
    v_mul_f32 v98, v98, v66
    v_mul_f32 v99, v99, v67
    v_cvt_pk_bf16_f32 v110, v98, v99
    v_exp_f32 v100, -v60
    v_exp_f32 v101, -v61
    v_fma_f32 v100, v100, s77, s77
    v_fma_f32 v101, v101, s77, s77
    v_rcp_f32 v100, v100
    v_rcp_f32 v101, v101
    v_mul_f32 v100, v100, v68
    v_mul_f32 v101, v101, v69
    v_cvt_pk_bf16_f32 v111, v100, v101
    v_exp_f32 v102, -v62
    v_exp_f32 v103, -v63
    v_fma_f32 v102, v102, s77, s77
    v_fma_f32 v103, v103, s77, s77
    v_rcp_f32 v102, v102
    v_rcp_f32 v103, v103
    v_mul_f32 v102, v102, v70
    v_mul_f32 v103, v103, v71
    v_cvt_pk_bf16_f32 v112, v102, v103
    v_exp_f32 v104, -v64
    v_exp_f32 v105, -v65
    v_fma_f32 v104, v104, s77, s77
    v_fma_f32 v105, v105, s77, s77
    v_rcp_f32 v104, v104
    v_rcp_f32 v105, v105
    v_mul_f32 v104, v104, v72
    v_mul_f32 v105, v105, v73
    v_cvt_pk_bf16_f32 v113, v104, v105
    s_add_u32 s71, s73, 1024
    s_mov_b64 exec, 1
    buffer_store_dword v114, v0, s[32:35], s71 offen
    s_mov_b64 exec, -1
    s_add_u32 s70, s78, 7168
    buffer_store_dwordx4 v[110:113], v0, s[32:35], s70 offen sc1
    s_add_u32 s76, s75, 49152
    buffer_load_dwordx4 v[140:143], v0, s[32:35], s76 offen sc1
    s_add_u32 s76, s75, 57344
    buffer_load_dwordx4 v[144:147], v0, s[32:35], s76 offen sc1
    s_add_u32 s76, s75, 65536
    buffer_load_dwordx4 v[148:151], v0, s[32:35], s76 offen sc1
    s_add_u32 s76, s75, 73728
    buffer_load_dwordx4 v[152:155], v0, s[32:35], s76 offen sc1
    s_add_u32 s76, s75, 81920
    buffer_load_dwordx4 v[156:159], v0, s[32:35], s76 offen sc1
    s_branch L_c_p4_L
L_c_idle_L:
    s_barrier
    v_mov_b32 v164, v115
    v_mov_b32 v165, v254
    v_add_u32 v166, 0x10000, v115
    v_add_u32 v167, 0x10000, v254
    v_add_u32 v168, 0x20000, v115
    v_add_u32 v169, 0x20000, v254

    s_mov_b32 s72, 0
    s_mov_b64 exec, 0xfffffff
L_f3_Li:
    buffer_load_dword v252, v253, s[32:35], 0 offen sc1
    s_add_u32 s72, s72, 1
    s_waitcnt vmcnt(0)
    v_cmp_ne_u32 vcc, s49, v252
    s_cmp_gt_u32 s72, 0x100000
    s_cbranch_scc1 L_f3_Li_out
    s_cbranch_vccnz L_f3_Li
L_f3_Li_out:
    s_mov_b64 exec, -1
    s_add_u32 s76, s75, 0
    buffer_load_dwordx4 v[116:119], v0, s[32:35], s76 offen sc1
    s_add_u32 s76, s75, 8192
    buffer_load_dwordx4 v[120:123], v0, s[32:35], s76 offen sc1
    s_add_u32 s76, s75, 16384
    buffer_load_dwordx4 v[124:127], v0, s[32:35], s76 offen sc1
    s_add_u32 s76, s75, 24576
    buffer_load_dwordx4 v[128:131], v0, s[32:35], s76 offen sc1
    s_add_u32 s76, s75, 32768
    buffer_load_dwordx4 v[132:135], v0, s[32:35], s76 offen sc1
    s_add_u32 s76, s75, 40960
    buffer_load_dwordx4 v[136:139], v0, s[32:35], s76 offen sc1
    buffer_load_dword v252, v253, s[32:35], 0 offen sc1
    s_add_u32 s76, s75, 49152
    buffer_load_dwordx4 v[140:143], v0, s[32:35], s76 offen sc1
    s_add_u32 s76, s75, 57344
    buffer_load_dwordx4 v[144:147], v0, s[32:35], s76 offen sc1
    s_add_u32 s76, s75, 65536
    buffer_load_dwordx4 v[148:151], v0, s[32:35], s76 offen sc1
    s_add_u32 s76, s75, 73728
    buffer_load_dwordx4 v[152:155], v0, s[32:35], s76 offen sc1
    s_add_u32 s76, s75, 81920
    buffer_load_dwordx4 v[156:159], v0, s[32:35], s76 offen sc1
L_c_p4_L:
    s_barrier
    ds_read_b64_tr_b16 v[74:75], v164 offset:24576
    ds_read_b64_tr_b16 v[76:77], v164 offset:25600
    ds_read_b64_tr_b16 v[78:79], v165 offset:24576
    ds_read_b64_tr_b16 v[80:81], v165 offset:25600
    ds_read_b64_tr_b16 v[82:83], v164 offset:28672
    ds_read_b64_tr_b16 v[84:85], v164 offset:29696
    ds_read_b64_tr_b16 v[86:87], v165 offset:28672
    ds_read_b64_tr_b16 v[88:89], v165 offset:29696
    s_add_u32 s76, s75, 90112
    buffer_load_dwordx4 v[160:163], v0, s[32:35], s76 offen sc1
    s_waitcnt vmcnt(12)
    s_waitcnt lgkmcnt(4)
    v_mfma_f32_32x32x16_bf16 v[4:19], v[74:77], v[116:119], 0
    v_mfma_f32_32x32x16_bf16 v[20:35], v[78:81], v[116:119], 0
    ds_read_b64_tr_b16 v[90:91], v164 offset:32768
    ds_read_b64_tr_b16 v[92:93], v164 offset:33792
    ds_read_b64_tr_b16 v[94:95], v165 offset:32768
    ds_read_b64_tr_b16 v[96:97], v165 offset:33792
    s_add_u32 s76, s75, 98304
    buffer_load_dwordx4 v[116:119], v0, s[32:35], s76 offen sc1
    s_waitcnt vmcnt(12)
    s_waitcnt lgkmcnt(4)
    v_mfma_f32_32x32x16_bf16 v[4:19], v[82:85], v[120:123], v[4:19]
    v_mfma_f32_32x32x16_bf16 v[20:35], v[86:89], v[120:123], v[20:35]
    ds_read_b64_tr_b16 v[74:75], v164 offset:36864
    ds_read_b64_tr_b16 v[76:77], v164 offset:37888
    ds_read_b64_tr_b16 v[78:79], v165 offset:36864
    ds_read_b64_tr_b16 v[80:81], v165 offset:37888
    s_add_u32 s76, s75, 106496
    buffer_load_dwordx4 v[120:123], v0, s[32:35], s76 offen sc1
    s_waitcnt vmcnt(12)
    s_waitcnt lgkmcnt(4)
    v_mfma_f32_32x32x16_bf16 v[4:19], v[90:93], v[124:127], v[4:19]
    v_mfma_f32_32x32x16_bf16 v[20:35], v[94:97], v[124:127], v[20:35]
    ds_read_b64_tr_b16 v[82:83], v164 offset:40960
    ds_read_b64_tr_b16 v[84:85], v164 offset:41984
    ds_read_b64_tr_b16 v[86:87], v165 offset:40960
    ds_read_b64_tr_b16 v[88:89], v165 offset:41984
    s_add_u32 s76, s75, 2048
    buffer_load_dwordx4 v[124:127], v0, s[32:35], s76 offen sc1
    s_waitcnt vmcnt(12)
    s_waitcnt lgkmcnt(4)
    v_mfma_f32_32x32x16_bf16 v[4:19], v[74:77], v[128:131], v[4:19]
    v_mfma_f32_32x32x16_bf16 v[20:35], v[78:81], v[128:131], v[20:35]
    ds_read_b64_tr_b16 v[90:91], v164 offset:45056
    ds_read_b64_tr_b16 v[92:93], v164 offset:46080
    ds_read_b64_tr_b16 v[94:95], v165 offset:45056
    ds_read_b64_tr_b16 v[96:97], v165 offset:46080
    s_add_u32 s76, s75, 10240
    buffer_load_dwordx4 v[128:131], v0, s[32:35], s76 offen sc1
    s_waitcnt vmcnt(12)
    s_waitcnt lgkmcnt(4)
    v_mfma_f32_32x32x16_bf16 v[4:19], v[82:85], v[132:135], v[4:19]
    v_mfma_f32_32x32x16_bf16 v[20:35], v[86:89], v[132:135], v[20:35]
    ds_read_b64_tr_b16 v[74:75], v164 offset:49152
    ds_read_b64_tr_b16 v[76:77], v164 offset:50176
    ds_read_b64_tr_b16 v[78:79], v165 offset:49152
    ds_read_b64_tr_b16 v[80:81], v165 offset:50176
    s_add_u32 s76, s75, 18432
    buffer_load_dwordx4 v[132:135], v0, s[32:35], s76 offen sc1
    s_waitcnt vmcnt(12)
    s_waitcnt lgkmcnt(4)
    v_mfma_f32_32x32x16_bf16 v[4:19], v[90:93], v[136:139], v[4:19]
    v_mfma_f32_32x32x16_bf16 v[20:35], v[94:97], v[136:139], v[20:35]
    v_lshlrev_b32 v99, 4, v1
    v_add_u32 v253, s74, v99
    s_mov_b64 exec, 0x3fff
    buffer_load_dword v252, v253, s[32:35], 0 offen offset:1024 sc1
    s_mov_b64 exec, -1
    ds_read_b64_tr_b16 v[82:83], v164 offset:53248
    ds_read_b64_tr_b16 v[84:85], v164 offset:54272
    ds_read_b64_tr_b16 v[86:87], v165 offset:53248
    ds_read_b64_tr_b16 v[88:89], v165 offset:54272
    s_add_u32 s76, s75, 26624
    buffer_load_dwordx4 v[136:139], v0, s[32:35], s76 offen sc1
    s_waitcnt vmcnt(12)
    s_add_u32 s71, s73, 1536
    v_mov_b32 v114, s49
    s_mov_b64 exec, 1
    buffer_store_dword v114, v0, s[32:35], s71 offen
    s_mov_b64 exec, -1
    s_waitcnt lgkmcnt(4)
    v_mfma_f32_32x32x16_bf16 v[4:19], v[74:77], v[140:143], v[4:19]
    v_mfma_f32_32x32x16_bf16 v[20:35], v[78:81], v[140:143], v[20:35]
    ds_read_b64_tr_b16 v[90:91], v164 offset:57344
    ds_read_b64_tr_b16 v[92:93], v164 offset:58368
    ds_read_b64_tr_b16 v[94:95], v165 offset:57344
    ds_read_b64_tr_b16 v[96:97], v165 offset:58368
    s_add_u32 s76, s75, 34816
    buffer_load_dwordx4 v[140:143], v0, s[32:35], s76 offen sc1
    s_waitcnt vmcnt(13)
    s_waitcnt lgkmcnt(4)
    v_mfma_f32_32x32x16_bf16 v[4:19], v[82:85], v[144:147], v[4:19]
    v_mfma_f32_32x32x16_bf16 v[20:35], v[86:89], v[144:147], v[20:35]
    s_waitcnt lgkmcnt(0)
    s_barrier
    ds_read_b64_tr_b16 v[74:75], v164 offset:61440
    ds_read_b64_tr_b16 v[76:77], v164 offset:62464
    ds_read_b64_tr_b16 v[78:79], v165 offset:61440
    ds_read_b64_tr_b16 v[80:81], v165 offset:62464
    s_add_u32 s76, s75, 43008
    buffer_load_dwordx4 v[144:147], v0, s[32:35], s76 offen sc1
    s_waitcnt vmcnt(13)
    s_waitcnt lgkmcnt(4)
    v_mfma_f32_32x32x16_bf16 v[4:19], v[90:93], v[148:151], v[4:19]
    v_mfma_f32_32x32x16_bf16 v[20:35], v[94:97], v[148:151], v[20:35]
    ds_read_b64_tr_b16 v[82:83], v166 offset:0
    ds_read_b64_tr_b16 v[84:85], v166 offset:1024
    ds_read_b64_tr_b16 v[86:87], v167 offset:0
    ds_read_b64_tr_b16 v[88:89], v167 offset:1024
    s_add_u32 s76, s75, 51200
    buffer_load_dwordx4 v[148:151], v0, s[32:35], s76 offen sc1
    s_waitcnt vmcnt(13)
    s_waitcnt lgkmcnt(4)
    v_mfma_f32_32x32x16_bf16 v[4:19], v[74:77], v[152:155], v[4:19]
    v_mfma_f32_32x32x16_bf16 v[20:35], v[78:81], v[152:155], v[20:35]
    ds_read_b64_tr_b16 v[90:91], v166 offset:4096
    ds_read_b64_tr_b16 v[92:93], v166 offset:5120
    ds_read_b64_tr_b16 v[94:95], v167 offset:4096
    ds_read_b64_tr_b16 v[96:97], v167 offset:5120
    s_add_u32 s76, s75, 59392
    buffer_load_dwordx4 v[152:155], v0, s[32:35], s76 offen sc1
    s_waitcnt vmcnt(13)
    s_waitcnt lgkmcnt(4)
    v_mfma_f32_32x32x16_bf16 v[4:19], v[82:85], v[156:159], v[4:19]
    v_mfma_f32_32x32x16_bf16 v[20:35], v[86:89], v[156:159], v[20:35]
    ds_read_b64_tr_b16 v[74:75], v166 offset:8192
    ds_read_b64_tr_b16 v[76:77], v166 offset:9216
    ds_read_b64_tr_b16 v[78:79], v167 offset:8192
    ds_read_b64_tr_b16 v[80:81], v167 offset:9216
    s_add_u32 s76, s75, 67584
    buffer_load_dwordx4 v[156:159], v0, s[32:35], s76 offen sc1
    s_waitcnt vmcnt(13)
    s_waitcnt lgkmcnt(4)
    v_mfma_f32_32x32x16_bf16 v[4:19], v[90:93], v[160:163], v[4:19]
    v_mfma_f32_32x32x16_bf16 v[20:35], v[94:97], v[160:163], v[20:35]
    ds_read_b64_tr_b16 v[82:83], v166 offset:12288
    ds_read_b64_tr_b16 v[84:85], v166 offset:13312
    ds_read_b64_tr_b16 v[86:87], v167 offset:12288
    ds_read_b64_tr_b16 v[88:89], v167 offset:13312
    s_add_u32 s76, s75, 75776
    buffer_load_dwordx4 v[160:163], v0, s[32:35], s76 offen sc1
    s_waitcnt vmcnt(13)
    s_waitcnt lgkmcnt(4)
    v_mfma_f32_32x32x16_bf16 v[4:19], v[74:77], v[116:119], v[4:19]
    v_mfma_f32_32x32x16_bf16 v[20:35], v[78:81], v[116:119], v[20:35]
    ds_read_b64_tr_b16 v[90:91], v166 offset:16384
    ds_read_b64_tr_b16 v[92:93], v166 offset:17408
    ds_read_b64_tr_b16 v[94:95], v167 offset:16384
    ds_read_b64_tr_b16 v[96:97], v167 offset:17408
    s_add_u32 s76, s75, 83968
    buffer_load_dwordx4 v[116:119], v0, s[32:35], s76 offen sc1
    s_waitcnt vmcnt(13)
    s_waitcnt lgkmcnt(4)
    v_mfma_f32_32x32x16_bf16 v[4:19], v[82:85], v[120:123], v[4:19]
    v_mfma_f32_32x32x16_bf16 v[20:35], v[86:89], v[120:123], v[20:35]
    ds_read_b64_tr_b16 v[74:75], v166 offset:20480
    ds_read_b64_tr_b16 v[76:77], v166 offset:21504
    ds_read_b64_tr_b16 v[78:79], v167 offset:20480
    ds_read_b64_tr_b16 v[80:81], v167 offset:21504
    s_add_u32 s76, s75, 92160
    buffer_load_dwordx4 v[120:123], v0, s[32:35], s76 offen sc1
    s_waitcnt vmcnt(13)
    s_waitcnt lgkmcnt(4)
    v_mfma_f32_32x32x16_bf16 v[4:19], v[90:93], v[124:127], v[4:19]
    v_mfma_f32_32x32x16_bf16 v[20:35], v[94:97], v[124:127], v[20:35]
    ds_read_b64_tr_b16 v[82:83], v166 offset:24576
    ds_read_b64_tr_b16 v[84:85], v166 offset:25600
    ds_read_b64_tr_b16 v[86:87], v167 offset:24576
    ds_read_b64_tr_b16 v[88:89], v167 offset:25600
    s_add_u32 s76, s75, 100352
    buffer_load_dwordx4 v[124:127], v0, s[32:35], s76 offen sc1
    s_waitcnt vmcnt(13)
    s_waitcnt lgkmcnt(4)
    v_mfma_f32_32x32x16_bf16 v[4:19], v[74:77], v[128:131], v[4:19]
    v_mfma_f32_32x32x16_bf16 v[20:35], v[78:81], v[128:131], v[20:35]
    s_waitcnt lgkmcnt(0)
    s_barrier
    s_waitcnt vmcnt(11)
    s_mov_b64 exec, 0x3fff
    v_cmp_ne_u32 vcc, s49, v252
    s_cbranch_vccz L_f3b2_L_ok
    v_add_u32 v253, 1024, v253
    s_mov_b64 exec, -1
    s_mov_b32 s72, 0
    s_mov_b64 exec, 0x3fff
L_f3b2_L:
    buffer_load_dword v252, v253, s[32:35], 0 offen sc1
    s_add_u32 s72, s72, 1
    s_waitcnt vmcnt(0)
    v_cmp_ne_u32 vcc, s49, v252
    s_cmp_gt_u32 s72, 0x100000
    s_cbranch_scc1 L_f3b2_L_out
    s_cbranch_vccnz L_f3b2_L
L_f3b2_L_out:
    s_mov_b64 exec, -1
L_f3b2_L_ok:
    s_mov_b64 exec, -1
    ds_read_b64_tr_b16 v[90:91], v166 offset:28672
    ds_read_b64_tr_b16 v[92:93], v166 offset:29696
    ds_read_b64_tr_b16 v[94:95], v167 offset:28672
    ds_read_b64_tr_b16 v[96:97], v167 offset:29696
    s_add_u32 s76, s75, 108544
    buffer_load_dwordx4 v[128:131], v0, s[32:35], s76 offen sc1
    s_waitcnt lgkmcnt(4)
    v_mfma_f32_32x32x16_bf16 v[4:19], v[82:85], v[132:135], v[4:19]
    v_mfma_f32_32x32x16_bf16 v[20:35], v[86:89], v[132:135], v[20:35]
    ds_read_b64_tr_b16 v[74:75], v166 offset:32768
    ds_read_b64_tr_b16 v[76:77], v166 offset:33792
    ds_read_b64_tr_b16 v[78:79], v167 offset:32768
    ds_read_b64_tr_b16 v[80:81], v167 offset:33792
    s_add_u32 s76, s75, 4096
    buffer_load_dwordx4 v[132:135], v0, s[32:35], s76 offen sc1
    s_waitcnt vmcnt(12)
    s_waitcnt lgkmcnt(4)
    v_mfma_f32_32x32x16_bf16 v[4:19], v[90:93], v[136:139], v[4:19]
    v_mfma_f32_32x32x16_bf16 v[20:35], v[94:97], v[136:139], v[20:35]
    ds_read_b64_tr_b16 v[82:83], v166 offset:36864
    ds_read_b64_tr_b16 v[84:85], v166 offset:37888
    ds_read_b64_tr_b16 v[86:87], v167 offset:36864
    ds_read_b64_tr_b16 v[88:89], v167 offset:37888
    s_add_u32 s76, s75, 12288
    buffer_load_dwordx4 v[136:139], v0, s[32:35], s76 offen sc1
    s_waitcnt vmcnt(11)
    s_waitcnt lgkmcnt(4)
    v_mfma_f32_32x32x16_bf16 v[4:19], v[74:77], v[140:143], v[4:19]
    v_mfma_f32_32x32x16_bf16 v[20:35], v[78:81], v[140:143], v[20:35]
    ds_read_b64_tr_b16 v[90:91], v166 offset:40960
    ds_read_b64_tr_b16 v[92:93], v166 offset:41984
    ds_read_b64_tr_b16 v[94:95], v167 offset:40960
    ds_read_b64_tr_b16 v[96:97], v167 offset:41984
    s_add_u32 s76, s75, 20480
    buffer_load_dwordx4 v[140:143], v0, s[32:35], s76 offen sc1
    s_waitcnt vmcnt(11)
    s_waitcnt lgkmcnt(4)
    v_mfma_f32_32x32x16_bf16 v[4:19], v[82:85], v[144:147], v[4:19]
    v_mfma_f32_32x32x16_bf16 v[20:35], v[86:89], v[144:147], v[20:35]
    v_lshlrev_b32 v99, 4, v1
    v_add_u32 v253, s74, v99
    s_mov_b64 exec, 0x3fff
    buffer_load_dword v252, v253, s[32:35], 0 offen offset:1536 sc1
    s_mov_b64 exec, -1
    ds_read_b64_tr_b16 v[74:75], v166 offset:45056
    ds_read_b64_tr_b16 v[76:77], v166 offset:46080
    ds_read_b64_tr_b16 v[78:79], v167 offset:45056
    ds_read_b64_tr_b16 v[80:81], v167 offset:46080
    s_add_u32 s76, s75, 28672
    buffer_load_dwordx4 v[144:147], v0, s[32:35], s76 offen sc1
    s_waitcnt vmcnt(12)
    s_waitcnt lgkmcnt(4)
    v_mfma_f32_32x32x16_bf16 v[4:19], v[90:93], v[148:151], v[4:19]
    v_mfma_f32_32x32x16_bf16 v[20:35], v[94:97], v[148:151], v[20:35]
    ds_read_b64_tr_b16 v[82:83], v166 offset:49152
    ds_read_b64_tr_b16 v[84:85], v166 offset:50176
    ds_read_b64_tr_b16 v[86:87], v167 offset:49152
    ds_read_b64_tr_b16 v[88:89], v167 offset:50176
    s_add_u32 s76, s75, 36864
    buffer_load_dwordx4 v[148:151], v0, s[32:35], s76 offen sc1
    s_waitcnt vmcnt(12)
    s_waitcnt lgkmcnt(4)
    v_mfma_f32_32x32x16_bf16 v[4:19], v[74:77], v[152:155], v[4:19]
    v_mfma_f32_32x32x16_bf16 v[20:35], v[78:81], v[152:155], v[20:35]
    ds_read_b64_tr_b16 v[90:91], v166 offset:53248
    ds_read_b64_tr_b16 v[92:93], v166 offset:54272
    ds_read_b64_tr_b16 v[94:95], v167 offset:53248
    ds_read_b64_tr_b16 v[96:97], v167 offset:54272
    s_add_u32 s76, s75, 45056
    buffer_load_dwordx4 v[152:155], v0, s[32:35], s76 offen sc1
    s_waitcnt vmcnt(12)
    s_waitcnt lgkmcnt(4)
    v_mfma_f32_32x32x16_bf16 v[4:19], v[82:85], v[156:159], v[4:19]
    v_mfma_f32_32x32x16_bf16 v[20:35], v[86:89], v[156:159], v[20:35]
    ds_read_b64_tr_b16 v[74:75], v166 offset:57344
    ds_read_b64_tr_b16 v[76:77], v166 offset:58368
    ds_read_b64_tr_b16 v[78:79], v167 offset:57344
    ds_read_b64_tr_b16 v[80:81], v167 offset:58368
    s_add_u32 s76, s75, 53248
    buffer_load_dwordx4 v[156:159], v0, s[32:35], s76 offen sc1
    s_waitcnt vmcnt(12)
    s_waitcnt lgkmcnt(4)
    v_mfma_f32_32x32x16_bf16 v[4:19], v[90:93], v[160:163], v[4:19]
    v_mfma_f32_32x32x16_bf16 v[20:35], v[94:97], v[160:163], v[20:35]
    s_waitcnt lgkmcnt(0)
    s_barrier
    ds_read_b64_tr_b16 v[82:83], v166 offset:61440
    ds_read_b64_tr_b16 v[84:85], v166 offset:62464
    ds_read_b64_tr_b16 v[86:87], v167 offset:61440
    ds_read_b64_tr_b16 v[88:89], v167 offset:62464
    s_add_u32 s76, s75, 61440
    buffer_load_dwordx4 v[160:163], v0, s[32:35], s76 offen sc1
    s_waitcnt vmcnt(12)
    s_waitcnt lgkmcnt(4)
    v_mfma_f32_32x32x16_bf16 v[4:19], v[74:77], v[116:119], v[4:19]
    v_mfma_f32_32x32x16_bf16 v[20:35], v[78:81], v[116:119], v[20:35]
    ds_read_b64_tr_b16 v[90:91], v168 offset:0
    ds_read_b64_tr_b16 v[92:93], v168 offset:1024
    ds_read_b64_tr_b16 v[94:95], v169 offset:0
    ds_read_b64_tr_b16 v[96:97], v169 offset:1024
    s_add_u32 s76, s75, 69632
    buffer_load_dwordx4 v[116:119], v0, s[32:35], s76 offen sc1
    s_waitcnt vmcnt(12)
    s_waitcnt lgkmcnt(4)
    v_mfma_f32_32x32x16_bf16 v[4:19], v[82:85], v[120:123], v[4:19]
    v_mfma_f32_32x32x16_bf16 v[20:35], v[86:89], v[120:123], v[20:35]
    ds_read_b64_tr_b16 v[74:75], v168 offset:4096
    ds_read_b64_tr_b16 v[76:77], v168 offset:5120
    ds_read_b64_tr_b16 v[78:79], v169 offset:4096
    ds_read_b64_tr_b16 v[80:81], v169 offset:5120
    s_add_u32 s76, s75, 77824
    buffer_load_dwordx4 v[120:123], v0, s[32:35], s76 offen sc1
    s_waitcnt vmcnt(12)
    s_waitcnt lgkmcnt(4)
    v_mfma_f32_32x32x16_bf16 v[4:19], v[90:93], v[124:127], v[4:19]
    v_mfma_f32_32x32x16_bf16 v[20:35], v[94:97], v[124:127], v[20:35]
    ds_read_b64_tr_b16 v[82:83], v168 offset:8192
    ds_read_b64_tr_b16 v[84:85], v168 offset:9216
    ds_read_b64_tr_b16 v[86:87], v169 offset:8192
    ds_read_b64_tr_b16 v[88:89], v169 offset:9216
    s_add_u32 s76, s75, 86016
    buffer_load_dwordx4 v[124:127], v0, s[32:35], s76 offen sc1
    s_waitcnt vmcnt(12)
    s_waitcnt lgkmcnt(4)
    v_mfma_f32_32x32x16_bf16 v[4:19], v[74:77], v[128:131], v[4:19]
    v_mfma_f32_32x32x16_bf16 v[20:35], v[78:81], v[128:131], v[20:35]
    ds_read_b64_tr_b16 v[90:91], v168 offset:12288
    ds_read_b64_tr_b16 v[92:93], v168 offset:13312
    ds_read_b64_tr_b16 v[94:95], v169 offset:12288
    ds_read_b64_tr_b16 v[96:97], v169 offset:13312
    s_add_u32 s76, s75, 94208
    buffer_load_dwordx4 v[128:131], v0, s[32:35], s76 offen sc1
    s_waitcnt vmcnt(12)
    s_waitcnt lgkmcnt(4)
    v_mfma_f32_32x32x16_bf16 v[4:19], v[82:85], v[132:135], v[4:19]
    v_mfma_f32_32x32x16_bf16 v[20:35], v[86:89], v[132:135], v[20:35]
    ds_read_b64_tr_b16 v[74:75], v168 offset:16384
    ds_read_b64_tr_b16 v[76:77], v168 offset:17408
    ds_read_b64_tr_b16 v[78:79], v169 offset:16384
    ds_read_b64_tr_b16 v[80:81], v169 offset:17408
    s_add_u32 s76, s75, 102400
    buffer_load_dwordx4 v[132:135], v0, s[32:35], s76 offen sc1
    s_waitcnt vmcnt(12)
    s_waitcnt lgkmcnt(4)
    v_mfma_f32_32x32x16_bf16 v[4:19], v[90:93], v[136:139], v[4:19]
    v_mfma_f32_32x32x16_bf16 v[20:35], v[94:97], v[136:139], v[20:35]
    s_waitcnt vmcnt(10)
    s_mov_b64 exec, 0x3fff
    v_cmp_ne_u32 vcc, s49, v252
    s_cbranch_vccz L_f3b3_L_ok
    v_add_u32 v253, 1536, v253
    s_mov_b64 exec, -1
    s_mov_b32 s72, 0
    s_mov_b64 exec, 0x3fff
L_f3b3_L:
    buffer_load_dword v252, v253, s[32:35], 0 offen sc1
    s_add_u32 s72, s72, 1
    s_waitcnt vmcnt(0)
    v_cmp_ne_u32 vcc, s49, v252
    s_cmp_gt_u32 s72, 0x100000
    s_cbranch_scc1 L_f3b3_L_out
    s_cbranch_vccnz L_f3b3_L
L_f3b3_L_out:
    s_mov_b64 exec, -1
L_f3b3_L_ok:
    s_mov_b64 exec, -1
    ds_read_b64_tr_b16 v[82:83], v168 offset:20480
    ds_read_b64_tr_b16 v[84:85], v168 offset:21504
    ds_read_b64_tr_b16 v[86:87], v169 offset:20480
    ds_read_b64_tr_b16 v[88:89], v169 offset:21504
    s_add_u32 s76, s75, 110592
    buffer_load_dwordx4 v[136:139], v0, s[32:35], s76 offen sc1
    s_waitcnt lgkmcnt(4)
    v_mfma_f32_32x32x16_bf16 v[4:19], v[74:77], v[140:143], v[4:19]
    v_mfma_f32_32x32x16_bf16 v[20:35], v[78:81], v[140:143], v[20:35]
    ds_read_b64_tr_b16 v[90:91], v168 offset:24576
    ds_read_b64_tr_b16 v[92:93], v168 offset:25600
    ds_read_b64_tr_b16 v[94:95], v169 offset:24576
    ds_read_b64_tr_b16 v[96:97], v169 offset:25600
    s_add_u32 s76, s75, 6144
    buffer_load_dwordx4 v[140:143], v0, s[32:35], s76 offen sc1
    s_waitcnt vmcnt(11)
    s_waitcnt lgkmcnt(4)
    v_mfma_f32_32x32x16_bf16 v[4:19], v[82:85], v[144:147], v[4:19]
    v_mfma_f32_32x32x16_bf16 v[20:35], v[86:89], v[144:147], v[20:35]
    s_waitcnt lgkmcnt(0)
    s_barrier
    ds_read_b64_tr_b16 v[74:75], v164 offset:0
    ds_read_b64_tr_b16 v[76:77], v164 offset:1024
    ds_read_b64_tr_b16 v[78:79], v165 offset:0
    ds_read_b64_tr_b16 v[80:81], v165 offset:1024
    s_add_u32 s76, s75, 14336
    buffer_load_dwordx4 v[144:147], v0, s[32:35], s76 offen sc1
    s_waitcnt vmcnt(11)
    s_waitcnt lgkmcnt(4)
    v_mfma_f32_32x32x16_bf16 v[4:19], v[90:93], v[148:151], v[4:19]
    v_mfma_f32_32x32x16_bf16 v[20:35], v[94:97], v[148:151], v[20:35]
    ds_read_b64_tr_b16 v[82:83], v164 offset:4096
    ds_read_b64_tr_b16 v[84:85], v164 offset:5120
    ds_read_b64_tr_b16 v[86:87], v165 offset:4096
    ds_read_b64_tr_b16 v[88:89], v165 offset:5120
    s_add_u32 s76, s75, 22528
    buffer_load_dwordx4 v[148:151], v0, s[32:35], s76 offen sc1
    s_waitcnt vmcnt(11)
    s_waitcnt lgkmcnt(4)
    v_mfma_f32_32x32x16_bf16 v[4:19], v[74:77], v[152:155], v[4:19]
    v_mfma_f32_32x32x16_bf16 v[20:35], v[78:81], v[152:155], v[20:35]
    ds_read_b64_tr_b16 v[90:91], v164 offset:8192
    ds_read_b64_tr_b16 v[92:93], v164 offset:9216
    ds_read_b64_tr_b16 v[94:95], v165 offset:8192
    ds_read_b64_tr_b16 v[96:97], v165 offset:9216
    s_add_u32 s76, s75, 30720
    buffer_load_dwordx4 v[152:155], v0, s[32:35], s76 offen sc1
    s_waitcnt vmcnt(11)
    s_waitcnt lgkmcnt(4)
    v_mfma_f32_32x32x16_bf16 v[4:19], v[82:85], v[156:159], v[4:19]
    v_mfma_f32_32x32x16_bf16 v[20:35], v[86:89], v[156:159], v[20:35]
    ds_read_b64_tr_b16 v[74:75], v164 offset:12288
    ds_read_b64_tr_b16 v[76:77], v164 offset:13312
    ds_read_b64_tr_b16 v[78:79], v165 offset:12288
    ds_read_b64_tr_b16 v[80:81], v165 offset:13312
    s_add_u32 s76, s75, 38912
    buffer_load_dwordx4 v[156:159], v0, s[32:35], s76 offen sc1
    s_waitcnt vmcnt(11)
    s_waitcnt lgkmcnt(4)
    v_mfma_f32_32x32x16_bf16 v[4:19], v[90:93], v[160:163], v[4:19]
    v_mfma_f32_32x32x16_bf16 v[20:35], v[94:97], v[160:163], v[20:35]
    ds_read_b64_tr_b16 v[82:83], v164 offset:16384
    ds_read_b64_tr_b16 v[84:85], v164 offset:17408
    ds_read_b64_tr_b16 v[86:87], v165 offset:16384
    ds_read_b64_tr_b16 v[88:89], v165 offset:17408
    s_add_u32 s76, s75, 47104
    buffer_load_dwordx4 v[160:163], v0, s[32:35], s76 offen sc1
    s_waitcnt vmcnt(11)
    s_waitcnt lgkmcnt(4)
    v_mfma_f32_32x32x16_bf16 v[4:19], v[74:77], v[116:119], v[4:19]
    v_mfma_f32_32x32x16_bf16 v[20:35], v[78:81], v[116:119], v[20:35]
    ds_read_b64_tr_b16 v[90:91], v164 offset:20480
    ds_read_b64_tr_b16 v[92:93], v164 offset:21504
    ds_read_b64_tr_b16 v[94:95], v165 offset:20480
    ds_read_b64_tr_b16 v[96:97], v165 offset:21504
    s_add_u32 s76, s75, 55296
    buffer_load_dwordx4 v[116:119], v0, s[32:35], s76 offen sc1
    s_waitcnt vmcnt(11)
    s_waitcnt lgkmcnt(4)
    v_mfma_f32_32x32x16_bf16 v[4:19], v[82:85], v[120:123], v[4:19]
    v_mfma_f32_32x32x16_bf16 v[20:35], v[86:89], v[120:123], v[20:35]
    ds_read_b64_tr_b16 v[74:75], v164 offset:24576
    ds_read_b64_tr_b16 v[76:77], v164 offset:25600
    ds_read_b64_tr_b16 v[78:79], v165 offset:24576
    ds_read_b64_tr_b16 v[80:81], v165 offset:25600
    s_add_u32 s76, s75, 63488
    buffer_load_dwordx4 v[120:123], v0, s[32:35], s76 offen sc1
    s_waitcnt vmcnt(11)
    s_waitcnt lgkmcnt(4)
    v_mfma_f32_32x32x16_bf16 v[4:19], v[90:93], v[124:127], v[4:19]
    v_mfma_f32_32x32x16_bf16 v[20:35], v[94:97], v[124:127], v[20:35]
    ds_read_b64_tr_b16 v[82:83], v164 offset:28672
    ds_read_b64_tr_b16 v[84:85], v164 offset:29696
    ds_read_b64_tr_b16 v[86:87], v165 offset:28672
    ds_read_b64_tr_b16 v[88:89], v165 offset:29696
    s_add_u32 s76, s75, 71680
    buffer_load_dwordx4 v[124:127], v0, s[32:35], s76 offen sc1
    s_waitcnt vmcnt(11)
    s_waitcnt lgkmcnt(4)
    v_mfma_f32_32x32x16_bf16 v[4:19], v[74:77], v[128:131], v[4:19]
    v_mfma_f32_32x32x16_bf16 v[20:35], v[78:81], v[128:131], v[20:35]
    s_waitcnt lgkmcnt(0)
    s_barrier
    ds_read_b64_tr_b16 v[90:91], v164 offset:32768
    ds_read_b64_tr_b16 v[92:93], v164 offset:33792
    ds_read_b64_tr_b16 v[94:95], v165 offset:32768
    ds_read_b64_tr_b16 v[96:97], v165 offset:33792
    s_add_u32 s76, s75, 79872
    buffer_load_dwordx4 v[128:131], v0, s[32:35], s76 offen sc1
    s_waitcnt vmcnt(11)
    s_waitcnt lgkmcnt(4)
    v_mfma_f32_32x32x16_bf16 v[4:19], v[82:85], v[132:135], v[4:19]
    v_mfma_f32_32x32x16_bf16 v[20:35], v[86:89], v[132:135], v[20:35]
    ds_read_b64_tr_b16 v[74:75], v164 offset:36864
    ds_read_b64_tr_b16 v[76:77], v164 offset:37888
    ds_read_b64_tr_b16 v[78:79], v165 offset:36864
    ds_read_b64_tr_b16 v[80:81], v165 offset:37888
    s_add_u32 s76, s75, 88064
    buffer_load_dwordx4 v[132:135], v0, s[32:35], s76 offen sc1
    s_waitcnt vmcnt(11)
    s_waitcnt lgkmcnt(4)
    v_mfma_f32_32x32x16_bf16 v[4:19], v[90:93], v[136:139], v[4:19]
    v_mfma_f32_32x32x16_bf16 v[20:35], v[94:97], v[136:139], v[20:35]
    ds_read_b64_tr_b16 v[82:83], v164 offset:40960
    ds_read_b64_tr_b16 v[84:85], v164 offset:41984
    ds_read_b64_tr_b16 v[86:87], v165 offset:40960
    ds_read_b64_tr_b16 v[88:89], v165 offset:41984
    s_add_u32 s76, s75, 96256
    buffer_load_dwordx4 v[136:139], v0, s[32:35], s76 offen sc1
    s_waitcnt vmcnt(11)
    s_waitcnt lgkmcnt(4)
    v_mfma_f32_32x32x16_bf16 v[4:19], v[74:77], v[140:143], v[4:19]
    v_mfma_f32_32x32x16_bf16 v[20:35], v[78:81], v[140:143], v[20:35]
    ds_read_b64_tr_b16 v[90:91], v164 offset:45056
    ds_read_b64_tr_b16 v[92:93], v164 offset:46080
    ds_read_b64_tr_b16 v[94:95], v165 offset:45056
    ds_read_b64_tr_b16 v[96:97], v165 offset:46080
    s_add_u32 s76, s75, 104448
    buffer_load_dwordx4 v[140:143], v0, s[32:35], s76 offen sc1
    s_waitcnt vmcnt(11)
    s_waitcnt lgkmcnt(4)
    v_mfma_f32_32x32x16_bf16 v[4:19], v[82:85], v[144:147], v[4:19]
    v_mfma_f32_32x32x16_bf16 v[20:35], v[86:89], v[144:147], v[20:35]
    ds_read_b64_tr_b16 v[74:75], v164 offset:49152
    ds_read_b64_tr_b16 v[76:77], v164 offset:50176
    ds_read_b64_tr_b16 v[78:79], v165 offset:49152
    ds_read_b64_tr_b16 v[80:81], v165 offset:50176
    s_add_u32 s76, s75, 112640
    buffer_load_dwordx4 v[144:147], v0, s[32:35], s76 offen sc1
    s_waitcnt vmcnt(11)
    s_waitcnt lgkmcnt(4)
    v_mfma_f32_32x32x16_bf16 v[4:19], v[90:93], v[148:151], v[4:19]
    v_mfma_f32_32x32x16_bf16 v[20:35], v[94:97], v[148:151], v[20:35]
    ds_read_b64_tr_b16 v[82:83], v164 offset:53248
    ds_read_b64_tr_b16 v[84:85], v164 offset:54272
    ds_read_b64_tr_b16 v[86:87], v165 offset:53248
    ds_read_b64_tr_b16 v[88:89], v165 offset:54272
    s_waitcnt vmcnt(10)
    s_waitcnt lgkmcnt(4)
    v_mfma_f32_32x32x16_bf16 v[4:19], v[74:77], v[152:155], v[4:19]
    v_mfma_f32_32x32x16_bf16 v[20:35], v[78:81], v[152:155], v[20:35]
    ds_read_b64_tr_b16 v[90:91], v164 offset:57344
    ds_read_b64_tr_b16 v[92:93], v164 offset:58368
    ds_read_b64_tr_b16 v[94:95], v165 offset:57344
    ds_read_b64_tr_b16 v[96:97], v165 offset:58368
    s_waitcnt vmcnt(9)
    s_waitcnt lgkmcnt(4)
    v_mfma_f32_32x32x16_bf16 v[4:19], v[82:85], v[156:159], v[4:19]
    v_mfma_f32_32x32x16_bf16 v[20:35], v[86:89], v[156:159], v[20:35]
    ds_read_b64_tr_b16 v[74:75], v164 offset:61440
    ds_read_b64_tr_b16 v[76:77], v164 offset:62464
    ds_read_b64_tr_b16 v[78:79], v165 offset:61440
    ds_read_b64_tr_b16 v[80:81], v165 offset:62464
    s_waitcnt vmcnt(8)
    s_waitcnt lgkmcnt(4)
    v_mfma_f32_32x32x16_bf16 v[4:19], v[90:93], v[160:163], v[4:19]
    v_mfma_f32_32x32x16_bf16 v[20:35], v[94:97], v[160:163], v[20:35]
    s_waitcnt lgkmcnt(0)
    s_barrier
    ds_read_b64_tr_b16 v[82:83], v166 offset:0
    ds_read_b64_tr_b16 v[84:85], v166 offset:1024
    ds_read_b64_tr_b16 v[86:87], v167 offset:0
    ds_read_b64_tr_b16 v[88:89], v167 offset:1024
    s_waitcnt vmcnt(7)
    s_waitcnt lgkmcnt(4)
    v_mfma_f32_32x32x16_bf16 v[4:19], v[74:77], v[116:119], v[4:19]
    v_mfma_f32_32x32x16_bf16 v[20:35], v[78:81], v[116:119], v[20:35]
    ds_read_b64_tr_b16 v[90:91], v166 offset:4096
    ds_read_b64_tr_b16 v[92:93], v166 offset:5120
    ds_read_b64_tr_b16 v[94:95], v167 offset:4096
    ds_read_b64_tr_b16 v[96:97], v167 offset:5120
    s_waitcnt vmcnt(6)
    s_waitcnt lgkmcnt(4)
    v_mfma_f32_32x32x16_bf16 v[4:19], v[82:85], v[120:123], v[4:19]
    v_mfma_f32_32x32x16_bf16 v[20:35], v[86:89], v[120:123], v[20:35]
    ds_read_b64_tr_b16 v[74:75], v166 offset:8192
    ds_read_b64_tr_b16 v[76:77], v166 offset:9216
    ds_read_b64_tr_b16 v[78:79], v167 offset:8192
    ds_read_b64_tr_b16 v[80:81], v167 offset:9216
    s_waitcnt vmcnt(5)
    s_waitcnt lgkmcnt(4)
    v_mfma_f32_32x32x16_bf16 v[4:19], v[90:93], v[124:127], v[4:19]
    v_mfma_f32_32x32x16_bf16 v[20:35], v[94:97], v[124:127], v[20:35]
    ds_read_b64_tr_b16 v[82:83], v166 offset:12288
    ds_read_b64_tr_b16 v[84:85], v166 offset:13312
    ds_read_b64_tr_b16 v[86:87], v167 offset:12288
    ds_read_b64_tr_b16 v[88:89], v167 offset:13312
    s_waitcnt vmcnt(4)
    s_waitcnt lgkmcnt(4)
    v_mfma_f32_32x32x16_bf16 v[4:19], v[74:77], v[128:131], v[4:19]
    v_mfma_f32_32x32x16_bf16 v[20:35], v[78:81], v[128:131], v[20:35]
    ds_read_b64_tr_b16 v[90:91], v166 offset:16384
    ds_read_b64_tr_b16 v[92:93], v166 offset:17408
    ds_read_b64_tr_b16 v[94:95], v167 offset:16384
    ds_read_b64_tr_b16 v[96:97], v167 offset:17408
    s_waitcnt vmcnt(3)
    s_waitcnt lgkmcnt(4)
    v_mfma_f32_32x32x16_bf16 v[4:19], v[82:85], v[132:135], v[4:19]
    v_mfma_f32_32x32x16_bf16 v[20:35], v[86:89], v[132:135], v[20:35]
    ds_read_b64_tr_b16 v[74:75], v166 offset:20480
    ds_read_b64_tr_b16 v[76:77], v166 offset:21504
    ds_read_b64_tr_b16 v[78:79], v167 offset:20480
    ds_read_b64_tr_b16 v[80:81], v167 offset:21504
    s_waitcnt vmcnt(2)
    s_waitcnt lgkmcnt(4)
    v_mfma_f32_32x32x16_bf16 v[4:19], v[90:93], v[136:139], v[4:19]
    v_mfma_f32_32x32x16_bf16 v[20:35], v[94:97], v[136:139], v[20:35]
    ds_read_b64_tr_b16 v[82:83], v166 offset:24576
    ds_read_b64_tr_b16 v[84:85], v166 offset:25600
    ds_read_b64_tr_b16 v[86:87], v167 offset:24576
    ds_read_b64_tr_b16 v[88:89], v167 offset:25600
    s_waitcnt vmcnt(1)
    s_waitcnt lgkmcnt(4)
    v_mfma_f32_32x32x16_bf16 v[4:19], v[74:77], v[140:143], v[4:19]
    v_mfma_f32_32x32x16_bf16 v[20:35], v[78:81], v[140:143], v[20:35]
    s_waitcnt vmcnt(0)
    s_waitcnt lgkmcnt(0)
    v_mfma_f32_32x32x16_bf16 v[4:19], v[82:85], v[144:147], v[4:19]
    v_mfma_f32_32x32x16_bf16 v[20:35], v[86:89], v[144:147], v[20:35]
    s_waitcnt lgkmcnt(0)
    s_barrier
    s_lshl_b32 s52, s44, 12
    s_add_u32 s52, s52, 0
    v_add_u32 v200, s52, v0
    s_xor_b32 s53, s44, 1
    s_lshl_b32 s53, s53, 12
    s_add_u32 s53, s53, 0
    v_add_u32 v201, s53, v0
    s_cmp_eq_u32 s57, 0
    s_nop 7

    s_cbranch_scc1 L_kr_2_a
    ds_write_b128 v200, v[4:7] offset:0
    ds_write_b128 v200, v[8:11] offset:1024
    ds_write_b128 v200, v[12:15] offset:2048
    ds_write_b128 v200, v[16:19] offset:3072
    v_mov_b32 v36, v20
    v_mov_b32 v37, v21
    v_mov_b32 v38, v22
    v_mov_b32 v39, v23
    v_mov_b32 v40, v24
    v_mov_b32 v41, v25
    v_mov_b32 v42, v26
    v_mov_b32 v43, v27
    v_mov_b32 v44, v28
    v_mov_b32 v45, v29
    v_mov_b32 v46, v30
    v_mov_b32 v47, v31
    v_mov_b32 v48, v32
    v_mov_b32 v49, v33
    v_mov_b32 v50, v34
    v_mov_b32 v51, v35
    s_branch L_kr_2_b
L_kr_2_a:
    ds_write_b128 v200, v[20:23] offset:0
    ds_write_b128 v200, v[24:27] offset:1024
    ds_write_b128 v200, v[28:31] offset:2048
    ds_write_b128 v200, v[32:35] offset:3072
    v_mov_b32 v36, v4
    v_mov_b32 v37, v5
    v_mov_b32 v38, v6
    v_mov_b32 v39, v7
    v_mov_b32 v40, v8
    v_mov_b32 v41, v9
    v_mov_b32 v42, v10
    v_mov_b32 v43, v11
    v_mov_b32 v44, v12
    v_mov_b32 v45, v13
    v_mov_b32 v46, v14
    v_mov_b32 v47, v15
    v_mov_b32 v48, v16
    v_mov_b32 v49, v17
    v_mov_b32 v50, v18
    v_mov_b32 v51, v19
L_kr_2_b:
    s_waitcnt lgkmcnt(0)
    s_barrier
    ds_read_b128 v[208:211], v201 offset:0
    ds_read_b128 v[212:215], v201 offset:1024
    ds_read_b128 v[216:219], v201 offset:2048
    ds_read_b128 v[220:223], v201 offset:3072
    s_waitcnt lgkmcnt(3)
    v_pk_add_f32 v[36:37], v[36:37], v[208:209]
    v_pk_add_f32 v[38:39], v[38:39], v[210:211]
    s_waitcnt lgkmcnt(2)
    v_pk_add_f32 v[40:41], v[40:41], v[212:213]
    v_pk_add_f32 v[42:43], v[42:43], v[214:215]
    s_waitcnt lgkmcnt(1)
    v_pk_add_f32 v[44:45], v[44:45], v[216:217]
    v_pk_add_f32 v[46:47], v[46:47], v[218:219]
    s_waitcnt lgkmcnt(0)
    v_pk_add_f32 v[48:49], v[48:49], v[220:221]
    v_pk_add_f32 v[50:51], v[50:51], v[222:223]
    v_lshrrev_b32 v200, 5, v1
    v_lshlrev_b32 v200, 4, v200
    s_lshl_b32 s53, s57, 7
    s_add_u32 s53, s53, 163072
    v_add_u32 v238, s53, v200

    ds_read_b128 v[64:67], v238 offset:0
    ds_read_b128 v[68:71], v238 offset:32
    ds_read_b128 v[72:75], v238 offset:64
    ds_read_b128 v[76:79], v238 offset:96
    s_mov_b32 s56, 0xffff0000
    v_lshlrev_b32 v80, 16, v244
    v_and_b32 v81, s56, v244
    v_lshlrev_b32 v82, 16, v245
    v_and_b32 v83, s56, v245
    v_lshlrev_b32 v84, 16, v246
    v_and_b32 v85, s56, v246
    v_lshlrev_b32 v86, 16, v247
    v_and_b32 v87, s56, v247
    v_lshlrev_b32 v88, 16, v248
    v_and_b32 v89, s56, v248
    v_lshlrev_b32 v90, 16, v249
    v_and_b32 v91, s56, v249
    v_lshlrev_b32 v92, 16, v250
    v_and_b32 v93, s56, v250
    v_lshlrev_b32 v94, 16, v251
    v_and_b32 v95, s56, v251
    s_lshl_b32 s52, s45, 8
    s_lshl_b32 s53, s47, 6
    s_add_u32 s52, s52, s53
    s_lshl_b32 s53, s58, 5
    s_add_u32 s52, s52, s53
    v_and_b32 v236, 31, v1
    v_add_u32 v236, s52, v236
    v_lshlrev_b32 v236, 10, v236
    v_lshrrev_b32 v237, 5, v1
    v_lshl_add_u32 v236, v237, 3, v236
    s_lshl_b32 s52, s48, 7
    s_lshl_b32 s53, s57, 6
    s_add_u32 s52, s52, s53
    v_add_u32 v236, s52, v236

    s_mov_b32 s36, s22
    s_and_b32 s37, s23, 0xffff
    s_mov_b32 s38, 0x200000
    s_mov_b32 s39, 0x20000
    s_waitcnt lgkmcnt(0)
    v_pk_fma_f32 v[36:37], v[36:37], v[64:65], v[80:81]
    v_pk_fma_f32 v[38:39], v[38:39], v[66:67], v[82:83]
    v_pk_fma_f32 v[40:41], v[40:41], v[68:69], v[84:85]
    v_pk_fma_f32 v[42:43], v[42:43], v[70:71], v[86:87]
    v_pk_fma_f32 v[44:45], v[44:45], v[72:73], v[88:89]
    v_pk_fma_f32 v[46:47], v[46:47], v[74:75], v[90:91]
    v_pk_fma_f32 v[48:49], v[48:49], v[76:77], v[92:93]
    v_pk_fma_f32 v[50:51], v[50:51], v[78:79], v[94:95]
    v_cvt_pk_bf16_f32 v4, v36, v37
    v_cvt_pk_bf16_f32 v5, v38, v39
    v_cvt_pk_bf16_f32 v6, v40, v41
    v_cvt_pk_bf16_f32 v7, v42, v43
    v_cvt_pk_bf16_f32 v8, v44, v45
    v_cvt_pk_bf16_f32 v9, v46, v47
    v_cvt_pk_bf16_f32 v10, v48, v49
    v_cvt_pk_bf16_f32 v11, v50, v51
    v_lshl_add_u32 v236, v237, 3, v236
    s_nop 0
    v_permlane32_swap_b32 v4, v6
    v_permlane32_swap_b32 v5, v7
    v_permlane32_swap_b32 v8, v10
    v_permlane32_swap_b32 v9, v11
    s_nop 0
    buffer_store_dwordx4 v[4:7], v236, s[36:39], 0 offen offset:0
    buffer_store_dwordx4 v[8:11], v236, s[36:39], 0 offen offset:32
    s_branch L_fin
L_loader2:
    s_barrier
    s_mov_b32 s63, 0
    s_add_u32 m0, s62, 0
    s_nop 0
    buffer_load_dwordx4 v10, s[28:31], s63 offen offset:0 lds
    buffer_load_dwordx4 v10, s[28:31], s63 offen offset:1024 lds
    buffer_load_dwordx4 v10, s[28:31], s63 offen offset:2048 lds
    s_mov_b32 s63, 98304
    s_add_u32 m0, s62, 12288
    s_nop 0
    buffer_load_dwordx4 v10, s[28:31], s63 offen offset:0 lds
    buffer_load_dwordx4 v10, s[28:31], s63 offen offset:1024 lds
    buffer_load_dwordx4 v10, s[28:31], s63 offen offset:2048 lds
    s_mov_b32 s63, 196608
    s_add_u32 m0, s62, 24576
    s_nop 0
    buffer_load_dwordx4 v10, s[28:31], s63 offen offset:0 lds
    buffer_load_dwordx4 v10, s[28:31], s63 offen offset:1024 lds
    buffer_load_dwordx4 v10, s[28:31], s63 offen offset:2048 lds
    s_sub_u32 s52, s2, 32
    s_cmp_ge_u32 s52, 64
    s_cbranch_scc1 L_l_nop0b
    s_waitcnt vmcnt(9)
    s_mov_b32 s56, 0xffff0000
    s_mov_b32 s57, 0xbfb8aa3b
    v_lshlrev_b32 v24, 16, v24
    v_lshlrev_b32 v25, 16, v25
    v_lshlrev_b32 v26, 16, v26
    v_lshlrev_b32 v27, 16, v27
    v_lshlrev_b32 v28, 16, v28
    v_lshlrev_b32 v29, 16, v29
    v_lshlrev_b32 v30, 16, v30
    v_lshlrev_b32 v31, 16, v31
    v_mul_f32 v64, s57, v24
    v_mul_f32 v65, s57, v25
    v_mul_f32 v66, s57, v26
    v_mul_f32 v67, s57, v27
    v_mul_f32 v68, s57, v28
    v_mul_f32 v69, s57, v29
    v_mul_f32 v70, s57, v30
    v_mul_f32 v71, s57, v31
    v_exp_f32 v64, v64
    v_exp_f32 v65, v65
    v_exp_f32 v66, v66
    v_exp_f32 v67, v67
    v_exp_f32 v68, v68
    v_exp_f32 v69, v69
    v_exp_f32 v70, v70
    v_exp_f32 v71, v71
    s_nop 0
    v_add_f32 v64, 1.0, v64
    v_add_f32 v65, 1.0, v65
    v_add_f32 v66, 1.0, v66
    v_add_f32 v67, 1.0, v67
    v_add_f32 v68, 1.0, v68
    v_add_f32 v69, 1.0, v69
    v_add_f32 v70, 1.0, v70
    v_add_f32 v71, 1.0, v71
    v_rcp_f32 v64, v64
    v_rcp_f32 v65, v65
    v_rcp_f32 v66, v66
    v_rcp_f32 v67, v67
    v_rcp_f32 v68, v68
    v_rcp_f32 v69, v69
    v_rcp_f32 v70, v70
    v_rcp_f32 v71, v71
    s_nop 0
    v_mul_f32 v64, v64, v24
    v_mul_f32 v65, v65, v25
    v_mul_f32 v66, v66, v26
    v_mul_f32 v67, v67, v27
    v_mul_f32 v68, v68, v28
    v_mul_f32 v69, v69, v29
    v_mul_f32 v70, v70, v30
    v_mul_f32 v71, v71, v31
    v_cvt_pk_bf16_f32 v64, v64, v64
    v_cvt_pk_bf16_f32 v65, v65, v65
    v_cvt_pk_bf16_f32 v66, v66, v66
    v_cvt_pk_bf16_f32 v67, v67, v67
    v_cvt_pk_bf16_f32 v68, v68, v68
    v_cvt_pk_bf16_f32 v69, v69, v69
    v_cvt_pk_bf16_f32 v70, v70, v70
    v_cvt_pk_bf16_f32 v71, v71, v71
    v_and_b32 v24, 0xffff, v64
    v_and_b32 v64, s56, v64
    v_and_b32 v25, 0xffff, v65
    v_and_b32 v65, s56, v65
    v_and_b32 v26, 0xffff, v66
    v_and_b32 v66, s56, v66
    v_and_b32 v27, 0xffff, v67
    v_and_b32 v67, s56, v67
    v_and_b32 v28, 0xffff, v68
    v_and_b32 v68, s56, v68
    v_and_b32 v29, 0xffff, v69
    v_and_b32 v69, s56, v69
    v_and_b32 v30, 0xffff, v70
    v_and_b32 v70, s56, v70
    v_and_b32 v31, 0xffff, v71
    v_and_b32 v71, s56, v71
    v_mov_b32 v72, 0
    v_mov_b32 v73, 0
    v_mov_b32 v74, 0
    v_mov_b32 v75, 0
    v_mov_b32 v76, 0
    v_mov_b32 v77, 0
    v_mov_b32 v78, 0
    v_mov_b32 v79, 0
    v_dot2c_f32_bf16 v72, v32, v24
    v_dot2c_f32_bf16 v73, v32, v64
    v_dot2c_f32_bf16 v74, v33, v24
    v_dot2c_f32_bf16 v75, v33, v64
    v_dot2c_f32_bf16 v76, v34, v24
    v_dot2c_f32_bf16 v77, v34, v64
    v_dot2c_f32_bf16 v78, v35, v24
    v_dot2c_f32_bf16 v79, v35, v64
    v_dot2c_f32_bf16 v72, v36, v25
    v_dot2c_f32_bf16 v73, v36, v65
    v_dot2c_f32_bf16 v74, v37, v25
    v_dot2c_f32_bf16 v75, v37, v65
    v_dot2c_f32_bf16 v76, v38, v25
    v_dot2c_f32_bf16 v77, v38, v65
    v_dot2c_f32_bf16 v78, v39, v25
    v_dot2c_f32_bf16 v79, v39, v65
    v_dot2c_f32_bf16 v72, v40, v26
    v_dot2c_f32_bf16 v73, v40, v66
    v_dot2c_f32_bf16 v74, v41, v26
    v_dot2c_f32_bf16 v75, v41, v66
    v_dot2c_f32_bf16 v76, v42, v26
    v_dot2c_f32_bf16 v77, v42, v66
    v_dot2c_f32_bf16 v78, v43, v26
    v_dot2c_f32_bf16 v79, v43, v66
    v_dot2c_f32_bf16 v72, v44, v27
    v_dot2c_f32_bf16 v73, v44, v67
    v_dot2c_f32_bf16 v74, v45, v27
    v_dot2c_f32_bf16 v75, v45, v67
    v_dot2c_f32_bf16 v76, v46, v27
    v_dot2c_f32_bf16 v77, v46, v67
    v_dot2c_f32_bf16 v78, v47, v27
    v_dot2c_f32_bf16 v79, v47, v67
    v_dot2c_f32_bf16 v72, v48, v28
    v_dot2c_f32_bf16 v73, v48, v68
    v_dot2c_f32_bf16 v74, v49, v28
    v_dot2c_f32_bf16 v75, v49, v68
    v_dot2c_f32_bf16 v76, v50, v28
    v_dot2c_f32_bf16 v77, v50, v68
    v_dot2c_f32_bf16 v78, v51, v28
    v_dot2c_f32_bf16 v79, v51, v68
    v_dot2c_f32_bf16 v72, v52, v29
    v_dot2c_f32_bf16 v73, v52, v69
    v_dot2c_f32_bf16 v74, v53, v29
    v_dot2c_f32_bf16 v75, v53, v69
    v_dot2c_f32_bf16 v76, v54, v29
    v_dot2c_f32_bf16 v77, v54, v69
    v_dot2c_f32_bf16 v78, v55, v29
    v_dot2c_f32_bf16 v79, v55, v69
    v_dot2c_f32_bf16 v72, v56, v30
    v_dot2c_f32_bf16 v73, v56, v70
    v_dot2c_f32_bf16 v74, v57, v30
    v_dot2c_f32_bf16 v75, v57, v70
    v_dot2c_f32_bf16 v76, v58, v30
    v_dot2c_f32_bf16 v77, v58, v70
    v_dot2c_f32_bf16 v78, v59, v30
    v_dot2c_f32_bf16 v79, v59, v70
    v_dot2c_f32_bf16 v72, v60, v31
    v_dot2c_f32_bf16 v73, v60, v71
    v_dot2c_f32_bf16 v74, v61, v31
    v_dot2c_f32_bf16 v75, v61, v71
    v_dot2c_f32_bf16 v76, v62, v31
    v_dot2c_f32_bf16 v77, v62, v71
    v_dot2c_f32_bf16 v78, v63, v31
    v_dot2c_f32_bf16 v79, v63, v71
    s_nop 1
    v_permlane32_swap_b32 v72, v76
    v_permlane32_swap_b32 v73, v77
    v_permlane32_swap_b32 v74, v78
    v_permlane32_swap_b32 v75, v79
    s_nop 0
    v_add_f32 v72, v72, v76
    v_add_f32 v73, v73, v77
    v_add_f32 v74, v74, v78
    v_add_f32 v75, v75, v79
    s_nop 1
    v_permlane16_swap_b32 v72, v74
    v_permlane16_swap_b32 v73, v75
    s_nop 0
    v_add_f32 v72, v72, v74
    v_add_f32 v73, v73, v75
    s_nop 1
    v_add_f32_dpp v72, v72, v72 row_ror:8 row_mask:0xf bank_mask:0xf
    v_add_f32_dpp v73, v73, v73 row_ror:8 row_mask:0xf bank_mask:0xf
    v_and_b32 v20, 7, v1
    v_lshlrev_b32 v20, 3, v20
    v_lshrrev_b32 v21, 5, v1
    v_lshl_add_u32 v20, v21, 2, v20
    v_lshrrev_b32 v21, 4, v1
    v_and_b32 v21, 1, v21
    v_lshl_add_u32 v20, v21, 1, v20
    v_lshlrev_b32 v20, 3, v20
    s_and_b32 s52, s2, 1
    s_lshl_b32 s52, s52, 2
    s_add_u32 s52, s52, s44
    s_lshl_b32 s52, s52, 14
    s_lshr_b32 s53, s2, 1
    s_sub_u32 s53, s53, 16
    s_lshl_b32 s53, s53, 9
    s_add_u32 s52, s52, s53
    s_add_u32 s52, s52, 180224
    v_mov_b32 v6, 132
    s_mov_b32 s72, 0

L_l_nonb:
    v_readfirstlane_b32 s49, v5
    s_add_u32 s72, s72, 1
    s_cmp_gt_u32 s72, 0x100000
    s_cbranch_scc1 L_l_nonb_out
    s_cmp_lg_u32 s49, 0
    s_cbranch_scc1 L_l_nonb_out
    global_load_dword v5, v6, s[24:25] sc1
    s_waitcnt vmcnt(0)
    s_branch L_l_nonb

L_l_nonb_out:
    v_mov_b32 v76, v72
    v_mov_b32 v77, v5
    v_mov_b32 v78, v73
    v_mov_b32 v79, v5
    s_mov_b32 exec_lo, 0x00ff00ff
    s_mov_b32 exec_hi, 0x00ff00ff

    buffer_store_dwordx4 v[76:79], v20, s[32:35], s52 offen sc1
    s_mov_b64 exec, -1
    s_nop 1
L_l_nop0b:
    s_barrier
    s_mov_b32 s63, 294912
    s_add_u32 m0, s62, 36864
    s_nop 0
    buffer_load_dwordx4 v10, s[28:31], s63 offen offset:0 lds
    buffer_load_dwordx4 v10, s[28:31], s63 offen offset:1024 lds
    buffer_load_dwordx4 v10, s[28:31], s63 offen offset:2048 lds
    s_mov_b32 s63, 393216
    s_add_u32 m0, s62, 49152
    s_nop 0
    buffer_load_dwordx4 v10, s[28:31], s63 offen offset:0 lds
    buffer_load_dwordx4 v10, s[28:31], s63 offen offset:1024 lds
    buffer_load_dwordx4 v10, s[28:31], s63 offen offset:2048 lds
    s_mov_b32 s63, 491520
    s_add_u32 m0, s62, 61440
    s_nop 0
    buffer_load_dwordx4 v10, s[28:31], s63 offen offset:0 lds
    buffer_load_dwordx4 v10, s[28:31], s63 offen offset:1024 lds
    buffer_load_dwordx4 v10, s[28:31], s63 offen offset:2048 lds
    v_lshlrev_b32 v203, 4, v1
    v_add_u32 v203, s62, v203
    s_mov_b32 s63, 589824
    buffer_load_dwordx4 v[64:67], v10, s[28:31], s63 offen offset:0
    buffer_load_dwordx4 v[68:71], v10, s[28:31], s63 offen offset:1024
    buffer_load_dwordx4 v[72:75], v10, s[28:31], s63 offen offset:2048
    s_mov_b32 s63, 688128
    buffer_load_dwordx4 v[76:79], v10, s[28:31], s63 offen offset:0
    buffer_load_dwordx4 v[80:83], v10, s[28:31], s63 offen offset:1024
    buffer_load_dwordx4 v[84:87], v10, s[28:31], s63 offen offset:2048
    s_mov_b32 s63, 786432
    buffer_load_dwordx4 v[88:91], v10, s[28:31], s63 offen offset:0
    buffer_load_dwordx4 v[92:95], v10, s[28:31], s63 offen offset:1024
    buffer_load_dwordx4 v[96:99], v10, s[28:31], s63 offen offset:2048
    s_mov_b32 s63, 884736
    buffer_load_dwordx4 v[100:103], v10, s[28:31], s63 offen offset:0
    buffer_load_dwordx4 v[104:107], v10, s[28:31], s63 offen offset:1024
    buffer_load_dwordx4 v[108:111], v10, s[28:31], s63 offen offset:2048
    s_mov_b32 s63, 983040
    buffer_load_dwordx4 v[112:115], v10, s[28:31], s63 offen offset:0
    buffer_load_dwordx4 v[116:119], v10, s[28:31], s63 offen offset:1024
    buffer_load_dwordx4 v[120:123], v10, s[28:31], s63 offen offset:2048
    s_mov_b32 s63, 1081344
    buffer_load_dwordx4 v[124:127], v10, s[28:31], s63 offen offset:0
    buffer_load_dwordx4 v[128:131], v10, s[28:31], s63 offen offset:1024
    buffer_load_dwordx4 v[132:135], v10, s[28:31], s63 offen offset:2048
    s_mov_b32 s63, 1179648
    buffer_load_dwordx4 v[136:139], v10, s[28:31], s63 offen offset:0
    buffer_load_dwordx4 v[140:143], v10, s[28:31], s63 offen offset:1024
    buffer_load_dwordx4 v[144:147], v10, s[28:31], s63 offen offset:2048
    s_mov_b32 s63, 1277952
    buffer_load_dwordx4 v[148:151], v10, s[28:31], s63 offen offset:0
    buffer_load_dwordx4 v[152:155], v10, s[28:31], s63 offen offset:1024
    buffer_load_dwordx4 v[156:159], v10, s[28:31], s63 offen offset:2048
    s_mov_b32 s63, 1376256
    buffer_load_dwordx4 v[160:163], v10, s[28:31], s63 offen offset:0
    buffer_load_dwordx4 v[164:167], v10, s[28:31], s63 offen offset:1024
    buffer_load_dwordx4 v[168:171], v10, s[28:31], s63 offen offset:2048
    s_mov_b32 s63, 1474560
    buffer_load_dwordx4 v[172:175], v10, s[28:31], s63 offen offset:0
    buffer_load_dwordx4 v[176:179], v10, s[28:31], s63 offen offset:1024
    buffer_load_dwordx4 v[180:183], v10, s[28:31], s63 offen offset:2048
    s_waitcnt vmcnt(39)
    s_barrier
    v_mov_b32 v2, 163332
    ds_read_b32 v3, v2
    s_waitcnt lgkmcnt(0)
    v_readfirstlane_b32 s49, v3
    s_mov_b64 exec, 1
    s_cmp_lg_u32 s44, 1
    s_cbranch_scc1 L_l_y3
L_l_y1:
    s_lshl_b32 s52, s45, 12
    s_lshl_b32 s53, s46, 2
    s_add_u32 s52, s52, s53
    s_add_u32 s52, s52, 69120
    s_add_u32 s53, s49, s50
    s_add_u32 s53, s53, 1
    v_mov_b32 v2, 0
    v_mov_b32 v3, s53

    buffer_store_dword v3, v2, s[32:35], s52 offen sc1
L_l_y3:
    s_mov_b64 exec, -1
    s_waitcnt lgkmcnt(0)
    s_barrier
    s_waitcnt vmcnt(27)
    ds_write_b128 v203, v[64:67] offset:0
    ds_write_b128 v203, v[68:71] offset:1024
    ds_write_b128 v203, v[72:75] offset:2048
    s_lshl_b32 s52, s2, 2
    s_add_u32 s52, s52, s44
    s_mov_b32 s54, s12
    s_mov_b32 s55, s13
    s_cmp_ge_u32 s52, 224
    s_cselect_b32 s54, s14, s54
    s_cselect_b32 s55, s15, s55
    s_cselect_b32 s53, 224, 0
    s_cmp_ge_u32 s52, 448
    s_cselect_b32 s54, s16, s54
    s_cselect_b32 s55, s17, s55
    s_cselect_b32 s53, 448, s53
    s_sub_u32 s53, s52, s53
    s_lshl_b32 s53, s53, 13
    v_lshlrev_b32 v46, 7, v1
    v_add_u32 v46, s53, v46
    s_cmp_ge_u32 s52, 672
    s_cselect_b64 vcc, -1, 0
    v_cndmask_b32 v46, v46, 0, vcc

    global_load_dword v47, v46, s[54:55]
    s_waitcnt lgkmcnt(0)
    s_barrier
    s_waitcnt vmcnt(25)
    ds_write_b128 v203, v[76:79] offset:12288
    ds_write_b128 v203, v[80:83] offset:13312
    ds_write_b128 v203, v[84:87] offset:14336
    s_waitcnt vmcnt(22)
    ds_write_b128 v203, v[88:91] offset:24576
    ds_write_b128 v203, v[92:95] offset:25600
    ds_write_b128 v203, v[96:99] offset:26624
    s_waitcnt lgkmcnt(0)
    s_barrier
    s_waitcnt vmcnt(19)
    ds_write_b128 v203, v[100:103] offset:36864
    ds_write_b128 v203, v[104:107] offset:37888
    ds_write_b128 v203, v[108:111] offset:38912
    s_waitcnt vmcnt(16)
    ds_write_b128 v203, v[112:115] offset:49152
    ds_write_b128 v203, v[116:119] offset:50176
    ds_write_b128 v203, v[120:123] offset:51200
    s_waitcnt lgkmcnt(0)
    s_barrier
    s_waitcnt vmcnt(13)
    ds_write_b128 v203, v[124:127] offset:61440
    ds_write_b128 v203, v[128:131] offset:62464
    ds_write_b128 v203, v[132:135] offset:63488
    s_waitcnt vmcnt(10)
    ds_write_b128 v203, v[136:139] offset:0
    ds_write_b128 v203, v[140:143] offset:1024
    ds_write_b128 v203, v[144:147] offset:2048
    s_waitcnt lgkmcnt(0)
    s_barrier
    s_waitcnt vmcnt(7)
    ds_write_b128 v203, v[148:151] offset:12288
    ds_write_b128 v203, v[152:155] offset:13312
    ds_write_b128 v203, v[156:159] offset:14336
    s_waitcnt vmcnt(4)
    ds_write_b128 v203, v[160:163] offset:24576
    ds_write_b128 v203, v[164:167] offset:25600
    ds_write_b128 v203, v[168:171] offset:26624
    s_waitcnt lgkmcnt(0)
    s_barrier
    s_waitcnt vmcnt(1)
    ds_write_b128 v203, v[172:175] offset:36864
    ds_write_b128 v203, v[176:179] offset:37888
    ds_write_b128 v203, v[180:183] offset:38912
    s_lshl_b32 s52, s45, 12
    s_add_u32 s52, s52, 69120
    v_and_b32 v2, 31, v1
    v_lshlrev_b32 v2, 2, v2
    v_add_u32 v251, s52, v2
    s_mov_b32 s53, 0
    s_cmp_eq_u32 s44, 1
    s_cselect_b32 s52, 1024, s53
    s_cmp_eq_u32 s44, 2
    s_cselect_b32 s52, 512, s52
    s_cmp_eq_u32 s44, 3
    s_cselect_b32 s52, 1536, s52
    s_lshl_b32 s53, s48, 6
    s_add_u32 s52, s52, s53
    s_lshl_b32 s52, s52, 3
    s_add_u32 s68, s52, 180224
    v_lshlrev_b32 v249, 3, v1
    s_mov_b32 s72, 0

    buffer_load_dword v250, v251, s[32:35], 0 offen sc1
    s_add_u32 s69, s68, 0
    buffer_load_dwordx2 v[20:21], v249, s[32:35], s69 offen sc1
    s_add_u32 s69, s68, 16384
    buffer_load_dwordx2 v[22:23], v249, s[32:35], s69 offen sc1
    s_add_u32 s69, s68, 32768
    buffer_load_dwordx2 v[24:25], v249, s[32:35], s69 offen sc1
    s_add_u32 s69, s68, 49152
    buffer_load_dwordx2 v[26:27], v249, s[32:35], s69 offen sc1
    s_add_u32 s69, s68, 65536
    buffer_load_dwordx2 v[28:29], v249, s[32:35], s69 offen sc1
    s_add_u32 s69, s68, 81920
    buffer_load_dwordx2 v[30:31], v249, s[32:35], s69 offen sc1
    s_add_u32 s69, s68, 98304
    buffer_load_dwordx2 v[32:33], v249, s[32:35], s69 offen sc1
    s_add_u32 s69, s68, 114688
    buffer_load_dwordx2 v[34:35], v249, s[32:35], s69 offen sc1
    s_lshl_b32 s52, s45, 3
    s_lshl_b32 s53, s47, 1
    s_add_u32 s52, s52, s53
    s_lshl_b32 s52, s52, 15
    s_lshl_b32 s53, s48, 12
    s_add_u32 s52, s52, s53
    s_mov_b32 s54, 0x100000
    s_cmp_eq_u32 s44, 1
    s_cselect_b32 s53, 0x400000, s54
    s_add_u32 s52, s52, s53
    v_and_b32 v40, 31, v1
    v_lshlrev_b32 v40, 7, v40
    v_lshrrev_b32 v41, 5, v1
    v_lshl_add_u32 v40, v41, 15, v40
    v_add_u32 v40, s52, v40
    s_lshl_b32 s52, s45, 2
    s_add_u32 s52, s52, s47
    s_lshl_b32 s52, s52, 14
    s_lshl_b32 s53, s48, 11
    s_add_u32 s52, s52, s53
    s_add_u32 s52, s52, 3145728
    s_lshl_b32 s53, s45, 12
    s_add_u32 s53, s53, 63488
    v_lshlrev_b32 v41, 7, v1
    v_add_u32 v42, s52, v41
    v_min_u32 v43, 47, v1
    v_lshlrev_b32 v43, 7, v43
    v_add_u32 v41, s53, v43
    v_cmp_gt_u32 vcc, 16, v1
    s_nop 1
    v_cndmask_b32 v41, v41, v42, vcc
    s_cmp_ge_u32 s44, 2
    s_cselect_b64 vcc, -1, 0
    v_cndmask_b32 v40, v40, v41, vcc

    buffer_load_dword v44, v40, s[32:35], 0 offen sc1
    s_waitcnt lgkmcnt(0)
    s_barrier
    v_lshrrev_b32 v14, 3, v1
    v_lshlrev_b32 v14, 10, v14
    v_lshrrev_b32 v15, 4, v1
    v_and_b32 v15, 1, v15
    v_lshlrev_b32 v15, 2, v15
    v_and_b32 v16, 7, v1
    v_xor_b32 v15, v15, v16
    v_lshl_add_u32 v12, v15, 4, v14
    s_lshl_b32 s53, s48, 7
    v_add_u32 v12, s53, v12
    s_lshl_b32 s53, s44, 13
    v_add_u32 v13, s53, v12

    s_and_b32 s53, s44, 1
    s_lshl_b32 s53, s53, 3
    v_lshrrev_b32 v14, 3, v1
    v_add_u32 v14, s53, v14
    v_mul_u32_u24 v14, 3584, v14
    v_lshrrev_b32 v15, 4, v1
    v_and_b32 v15, 1, v15
    v_lshlrev_b32 v15, 1, v15
    s_lshr_b32 s53, s44, 1
    s_lshl_b32 s53, s53, 2
    v_add_u32 v15, s53, v15
    v_xor_b32 v15, v15, v16
    v_lshl_add_u32 v11, v15, 4, v14
    s_lshl_b32 s64, s44, 10

    s_cmp_ge_u32 s46, 14
    s_cselect_b32 s66, 1, 0
    s_mul_i32 s53, s66, 14
    s_sub_u32 s67, s46, s53
    s_lshl_b32 s65, s67, 8

    s_add_u32 s70, s65, 128
    s_waitcnt lgkmcnt(0)
    s_barrier
    s_branch L_l_vx_chk
L_l_vx:
    buffer_load_dword v250, v251, s[32:35], 0 offen sc1
    s_add_u32 s69, s68, 0
    buffer_load_dwordx2 v[20:21], v249, s[32:35], s69 offen sc1
    s_add_u32 s69, s68, 16384
    buffer_load_dwordx2 v[22:23], v249, s[32:35], s69 offen sc1
    s_add_u32 s69, s68, 32768
    buffer_load_dwordx2 v[24:25], v249, s[32:35], s69 offen sc1
    s_add_u32 s69, s68, 49152
    buffer_load_dwordx2 v[26:27], v249, s[32:35], s69 offen sc1
    s_add_u32 s69, s68, 65536
    buffer_load_dwordx2 v[28:29], v249, s[32:35], s69 offen sc1
    s_add_u32 s69, s68, 81920
    buffer_load_dwordx2 v[30:31], v249, s[32:35], s69 offen sc1
    s_add_u32 s69, s68, 98304
    buffer_load_dwordx2 v[32:33], v249, s[32:35], s69 offen sc1
    s_add_u32 s69, s68, 114688
    buffer_load_dwordx2 v[34:35], v249, s[32:35], s69 offen sc1
    s_waitcnt vmcnt(0)
L_l_vx_chk:
    s_waitcnt vmcnt(1)
    s_add_u32 s72, s72, 1
    v_subrev_u32 v3, s49, v250
    v_add_u32 v3, -1, v3
    v_xor_b32 v4, s49, v21
    v_xor_b32 v5, s49, v23
    v_xor_b32 v6, s49, v25
    v_or3_b32 v4, v4, v5, v6
    v_xor_b32 v5, s49, v27
    v_xor_b32 v6, s49, v29
    v_or3_b32 v4, v4, v5, v6
    v_xor_b32 v5, s49, v31
    v_xor_b32 v6, s49, v33
    v_or3_b32 v4, v4, v5, v6
    v_xor_b32 v5, s49, v35
    v_or_b32 v4, v4, v5
    v_cmp_lt_u32 s[80:81], 15, v3
    v_cmp_ne_u32 vcc, 0, v4
    s_cmp_gt_u32 s72, 0x100000
    s_cbranch_scc1 L_l_vx_out
    s_or_b64 vcc, vcc, s[80:81]
    s_cbranch_vccnz L_l_vx

L_l_vx_out:
    v_cmp_ne_u32 vcc, s50, v3
    s_mov_b32 s51, 1
    s_cbranch_vccz L_l_hi_loc
    s_mov_b32 s51, 0

L_l_hi_loc:
    v_mov_b32 v2, 163328
    v_mov_b32 v3, s51
    ds_write_b32 v2, v3
    s_waitcnt lgkmcnt(0)

    s_barrier
    s_mov_b32 s40, s8
    s_and_b32 s41, s9, 0xffff
    s_mov_b32 s42, 0x80000
    s_mov_b32 s43, 0x20000
    s_mov_b32 s63, 0
    s_add_u32 m0, s64, 0
    s_nop 0
    buffer_load_dwordx4 v13, s[40:43], s63 offen lds
    s_mov_b32 s63, 32768
    s_add_u32 m0, s64, 4096
    s_nop 0
    buffer_load_dwordx4 v13, s[40:43], s63 offen lds
    s_mov_b32 s63, 65536
    s_add_u32 m0, s64, 8192
    s_nop 0
    buffer_load_dwordx4 v13, s[40:43], s63 offen lds
    s_mov_b32 s63, 98304
    s_add_u32 m0, s64, 12288
    s_nop 0
    buffer_load_dwordx4 v13, s[40:43], s63 offen lds
    s_mov_b32 s63, 131072
    s_add_u32 m0, s64, 16384
    s_nop 0
    buffer_load_dwordx4 v13, s[40:43], s63 offen lds
    s_mov_b32 s63, 163840
    s_add_u32 m0, s64, 20480
    s_nop 0
    buffer_load_dwordx4 v13, s[40:43], s63 offen lds
    s_mov_b32 s63, 196608
    s_add_u32 m0, s64, 24576
    s_nop 0
    buffer_load_dwordx4 v13, s[40:43], s63 offen lds
    s_mov_b32 s63, 229376
    s_add_u32 m0, s64, 28672
    s_nop 0
    buffer_load_dwordx4 v13, s[40:43], s63 offen lds
    s_mov_b32 s63, 262144
    s_add_u32 m0, s64, 32768
    s_nop 0
    buffer_load_dwordx4 v13, s[40:43], s63 offen lds
    s_mov_b32 s63, 294912
    s_add_u32 m0, s64, 36864
    s_nop 0
    buffer_load_dwordx4 v13, s[40:43], s63 offen lds
    s_mov_b32 s63, 327680
    s_add_u32 m0, s64, 40960
    s_nop 0
    buffer_load_dwordx4 v13, s[40:43], s63 offen lds
    s_mov_b32 s63, 360448
    s_add_u32 m0, s64, 45056
    s_nop 0
    buffer_load_dwordx4 v13, s[40:43], s63 offen lds
    s_mov_b32 s63, 393216
    s_add_u32 m0, s64, 49152
    s_nop 0
    buffer_load_dwordx4 v13, s[40:43], s63 offen lds
    s_mov_b32 s63, 425984
    s_add_u32 m0, s64, 53248
    s_nop 0
    buffer_load_dwordx4 v13, s[40:43], s63 offen lds
    s_mov_b32 s63, 458752
    s_add_u32 m0, s64, 57344
    s_nop 0
    buffer_load_dwordx4 v13, s[40:43], s63 offen lds
    s_mov_b32 s63, 491520
    s_add_u32 m0, s64, 61440
    s_nop 0
    buffer_load_dwordx4 v13, s[40:43], s63 offen lds
    v_add_f32 v20, v20, v22
    v_add_f32 v24, v24, v26
    v_add_f32 v28, v28, v30
    v_add_f32 v32, v32, v34
    v_add_f32 v20, v20, v24
    v_add_f32 v28, v28, v32
    v_add_f32 v3, v20, v28
    v_cvt_pk_bf16_f32 v3, v3, v3
    s_mov_b32 s56, 0xffff0000
    v_and_b32 v3, s56, v3
    v_add_f32 v4, 1.0, v3
    v_cvt_pk_bf16_f32 v4, v4, v4
    v_and_b32 v4, s56, v4
    s_cmp_eq_u32 s44, 1
    s_cselect_b64 s[80:81], -1, 0
    v_cndmask_b32 v3, v3, v4, s[80:81]
    s_sub_u32 s52, s44, 1
    s_cmp_lt_u32 s52, 2
    s_cselect_b32 s53, 0x3fb8aa3b, 1.0
    v_mul_f32 v3, s53, v3
    s_lshl_b32 s52, s44, 8
    s_add_u32 s52, s52, 162304
    v_lshlrev_b32 v2, 2, v1
    v_add_u32 v2, s52, v2
    ds_write_b32 v2, v3
    s_waitcnt lgkmcnt(0)

    s_mov_b32 s28, s12
    s_and_b32 s29, s13, 0xffff
    s_mov_b32 s30, 0x1c0000
    s_mov_b32 s31, 0x20000
    s_cmp_ge_u32 s44, 2
    s_cselect_b32 s28, s14, s12
    s_cselect_b32 s29, s15, s13
    s_and_b32 s29, s29, 0xffff
    s_cmp_ge_u32 s46, 28
    s_cbranch_scc1 L_l_p2idle_X
L_l_p2idle_X:
    s_barrier
    s_cmp_ge_u32 s46, 28
    s_cbranch_scc1 L_l_b1_X
    s_add_u32 s63, s65, 0
    s_add_u32 m0, s64, 81920
    s_nop 0
    buffer_load_dwordx4 v11, s[28:31], s63 offen lds
    s_add_u32 s63, s65, 57344
    s_add_u32 m0, s64, 86016
    s_nop 0
    buffer_load_dwordx4 v11, s[28:31], s63 offen lds
    s_add_u32 s63, s65, 114688
    s_add_u32 m0, s64, 90112
    s_nop 0
    buffer_load_dwordx4 v11, s[28:31], s63 offen lds
    s_add_u32 s63, s65, 172032
    s_add_u32 m0, s64, 94208
    s_nop 0
    buffer_load_dwordx4 v11, s[28:31], s63 offen lds
L_l_b1_X:
    s_barrier
    s_cmp_ge_u32 s46, 28
    s_cbranch_scc1 L_l_b2_X
    s_add_u32 s63, s65, 229376
    s_add_u32 m0, s64, 98304
    s_nop 0
    buffer_load_dwordx4 v11, s[28:31], s63 offen lds
    s_add_u32 s63, s65, 286720
    s_add_u32 m0, s64, 102400
    s_nop 0
    buffer_load_dwordx4 v11, s[28:31], s63 offen lds
    s_add_u32 s63, s65, 344064
    s_add_u32 m0, s64, 106496
    s_nop 0
    buffer_load_dwordx4 v11, s[28:31], s63 offen lds
    s_add_u32 s63, s65, 401408
    s_add_u32 m0, s64, 110592
    s_nop 0
    buffer_load_dwordx4 v11, s[28:31], s63 offen lds
L_l_b2_X:
    s_cmp_ge_u32 s46, 28
    s_cbranch_scc1 L_l_wo0_X
    s_waitcnt vmcnt(8)
    s_branch L_l_wo1_X
L_l_wo0_X:
    s_waitcnt vmcnt(0)
L_l_wo1_X:
    s_barrier
    s_barrier
    s_cmp_ge_u32 s46, 28
    s_cbranch_scc1 L_l_b3_X
    s_add_u32 s63, s65, 458752
    s_add_u32 m0, s64, 114688
    s_nop 0
    buffer_load_dwordx4 v11, s[28:31], s63 offen lds
    s_add_u32 s63, s65, 516096
    s_add_u32 m0, s64, 118784
    s_nop 0
    buffer_load_dwordx4 v11, s[28:31], s63 offen lds
    s_add_u32 s63, s65, 573440
    s_add_u32 m0, s64, 122880
    s_nop 0
    buffer_load_dwordx4 v11, s[28:31], s63 offen lds
    s_add_u32 s63, s65, 630784
    s_add_u32 m0, s64, 126976
    s_nop 0
    buffer_load_dwordx4 v11, s[28:31], s63 offen lds
    s_add_u32 s63, s65, 688128
    s_add_u32 m0, s64, 131072
    s_nop 0
    buffer_load_dwordx4 v11, s[28:31], s63 offen lds
    s_add_u32 s63, s65, 745472
    s_add_u32 m0, s64, 135168
    s_nop 0
    buffer_load_dwordx4 v11, s[28:31], s63 offen lds
    s_add_u32 s63, s65, 802816
    s_add_u32 m0, s64, 139264
    s_nop 0
    buffer_load_dwordx4 v11, s[28:31], s63 offen lds
    s_add_u32 s63, s65, 860160
    s_add_u32 m0, s64, 143360
    s_nop 0
    buffer_load_dwordx4 v11, s[28:31], s63 offen lds
    s_add_u32 s63, s65, 917504
    s_add_u32 m0, s64, 147456
    s_nop 0
    buffer_load_dwordx4 v11, s[28:31], s63 offen lds
    s_add_u32 s63, s65, 974848
    s_add_u32 m0, s64, 151552
    s_nop 0
    buffer_load_dwordx4 v11, s[28:31], s63 offen lds
    s_add_u32 s63, s65, 1032192
    s_add_u32 m0, s64, 155648
    s_nop 0
    buffer_load_dwordx4 v11, s[28:31], s63 offen lds
L_l_b3_X:
    s_barrier
    s_mov_b32 s40, s16
    s_and_b32 s41, s17, 0xffff
    s_mov_b32 s42, 0x1c0000
    s_mov_b32 s43, 0x20000
    s_cmp_ge_u32 s46, 28
    s_cbranch_scc1 L_l_idle_X
    s_barrier
    s_add_u32 s63, s65, 1089536
    s_add_u32 m0, s64, 0
    s_nop 0
    buffer_load_dwordx4 v11, s[28:31], s63 offen lds
    s_add_u32 s63, s65, 1146880
    s_add_u32 m0, s64, 4096
    s_nop 0
    buffer_load_dwordx4 v11, s[28:31], s63 offen lds
    s_barrier
    s_add_u32 s63, s65, 1204224
    s_add_u32 m0, s64, 8192
    s_nop 0
    buffer_load_dwordx4 v11, s[28:31], s63 offen lds
    s_add_u32 s63, s65, 1261568
    s_add_u32 m0, s64, 12288
    s_nop 0
    buffer_load_dwordx4 v11, s[28:31], s63 offen lds
    s_add_u32 s63, s65, 1318912
    s_add_u32 m0, s64, 16384
    s_nop 0
    buffer_load_dwordx4 v11, s[28:31], s63 offen lds
    s_add_u32 s63, s65, 1376256
    s_add_u32 m0, s64, 20480
    s_nop 0
    buffer_load_dwordx4 v11, s[28:31], s63 offen lds
    s_add_u32 s63, s65, 1433600
    s_add_u32 m0, s64, 24576
    s_nop 0
    buffer_load_dwordx4 v11, s[28:31], s63 offen lds
    s_add_u32 s63, s65, 1490944
    s_add_u32 m0, s64, 28672
    s_nop 0
    buffer_load_dwordx4 v11, s[28:31], s63 offen lds
    s_add_u32 s63, s65, 1548288
    s_add_u32 m0, s64, 32768
    s_nop 0
    buffer_load_dwordx4 v11, s[28:31], s63 offen lds
    s_add_u32 s63, s65, 1605632
    s_add_u32 m0, s64, 36864
    s_nop 0
    buffer_load_dwordx4 v11, s[28:31], s63 offen lds
    s_barrier
    s_add_u32 s63, s65, 1662976
    s_add_u32 m0, s64, 40960
    s_nop 0
    buffer_load_dwordx4 v11, s[28:31], s63 offen lds
    s_add_u32 s63, s65, 1720320
    s_add_u32 m0, s64, 45056
    s_nop 0
    buffer_load_dwordx4 v11, s[28:31], s63 offen lds
    s_add_u32 s63, s65, 1777664
    s_add_u32 m0, s64, 49152
    s_nop 0
    buffer_load_dwordx4 v11, s[28:31], s63 offen lds
    s_add_u32 s63, s70, 0
    s_add_u32 m0, s64, 53248
    s_nop 0
    buffer_load_dwordx4 v11, s[28:31], s63 offen lds
    s_add_u32 s63, s70, 57344
    s_add_u32 m0, s64, 57344
    s_nop 0
    buffer_load_dwordx4 v11, s[28:31], s63 offen lds
    s_add_u32 s63, s70, 114688
    s_add_u32 m0, s64, 61440
    s_nop 0
    buffer_load_dwordx4 v11, s[28:31], s63 offen lds
    s_waitcnt vmcnt(0)
    s_barrier
    s_add_u32 s63, s70, 172032
    s_add_u32 m0, s64, 65536
    s_nop 0
    buffer_load_dwordx4 v11, s[28:31], s63 offen lds
    s_add_u32 s63, s70, 229376
    s_add_u32 m0, s64, 69632
    s_nop 0
    buffer_load_dwordx4 v11, s[28:31], s63 offen lds
    s_add_u32 s63, s70, 286720
    s_add_u32 m0, s64, 73728
    s_nop 0
    buffer_load_dwordx4 v11, s[28:31], s63 offen lds
    s_add_u32 s63, s70, 344064
    s_add_u32 m0, s64, 77824
    s_nop 0
    buffer_load_dwordx4 v11, s[28:31], s63 offen lds
    s_barrier
    s_add_u32 s63, s70, 401408
    s_add_u32 m0, s64, 81920
    s_nop 0
    buffer_load_dwordx4 v11, s[28:31], s63 offen lds
    s_add_u32 s63, s70, 458752
    s_add_u32 m0, s64, 86016
    s_nop 0
    buffer_load_dwordx4 v11, s[28:31], s63 offen lds
    s_add_u32 s63, s70, 516096
    s_add_u32 m0, s64, 90112
    s_nop 0
    buffer_load_dwordx4 v11, s[28:31], s63 offen lds
    s_add_u32 s63, s70, 573440
    s_add_u32 m0, s64, 94208
    s_nop 0
    buffer_load_dwordx4 v11, s[28:31], s63 offen lds
    s_barrier
    s_add_u32 s63, s70, 630784
    s_add_u32 m0, s64, 98304
    s_nop 0
    buffer_load_dwordx4 v11, s[28:31], s63 offen lds
    s_add_u32 s63, s70, 688128
    s_add_u32 m0, s64, 102400
    s_nop 0
    buffer_load_dwordx4 v11, s[28:31], s63 offen lds
    s_add_u32 s63, s70, 745472
    s_add_u32 m0, s64, 106496
    s_nop 0
    buffer_load_dwordx4 v11, s[28:31], s63 offen lds
    s_add_u32 s63, s70, 802816
    s_add_u32 m0, s64, 110592
    s_nop 0
    buffer_load_dwordx4 v11, s[28:31], s63 offen lds
    s_add_u32 s63, s70, 860160
    s_add_u32 m0, s64, 114688
    s_nop 0
    buffer_load_dwordx4 v11, s[28:31], s63 offen lds
    s_add_u32 s63, s70, 917504
    s_add_u32 m0, s64, 118784
    s_nop 0
    buffer_load_dwordx4 v11, s[28:31], s63 offen lds
    s_add_u32 s63, s70, 974848
    s_add_u32 m0, s64, 122880
    s_nop 0
    buffer_load_dwordx4 v11, s[28:31], s63 offen lds
    s_add_u32 s63, s70, 1032192
    s_add_u32 m0, s64, 126976
    s_nop 0
    buffer_load_dwordx4 v11, s[28:31], s63 offen lds
    s_barrier
    s_add_u32 s63, s70, 1089536
    s_add_u32 m0, s64, 131072
    s_nop 0
    buffer_load_dwordx4 v11, s[28:31], s63 offen lds
    s_add_u32 s63, s70, 1146880
    s_add_u32 m0, s64, 135168
    s_nop 0
    buffer_load_dwordx4 v11, s[28:31], s63 offen lds
    s_add_u32 s63, s70, 1204224
    s_add_u32 m0, s64, 139264
    s_nop 0
    buffer_load_dwordx4 v11, s[28:31], s63 offen lds
    s_add_u32 s63, s70, 1261568
    s_add_u32 m0, s64, 143360
    s_nop 0
    buffer_load_dwordx4 v11, s[28:31], s63 offen lds
    s_add_u32 s63, s70, 1318912
    s_add_u32 m0, s64, 147456
    s_nop 0
    buffer_load_dwordx4 v11, s[28:31], s63 offen lds
    s_add_u32 s63, s70, 1376256
    s_add_u32 m0, s64, 151552
    s_nop 0
    buffer_load_dwordx4 v11, s[28:31], s63 offen lds
    s_add_u32 s63, s70, 1433600
    s_add_u32 m0, s64, 155648
    s_nop 0
    buffer_load_dwordx4 v11, s[28:31], s63 offen lds
    s_add_u32 s63, s70, 1490944
    s_add_u32 m0, s64, 0
    s_nop 0
    buffer_load_dwordx4 v11, s[28:31], s63 offen lds
    s_waitcnt vmcnt(21)
    s_barrier
    s_add_u32 s63, s70, 1548288
    s_add_u32 m0, s64, 4096
    s_nop 0
    buffer_load_dwordx4 v11, s[28:31], s63 offen lds
    s_add_u32 s63, s70, 1605632
    s_add_u32 m0, s64, 8192
    s_nop 0
    buffer_load_dwordx4 v11, s[28:31], s63 offen lds
    s_add_u32 s63, s70, 1662976
    s_add_u32 m0, s64, 12288
    s_nop 0
    buffer_load_dwordx4 v11, s[28:31], s63 offen lds
    s_add_u32 s63, s70, 1720320
    s_add_u32 m0, s64, 16384
    s_nop 0
    buffer_load_dwordx4 v11, s[28:31], s63 offen lds
    s_add_u32 s63, s70, 1777664
    s_add_u32 m0, s64, 20480
    s_nop 0
    buffer_load_dwordx4 v11, s[28:31], s63 offen lds
    s_mov_b32 s63, 0
    s_add_u32 m0, s64, 24576
    s_nop 0
    buffer_load_dwordx4 v13, s[40:43], s63 offen lds
    s_mov_b32 s63, 131072
    s_add_u32 m0, s64, 28672
    s_nop 0
    buffer_load_dwordx4 v13, s[40:43], s63 offen lds
    s_mov_b32 s63, 262144
    s_add_u32 m0, s64, 32768
    s_nop 0
    buffer_load_dwordx4 v13, s[40:43], s63 offen lds
    s_waitcnt vmcnt(21)
    s_barrier
    s_mov_b32 s63, 393216
    s_add_u32 m0, s64, 36864
    s_nop 0
    buffer_load_dwordx4 v13, s[40:43], s63 offen lds
    s_mov_b32 s63, 524288
    s_add_u32 m0, s64, 40960
    s_nop 0
    buffer_load_dwordx4 v13, s[40:43], s63 offen lds
    s_mov_b32 s63, 655360
    s_add_u32 m0, s64, 45056
    s_nop 0
    buffer_load_dwordx4 v13, s[40:43], s63 offen lds
    s_mov_b32 s63, 786432
    s_add_u32 m0, s64, 49152
    s_nop 0
    buffer_load_dwordx4 v13, s[40:43], s63 offen lds
    s_waitcnt vmcnt(17)
    s_barrier
    s_waitcnt vmcnt(7)
    s_barrier
    s_barrier
    s_mov_b32 s63, 917504
    s_add_u32 m0, s64, 53248
    s_nop 0
    buffer_load_dwordx4 v13, s[40:43], s63 offen lds
    s_mov_b32 s63, 1048576
    s_add_u32 m0, s64, 57344
    s_nop 0
    buffer_load_dwordx4 v13, s[40:43], s63 offen lds
    s_mov_b32 s63, 1179648
    s_add_u32 m0, s64, 61440
    s_nop 0
    buffer_load_dwordx4 v13, s[40:43], s63 offen lds
    s_mov_b32 s63, 1310720
    s_add_u32 m0, s64, 65536
    s_nop 0
    buffer_load_dwordx4 v13, s[40:43], s63 offen lds
    s_barrier
    s_mov_b32 s63, 1441792
    s_add_u32 m0, s64, 69632
    s_nop 0
    buffer_load_dwordx4 v13, s[40:43], s63 offen lds
    s_mov_b32 s63, 1572864
    s_add_u32 m0, s64, 73728
    s_nop 0
    buffer_load_dwordx4 v13, s[40:43], s63 offen lds
    s_mov_b32 s63, 1703936
    s_add_u32 m0, s64, 77824
    s_nop 0
    buffer_load_dwordx4 v13, s[40:43], s63 offen lds
    s_mov_b32 s63, 32768
    s_add_u32 m0, s64, 81920
    s_nop 0
    buffer_load_dwordx4 v13, s[40:43], s63 offen lds
    s_mov_b32 s63, 163840
    s_add_u32 m0, s64, 86016
    s_nop 0
    buffer_load_dwordx4 v13, s[40:43], s63 offen lds
    s_mov_b32 s63, 294912
    s_add_u32 m0, s64, 90112
    s_nop 0
    buffer_load_dwordx4 v13, s[40:43], s63 offen lds
    s_mov_b32 s63, 425984
    s_add_u32 m0, s64, 94208
    s_nop 0
    buffer_load_dwordx4 v13, s[40:43], s63 offen lds
    s_mov_b32 s63, 557056
    s_add_u32 m0, s64, 98304
    s_nop 0
    buffer_load_dwordx4 v13, s[40:43], s63 offen lds
    s_barrier
    s_mov_b32 s63, 688128
    s_add_u32 m0, s64, 102400
    s_nop 0
    buffer_load_dwordx4 v13, s[40:43], s63 offen lds
    s_mov_b32 s63, 819200
    s_add_u32 m0, s64, 106496
    s_nop 0
    buffer_load_dwordx4 v13, s[40:43], s63 offen lds
    s_mov_b32 s63, 950272
    s_add_u32 m0, s64, 110592
    s_nop 0
    buffer_load_dwordx4 v13, s[40:43], s63 offen lds
    s_mov_b32 s63, 1081344
    s_add_u32 m0, s64, 114688
    s_nop 0
    buffer_load_dwordx4 v13, s[40:43], s63 offen lds
    s_mov_b32 s63, 1212416
    s_add_u32 m0, s64, 118784
    s_nop 0
    buffer_load_dwordx4 v13, s[40:43], s63 offen lds
    s_mov_b32 s63, 1343488
    s_add_u32 m0, s64, 122880
    s_nop 0
    buffer_load_dwordx4 v13, s[40:43], s63 offen lds
    s_mov_b32 s63, 1474560
    s_add_u32 m0, s64, 126976
    s_nop 0
    buffer_load_dwordx4 v13, s[40:43], s63 offen lds
    s_mov_b32 s63, 1605632
    s_add_u32 m0, s64, 131072
    s_nop 0
    buffer_load_dwordx4 v13, s[40:43], s63 offen lds
    s_barrier
    s_mov_b32 s63, 1736704
    s_add_u32 m0, s64, 135168
    s_nop 0
    buffer_load_dwordx4 v13, s[40:43], s63 offen lds
    s_mov_b32 s63, 65536
    s_add_u32 m0, s64, 139264
    s_nop 0
    buffer_load_dwordx4 v13, s[40:43], s63 offen lds
    s_mov_b32 s63, 196608
    s_add_u32 m0, s64, 143360
    s_nop 0
    buffer_load_dwordx4 v13, s[40:43], s63 offen lds
    s_mov_b32 s63, 327680
    s_add_u32 m0, s64, 147456
    s_nop 0
    buffer_load_dwordx4 v13, s[40:43], s63 offen lds
    s_mov_b32 s63, 458752
    s_add_u32 m0, s64, 151552
    s_nop 0
    buffer_load_dwordx4 v13, s[40:43], s63 offen lds
    s_mov_b32 s63, 589824
    s_add_u32 m0, s64, 155648
    s_nop 0
    buffer_load_dwordx4 v13, s[40:43], s63 offen lds
    s_mov_b32 s63, 720896
    s_add_u32 m0, s64, 0
    s_nop 0
    buffer_load_dwordx4 v13, s[40:43], s63 offen lds
    s_mov_b32 s63, 851968
    s_add_u32 m0, s64, 4096
    s_nop 0
    buffer_load_dwordx4 v13, s[40:43], s63 offen lds
    s_waitcnt vmcnt(26)
    s_branch L_l_p4_X
L_l_idle_X:
    s_waitcnt vmcnt(0)
    s_barrier
    s_barrier
    s_barrier
    s_barrier
    s_sub_u32 s52, s46, 28
    s_lshl_b32 s52, s52, 2
    s_add_u32 s52, s52, s44
    s_mul_i32 s52, s52, 112
    v_add_u32 v52, s52, v1
    v_lshlrev_b32 v52, 10, v52
    v_add_u32 v52, 384, v52
    v_add_u32 v54, 0x10000, v52

    buffer_load_dword v53, v52, s[40:43], 0 offen
    s_mov_b32 exec_lo, -1
    s_mov_b32 exec_hi, 0xffff
    buffer_load_dword v53, v54, s[40:43], 0 offen
    s_mov_b64 exec, -1
    s_mov_b32 s63, 0
    s_add_u32 m0, s64, 24576
    s_nop 0
    buffer_load_dwordx4 v13, s[40:43], s63 offen lds
    s_mov_b32 s63, 131072
    s_add_u32 m0, s64, 28672
    s_nop 0
    buffer_load_dwordx4 v13, s[40:43], s63 offen lds
    s_mov_b32 s63, 262144
    s_add_u32 m0, s64, 32768
    s_nop 0
    buffer_load_dwordx4 v13, s[40:43], s63 offen lds
    s_mov_b32 s63, 393216
    s_add_u32 m0, s64, 36864
    s_nop 0
    buffer_load_dwordx4 v13, s[40:43], s63 offen lds
    s_mov_b32 s63, 524288
    s_add_u32 m0, s64, 40960
    s_nop 0
    buffer_load_dwordx4 v13, s[40:43], s63 offen lds
    s_mov_b32 s63, 655360
    s_add_u32 m0, s64, 45056
    s_nop 0
    buffer_load_dwordx4 v13, s[40:43], s63 offen lds
    s_mov_b32 s63, 786432
    s_add_u32 m0, s64, 49152
    s_nop 0
    buffer_load_dwordx4 v13, s[40:43], s63 offen lds
    s_mov_b32 s63, 917504
    s_add_u32 m0, s64, 53248
    s_nop 0
    buffer_load_dwordx4 v13, s[40:43], s63 offen lds
    s_mov_b32 s63, 1048576
    s_add_u32 m0, s64, 57344
    s_nop 0
    buffer_load_dwordx4 v13, s[40:43], s63 offen lds
    s_waitcnt vmcnt(8)
    s_mov_b32 s63, 1179648
    s_add_u32 m0, s64, 61440
    s_nop 0
    buffer_load_dwordx4 v13, s[40:43], s63 offen lds
    s_waitcnt vmcnt(8)
    s_mov_b32 s63, 1310720
    s_add_u32 m0, s64, 65536
    s_nop 0
    buffer_load_dwordx4 v13, s[40:43], s63 offen lds
    s_waitcnt vmcnt(8)
    s_mov_b32 s63, 1441792
    s_add_u32 m0, s64, 69632
    s_nop 0
    buffer_load_dwordx4 v13, s[40:43], s63 offen lds
    s_waitcnt vmcnt(8)
    s_mov_b32 s63, 1572864
    s_add_u32 m0, s64, 73728
    s_nop 0
    buffer_load_dwordx4 v13, s[40:43], s63 offen lds
    s_waitcnt vmcnt(8)
    s_mov_b32 s63, 1703936
    s_add_u32 m0, s64, 77824
    s_nop 0
    buffer_load_dwordx4 v13, s[40:43], s63 offen lds
    s_waitcnt vmcnt(8)
    s_mov_b32 s63, 32768
    s_add_u32 m0, s64, 81920
    s_nop 0
    buffer_load_dwordx4 v13, s[40:43], s63 offen lds
    s_waitcnt vmcnt(8)
    s_mov_b32 s63, 163840
    s_add_u32 m0, s64, 86016
    s_nop 0
    buffer_load_dwordx4 v13, s[40:43], s63 offen lds
    s_waitcnt vmcnt(8)
    s_mov_b32 s63, 294912
    s_add_u32 m0, s64, 90112
    s_nop 0
    buffer_load_dwordx4 v13, s[40:43], s63 offen lds
    s_waitcnt vmcnt(8)
    s_mov_b32 s63, 425984
    s_add_u32 m0, s64, 94208
    s_nop 0
    buffer_load_dwordx4 v13, s[40:43], s63 offen lds
    s_waitcnt vmcnt(8)
    s_mov_b32 s63, 557056
    s_add_u32 m0, s64, 98304
    s_nop 0
    buffer_load_dwordx4 v13, s[40:43], s63 offen lds
    s_waitcnt vmcnt(8)
    s_mov_b32 s63, 688128
    s_add_u32 m0, s64, 102400
    s_nop 0
    buffer_load_dwordx4 v13, s[40:43], s63 offen lds
    s_waitcnt vmcnt(8)
    s_mov_b32 s63, 819200
    s_add_u32 m0, s64, 106496
    s_nop 0
    buffer_load_dwordx4 v13, s[40:43], s63 offen lds
    s_waitcnt vmcnt(8)
    s_mov_b32 s63, 950272
    s_add_u32 m0, s64, 110592
    s_nop 0
    buffer_load_dwordx4 v13, s[40:43], s63 offen lds
    s_waitcnt vmcnt(8)
    s_mov_b32 s63, 1081344
    s_add_u32 m0, s64, 114688
    s_nop 0
    buffer_load_dwordx4 v13, s[40:43], s63 offen lds
    s_waitcnt vmcnt(8)
    s_mov_b32 s63, 1212416
    s_add_u32 m0, s64, 118784
    s_nop 0
    buffer_load_dwordx4 v13, s[40:43], s63 offen lds
    s_waitcnt vmcnt(8)
    s_mov_b32 s63, 1343488
    s_add_u32 m0, s64, 122880
    s_nop 0
    buffer_load_dwordx4 v13, s[40:43], s63 offen lds
    s_waitcnt vmcnt(8)
    s_mov_b32 s63, 1474560
    s_add_u32 m0, s64, 126976
    s_nop 0
    buffer_load_dwordx4 v13, s[40:43], s63 offen lds
    s_waitcnt vmcnt(8)
    s_mov_b32 s63, 1605632
    s_add_u32 m0, s64, 131072
    s_nop 0
    buffer_load_dwordx4 v13, s[40:43], s63 offen lds
    s_waitcnt vmcnt(8)
    s_mov_b32 s63, 1736704
    s_add_u32 m0, s64, 135168
    s_nop 0
    buffer_load_dwordx4 v13, s[40:43], s63 offen lds
    s_waitcnt vmcnt(8)
    s_mov_b32 s63, 65536
    s_add_u32 m0, s64, 139264
    s_nop 0
    buffer_load_dwordx4 v13, s[40:43], s63 offen lds
    s_waitcnt vmcnt(8)
    s_mov_b32 s63, 196608
    s_add_u32 m0, s64, 143360
    s_nop 0
    buffer_load_dwordx4 v13, s[40:43], s63 offen lds
    s_waitcnt vmcnt(8)
    s_mov_b32 s63, 327680
    s_add_u32 m0, s64, 147456
    s_nop 0
    buffer_load_dwordx4 v13, s[40:43], s63 offen lds
    s_waitcnt vmcnt(8)
    s_mov_b32 s63, 458752
    s_add_u32 m0, s64, 151552
    s_nop 0
    buffer_load_dwordx4 v13, s[40:43], s63 offen lds
    s_waitcnt vmcnt(8)
    s_mov_b32 s63, 589824
    s_add_u32 m0, s64, 155648
    s_nop 0
    buffer_load_dwordx4 v13, s[40:43], s63 offen lds
    s_waitcnt vmcnt(8)
    s_mov_b32 s63, 720896
    s_add_u32 m0, s64, 0
    s_nop 0
    buffer_load_dwordx4 v13, s[40:43], s63 offen lds
    s_waitcnt vmcnt(8)
    s_mov_b32 s63, 851968
    s_add_u32 m0, s64, 4096
    s_nop 0
    buffer_load_dwordx4 v13, s[40:43], s63 offen lds
    s_waitcnt vmcnt(8)
    s_mov_b32 s63, 983040
    s_add_u32 m0, s64, 8192
    s_nop 0
    buffer_load_dwordx4 v13, s[40:43], s63 offen lds
    s_waitcnt vmcnt(8)
    s_mov_b32 s63, 1114112
    s_add_u32 m0, s64, 12288
    s_nop 0
    buffer_load_dwordx4 v13, s[40:43], s63 offen lds
    s_waitcnt vmcnt(8)
    s_mov_b32 s63, 1245184
    s_add_u32 m0, s64, 16384
    s_nop 0
    buffer_load_dwordx4 v13, s[40:43], s63 offen lds
    s_waitcnt vmcnt(8)
    s_mov_b32 s63, 1376256
    s_add_u32 m0, s64, 20480
    s_nop 0
    buffer_load_dwordx4 v13, s[40:43], s63 offen lds
    s_waitcnt vmcnt(8)
    s_waitcnt vmcnt(0)
L_l_p4_X:
    s_barrier
    s_cmp_ge_u32 s46, 28
    s_cbranch_scc1 L_l_p4b_X
    s_mov_b32 s63, 983040
    s_add_u32 m0, s64, 8192
    s_nop 0
    buffer_load_dwordx4 v13, s[40:43], s63 offen lds
    s_mov_b32 s63, 1114112
    s_add_u32 m0, s64, 12288
    s_nop 0
    buffer_load_dwordx4 v13, s[40:43], s63 offen lds
    s_mov_b32 s63, 1245184
    s_add_u32 m0, s64, 16384
    s_nop 0
    buffer_load_dwordx4 v13, s[40:43], s63 offen lds
    s_mov_b32 s63, 1376256
    s_add_u32 m0, s64, 20480
    s_nop 0
    buffer_load_dwordx4 v13, s[40:43], s63 offen lds
L_l_p4b_X:
    s_waitcnt vmcnt(22)
    s_barrier
    s_mov_b32 s63, 1507328
    s_add_u32 m0, s64, 24576
    s_nop 0
    buffer_load_dwordx4 v13, s[40:43], s63 offen lds
    s_mov_b32 s63, 1638400
    s_add_u32 m0, s64, 28672
    s_nop 0
    buffer_load_dwordx4 v13, s[40:43], s63 offen lds
    s_mov_b32 s63, 1769472
    s_add_u32 m0, s64, 32768
    s_nop 0
    buffer_load_dwordx4 v13, s[40:43], s63 offen lds
    s_mov_b32 s63, 98304
    s_add_u32 m0, s64, 36864
    s_nop 0
    buffer_load_dwordx4 v13, s[40:43], s63 offen lds
    s_mov_b32 s63, 229376
    s_add_u32 m0, s64, 40960
    s_nop 0
    buffer_load_dwordx4 v13, s[40:43], s63 offen lds
    s_mov_b32 s63, 360448
    s_add_u32 m0, s64, 45056
    s_nop 0
    buffer_load_dwordx4 v13, s[40:43], s63 offen lds
    s_mov_b32 s63, 491520
    s_add_u32 m0, s64, 49152
    s_nop 0
    buffer_load_dwordx4 v13, s[40:43], s63 offen lds
    s_mov_b32 s63, 622592
    s_add_u32 m0, s64, 53248
    s_nop 0
    buffer_load_dwordx4 v13, s[40:43], s63 offen lds
    s_waitcnt vmcnt(22)
    s_barrier
    s_mov_b32 s63, 753664
    s_add_u32 m0, s64, 57344
    s_nop 0
    buffer_load_dwordx4 v13, s[40:43], s63 offen lds
    s_mov_b32 s63, 884736
    s_add_u32 m0, s64, 61440
    s_nop 0
    buffer_load_dwordx4 v13, s[40:43], s63 offen lds
    s_mov_b32 s63, 1015808
    s_add_u32 m0, s64, 65536
    s_nop 0
    buffer_load_dwordx4 v13, s[40:43], s63 offen lds
    s_mov_b32 s63, 1146880
    s_add_u32 m0, s64, 69632
    s_nop 0
    buffer_load_dwordx4 v13, s[40:43], s63 offen lds
    s_mov_b32 s63, 1277952
    s_add_u32 m0, s64, 73728
    s_nop 0
    buffer_load_dwordx4 v13, s[40:43], s63 offen lds
    s_mov_b32 s63, 1409024
    s_add_u32 m0, s64, 77824
    s_nop 0
    buffer_load_dwordx4 v13, s[40:43], s63 offen lds
    s_mov_b32 s63, 1540096
    s_add_u32 m0, s64, 81920
    s_nop 0
    buffer_load_dwordx4 v13, s[40:43], s63 offen lds
    s_mov_b32 s63, 1671168
    s_add_u32 m0, s64, 86016
    s_nop 0
    buffer_load_dwordx4 v13, s[40:43], s63 offen lds
    s_waitcnt vmcnt(22)
    s_barrier
    s_mov_b32 s63, 1802240
    s_add_u32 m0, s64, 90112
    s_nop 0
    buffer_load_dwordx4 v13, s[40:43], s63 offen lds
    s_waitcnt vmcnt(15)
    s_barrier
    s_waitcnt vmcnt(7)
    s_barrier
    s_waitcnt vmcnt(0)
    s_barrier
    s_barrier
    s_barrier
L_fin:
L_end:
    s_endpgm
L_code_end:
L_c_global:
    v_cvt_pk_bf16_f32 v72, v20, v21
    v_cvt_pk_bf16_f32 v73, v22, v23
    v_cvt_pk_bf16_f32 v84, v40, v41
    v_cvt_pk_bf16_f32 v85, v42, v43
    v_cvt_pk_bf16_f32 v74, v24, v25
    v_cvt_pk_bf16_f32 v75, v26, v27
    v_cvt_pk_bf16_f32 v86, v44, v45
    v_cvt_pk_bf16_f32 v87, v46, v47
    v_cvt_pk_bf16_f32 v64, v4, v5
    v_cvt_pk_bf16_f32 v65, v6, v7
    v_cvt_pk_bf16_f32 v76, v28, v29
    v_cvt_pk_bf16_f32 v77, v30, v31
    v_cvt_pk_bf16_f32 v88, v48, v49
    v_cvt_pk_bf16_f32 v89, v50, v51
    v_cvt_pk_bf16_f32 v66, v8, v9
    v_cvt_pk_bf16_f32 v67, v10, v11
    v_cvt_pk_bf16_f32 v78, v32, v33
    v_cvt_pk_bf16_f32 v79, v34, v35
    v_cvt_pk_bf16_f32 v90, v52, v53
    v_cvt_pk_bf16_f32 v91, v54, v55
    v_cvt_pk_bf16_f32 v68, v12, v13
    v_cvt_pk_bf16_f32 v69, v14, v15
    v_cvt_pk_bf16_f32 v80, v36, v37
    v_cvt_pk_bf16_f32 v81, v38, v39
    v_cvt_pk_bf16_f32 v92, v56, v57
    v_cvt_pk_bf16_f32 v93, v58, v59
    v_cvt_pk_bf16_f32 v70, v16, v17
    v_cvt_pk_bf16_f32 v71, v18, v19
    s_nop 1
    v_mfma_f32_16x16x16_bf16 v[4:7], v[74:75], v[64:65], 0
    v_mfma_f32_16x16x16_bf16 v[20:23], v[72:73], v[64:65], 0
    v_mfma_f32_16x16x16_bf16 v[8:11], v[76:77], v[66:67], 0
    v_mfma_f32_16x16x16_bf16 v[24:27], v[74:75], v[66:67], 0
    v_mfma_f32_16x16x16_bf16 v[12:15], v[78:79], v[68:69], 0
    v_mfma_f32_16x16x16_bf16 v[28:31], v[76:77], v[68:69], 0
    v_mfma_f32_16x16x16_bf16 v[16:19], v[80:81], v[70:71], 0
    v_mfma_f32_16x16x16_bf16 v[32:35], v[78:79], v[70:71], 0
    s_nop 4
    v_cndmask_b32 v36, v4, v5, s[80:81]
    v_cndmask_b32 v48, v20, v21, s[80:81]
    v_cndmask_b32 v40, v6, v7, s[80:81]
    v_cndmask_b32 v52, v22, v23, s[80:81]
    v_cndmask_b32 v37, v8, v9, s[80:81]
    v_cndmask_b32 v49, v24, v25, s[80:81]
    v_cndmask_b32 v41, v10, v11, s[80:81]
    v_cndmask_b32 v53, v26, v27, s[80:81]
    v_cndmask_b32 v38, v12, v13, s[80:81]
    v_cndmask_b32 v50, v28, v29, s[80:81]
    v_cndmask_b32 v42, v14, v15, s[80:81]
    v_cndmask_b32 v54, v30, v31, s[80:81]
    v_cndmask_b32 v39, v16, v17, s[80:81]
    v_cndmask_b32 v51, v32, v33, s[80:81]
    v_cndmask_b32 v43, v18, v19, s[80:81]
    v_cndmask_b32 v55, v34, v35, s[80:81]
    v_cndmask_b32 v36, v48, v36, s[82:83]
    v_cndmask_b32 v40, v52, v40, s[84:85]
    v_cndmask_b32 v37, v49, v37, s[82:83]
    v_cndmask_b32 v41, v53, v41, s[84:85]
    v_cndmask_b32 v38, v50, v38, s[82:83]
    v_cndmask_b32 v42, v54, v42, s[84:85]
    v_cndmask_b32 v39, v51, v39, s[82:83]
    v_cndmask_b32 v43, v55, v43, s[84:85]
    v_add_f32 v36, v36, v152
    v_add_f32 v40, v40, v153
    v_max_f32 v44, v36, v40
    v_max_f32 v45, v37, v41
    v_max_f32 v46, v38, v42
    v_max_f32 v47, v39, v43
    v_mov_b32 v48, v44
    v_mov_b32 v49, v45
    v_mov_b32 v50, v46
    v_mov_b32 v51, v47
    s_nop 0
    v_permlane16_swap_b32 v44, v48
    v_permlane16_swap_b32 v45, v49
    v_permlane16_swap_b32 v46, v50
    v_permlane16_swap_b32 v47, v51
    s_nop 0
    v_max_f32 v44, v44, v48
    v_max_f32 v45, v45, v49
    v_max_f32 v46, v46, v50
    v_max_f32 v47, v47, v51
    v_mov_b32 v48, v44
    v_mov_b32 v49, v45
    v_mov_b32 v50, v46
    v_mov_b32 v51, v47
    s_nop 0
    v_permlane32_swap_b32 v44, v48
    v_permlane32_swap_b32 v45, v49
    v_permlane32_swap_b32 v46, v50
    v_permlane32_swap_b32 v47, v51
    s_nop 0
    v_max_f32 v44, v44, v48
    v_max_f32 v45, v45, v49
    v_max_f32 v46, v46, v50
    v_max_f32 v47, v47, v51
    s_mov_b32 s54, 0x3eb8aa3b
    v_mul_f32 v44, s54, v44
    v_mul_f32 v45, s54, v45
    v_mul_f32 v46, s54, v46
    v_mul_f32 v47, s54, v47
    v_fma_f32 v36, v36, s54, -v44
    v_fma_f32 v40, v40, s54, -v44
    v_fma_f32 v37, v37, s54, -v45
    v_fma_f32 v41, v41, s54, -v45
    v_fma_f32 v38, v38, s54, -v46
    v_fma_f32 v42, v42, s54, -v46
    v_fma_f32 v39, v39, s54, -v47
    v_fma_f32 v43, v43, s54, -v47
    v_exp_f32 v36, v36
    v_exp_f32 v40, v40
    v_exp_f32 v37, v37
    v_exp_f32 v41, v41
    v_exp_f32 v38, v38
    v_exp_f32 v42, v42
    v_exp_f32 v39, v39
    v_exp_f32 v43, v43
    s_nop 0
    v_add_f32 v44, v36, v40
    v_add_f32 v45, v37, v41
    v_add_f32 v46, v38, v42
    v_add_f32 v47, v39, v43
    v_mov_b32 v48, v44
    v_mov_b32 v49, v45
    v_mov_b32 v50, v46
    v_mov_b32 v51, v47
    s_nop 0
    v_permlane16_swap_b32 v44, v48
    v_permlane16_swap_b32 v45, v49
    v_permlane16_swap_b32 v46, v50
    v_permlane16_swap_b32 v47, v51
    s_nop 0
    v_add_f32 v44, v44, v48
    v_add_f32 v45, v45, v49
    v_add_f32 v46, v46, v50
    v_add_f32 v47, v47, v51
    v_mov_b32 v48, v44
    v_mov_b32 v49, v45
    v_mov_b32 v50, v46
    v_mov_b32 v51, v47
    s_nop 0
    v_permlane32_swap_b32 v44, v48
    v_permlane32_swap_b32 v45, v49
    v_permlane32_swap_b32 v46, v50
    v_permlane32_swap_b32 v47, v51
    s_nop 0
    v_add_f32 v44, v44, v48
    v_add_f32 v45, v45, v49
    v_add_f32 v46, v46, v50
    v_add_f32 v47, v47, v51
    v_rcp_f32 v44, v44
    v_rcp_f32 v45, v45
    v_rcp_f32 v46, v46
    v_rcp_f32 v47, v47
    s_nop 0
    v_mul_f32 v36, v36, v44
    v_mul_f32 v40, v40, v44
    v_mul_f32 v37, v37, v45
    v_mul_f32 v41, v41, v45
    v_mul_f32 v38, v38, v46
    v_mul_f32 v42, v42, v46
    v_mul_f32 v39, v39, v47
    v_mul_f32 v43, v43, v47
    v_cvt_pk_bf16_f32 v48, v36, v40
    v_cvt_pk_bf16_f32 v49, v37, v41
    v_cvt_pk_bf16_f32 v50, v38, v42
    v_cvt_pk_bf16_f32 v51, v39, v43
    s_nop 0
    v_perm_b32 v4, v48, v48, v146
    v_perm_b32 v5, v48, v48, v147
    v_perm_b32 v6, v48, v48, v148
    v_perm_b32 v7, v48, v48, v149
    v_perm_b32 v8, v49, v49, v146
    v_perm_b32 v9, v49, v49, v147
    v_perm_b32 v10, v49, v49, v148
    v_perm_b32 v11, v49, v49, v149
    v_perm_b32 v12, v50, v50, v146
    v_perm_b32 v13, v50, v50, v147
    v_perm_b32 v14, v50, v50, v148
    v_perm_b32 v15, v50, v50, v149
    v_perm_b32 v16, v51, v51, v146
    v_perm_b32 v17, v51, v51, v147
    v_perm_b32 v18, v51, v51, v148
    v_perm_b32 v19, v51, v51, v149
    s_nop 1
    v_mfma_f32_16x16x32_bf16 v[20:23], v[84:87], v[4:7], 0
    v_mfma_f32_16x16x32_bf16 v[24:27], v[86:89], v[8:11], 0
    v_mfma_f32_16x16x32_bf16 v[28:31], v[88:91], v[12:15], 0
    v_mfma_f32_16x16x32_bf16 v[32:35], v[90:93], v[16:19], 0
    s_nop 4
    v_cvt_pk_bf16_f32 v36, v20, v21
    v_cvt_pk_bf16_f32 v37, v22, v23
    v_cvt_pk_bf16_f32 v38, v24, v25
    v_cvt_pk_bf16_f32 v39, v26, v27
    v_cvt_pk_bf16_f32 v40, v28, v29
    v_cvt_pk_bf16_f32 v41, v30, v31
    v_cvt_pk_bf16_f32 v42, v32, v33
    v_cvt_pk_bf16_f32 v43, v34, v35
    buffer_store_dwordx2 v[36:37], v154, s[32:35], s60 offen offset:0 sc1
    buffer_store_dwordx2 v[38:39], v154, s[32:35], s60 offen offset:256 sc1
    buffer_store_dwordx2 v[40:41], v154, s[32:35], s61 offen offset:0 sc1
    buffer_store_dwordx2 v[42:43], v154, s[32:35], s61 offen offset:256 sc1
    s_barrier
    s_waitcnt vmcnt(0)
    s_lshl_b32 s53, s45, 12
    s_lshl_b32 s54, s46, 4
    s_add_u32 s53, s53, s54
    s_lshl_b32 s54, s44, 2
    s_add_u32 s53, s53, s54
    s_add_u32 s53, s53, 65536
    v_mov_b32 v252, s49
    v_mov_b32 v253, 0
    s_mov_b64 exec, 1

    buffer_store_dword v252, v253, s[32:35], s53 offen sc1
    s_mov_b64 exec, -1
    s_barrier
    v_mov_b32 v253, v157
    s_mov_b32 s72, 0
    s_mov_b64 exec, 0xffff
L_f1_G:
    buffer_load_dword v252, v253, s[32:35], 0 offen sc1
    s_add_u32 s72, s72, 1
    s_waitcnt vmcnt(0)
    v_cmp_ne_u32 vcc, s49, v252
    s_cmp_gt_u32 s72, 0x100000
    s_cbranch_scc1 L_f1_G_out
    s_cbranch_vccnz L_f1_G
L_f1_G_out:
    s_mov_b64 exec, -1
    buffer_load_dwordx4 v[64:67], v0, s[32:35], s62 offen offset:0 sc1
    buffer_load_dwordx4 v[68:71], v0, s[32:35], s62 offen offset:1024 sc1
    buffer_load_dwordx4 v[72:75], v0, s[32:35], s62 offen offset:2048 sc1
    buffer_load_dwordx4 v[76:79], v0, s[32:35], s62 offen offset:3072 sc1
    s_barrier
    ds_read_b64_tr_b16 v[128:129], v234 offset:0
    ds_read_b64_tr_b16 v[130:131], v234 offset:1024
    ds_read_b64_tr_b16 v[132:133], v235 offset:0
    ds_read_b64_tr_b16 v[134:135], v235 offset:1024
    ds_read_b64_tr_b16 v[136:137], v234 offset:2048
    ds_read_b64_tr_b16 v[138:139], v234 offset:3072
    ds_read_b64_tr_b16 v[140:141], v235 offset:2048
    ds_read_b64_tr_b16 v[142:143], v235 offset:3072
    ds_read_b64_tr_b16 v[144:145], v234 offset:4096
    ds_read_b64_tr_b16 v[146:147], v234 offset:5120
    s_add_u32 s62, s62, 4096
    buffer_load_dwordx4 v[80:83], v0, s[32:35], s62 offen offset:0 sc1
    s_waitcnt vmcnt(4)
    s_waitcnt lgkmcnt(8)
    v_mfma_f32_32x32x16_bf16 v[4:19], v[128:131], v[64:67], 0
    ds_read_b64_tr_b16 v[148:149], v235 offset:4096
    ds_read_b64_tr_b16 v[150:151], v235 offset:5120
    s_waitcnt lgkmcnt(8)
    v_mfma_f32_32x32x16_bf16 v[20:35], v[132:135], v[64:67], 0
    ds_read_b64_tr_b16 v[128:129], v234 offset:6144
    ds_read_b64_tr_b16 v[130:131], v234 offset:7168
    buffer_load_dwordx4 v[84:87], v0, s[32:35], s62 offen offset:1024 sc1
    s_waitcnt vmcnt(4)
    s_waitcnt lgkmcnt(8)
    v_mfma_f32_32x32x16_bf16 v[4:19], v[136:139], v[68:71], v[4:19]
    ds_read_b64_tr_b16 v[132:133], v235 offset:6144
    ds_read_b64_tr_b16 v[134:135], v235 offset:7168
    s_waitcnt lgkmcnt(8)
    v_mfma_f32_32x32x16_bf16 v[20:35], v[140:143], v[68:71], v[20:35]
    ds_read_b64_tr_b16 v[136:137], v234 offset:8192
    ds_read_b64_tr_b16 v[138:139], v234 offset:9216
    buffer_load_dwordx4 v[88:91], v0, s[32:35], s62 offen offset:2048 sc1
    s_waitcnt vmcnt(4)
    s_waitcnt lgkmcnt(8)
    v_mfma_f32_32x32x16_bf16 v[4:19], v[144:147], v[72:75], v[4:19]
    ds_read_b64_tr_b16 v[140:141], v235 offset:8192
    ds_read_b64_tr_b16 v[142:143], v235 offset:9216
    s_waitcnt lgkmcnt(8)
    v_mfma_f32_32x32x16_bf16 v[20:35], v[148:151], v[72:75], v[20:35]
    ds_read_b64_tr_b16 v[144:145], v234 offset:10240
    ds_read_b64_tr_b16 v[146:147], v234 offset:11264
    buffer_load_dwordx4 v[92:95], v0, s[32:35], s62 offen offset:3072 sc1
    s_waitcnt vmcnt(4)
    s_waitcnt lgkmcnt(8)
    v_mfma_f32_32x32x16_bf16 v[4:19], v[128:131], v[76:79], v[4:19]
    ds_read_b64_tr_b16 v[148:149], v235 offset:10240
    ds_read_b64_tr_b16 v[150:151], v235 offset:11264
    s_waitcnt lgkmcnt(8)
    v_mfma_f32_32x32x16_bf16 v[20:35], v[132:135], v[76:79], v[20:35]
    ds_read_b64_tr_b16 v[128:129], v234 offset:12288
    ds_read_b64_tr_b16 v[130:131], v234 offset:13312
    s_add_u32 s62, s62, 4096
    buffer_load_dwordx4 v[96:99], v0, s[32:35], s62 offen offset:0 sc1
    s_waitcnt vmcnt(4)
    s_waitcnt lgkmcnt(8)
    v_mfma_f32_32x32x16_bf16 v[4:19], v[136:139], v[80:83], v[4:19]
    ds_read_b64_tr_b16 v[132:133], v235 offset:12288
    ds_read_b64_tr_b16 v[134:135], v235 offset:13312
    s_waitcnt lgkmcnt(8)
    v_mfma_f32_32x32x16_bf16 v[20:35], v[140:143], v[80:83], v[20:35]
    ds_read_b64_tr_b16 v[136:137], v234 offset:14336
    ds_read_b64_tr_b16 v[138:139], v234 offset:15360
    buffer_load_dwordx4 v[100:103], v0, s[32:35], s62 offen offset:1024 sc1
    s_waitcnt vmcnt(4)
    s_waitcnt lgkmcnt(8)
    v_mfma_f32_32x32x16_bf16 v[4:19], v[144:147], v[84:87], v[4:19]
    ds_read_b64_tr_b16 v[140:141], v235 offset:14336
    ds_read_b64_tr_b16 v[142:143], v235 offset:15360
    s_waitcnt lgkmcnt(8)
    v_mfma_f32_32x32x16_bf16 v[20:35], v[148:151], v[84:87], v[20:35]
    ds_read_b64_tr_b16 v[144:145], v234 offset:16384
    ds_read_b64_tr_b16 v[146:147], v234 offset:17408
    buffer_load_dwordx4 v[104:107], v0, s[32:35], s62 offen offset:2048 sc1
    s_waitcnt vmcnt(4)
    s_waitcnt lgkmcnt(8)
    v_mfma_f32_32x32x16_bf16 v[4:19], v[128:131], v[88:91], v[4:19]
    ds_read_b64_tr_b16 v[148:149], v235 offset:16384
    ds_read_b64_tr_b16 v[150:151], v235 offset:17408
    s_waitcnt lgkmcnt(8)
    v_mfma_f32_32x32x16_bf16 v[20:35], v[132:135], v[88:91], v[20:35]
    ds_read_b64_tr_b16 v[128:129], v234 offset:18432
    ds_read_b64_tr_b16 v[130:131], v234 offset:19456
    buffer_load_dwordx4 v[108:111], v0, s[32:35], s62 offen offset:3072 sc1
    s_waitcnt vmcnt(4)
    s_waitcnt lgkmcnt(8)
    v_mfma_f32_32x32x16_bf16 v[4:19], v[136:139], v[92:95], v[4:19]
    ds_read_b64_tr_b16 v[132:133], v235 offset:18432
    ds_read_b64_tr_b16 v[134:135], v235 offset:19456
    s_waitcnt lgkmcnt(8)
    v_mfma_f32_32x32x16_bf16 v[20:35], v[140:143], v[92:95], v[20:35]
    ds_read_b64_tr_b16 v[136:137], v234 offset:20480
    ds_read_b64_tr_b16 v[138:139], v234 offset:21504
    s_add_u32 s62, s62, 4096
    buffer_load_dwordx4 v[112:115], v0, s[32:35], s62 offen offset:0 sc1
    s_waitcnt vmcnt(4)
    s_waitcnt lgkmcnt(8)
    v_mfma_f32_32x32x16_bf16 v[4:19], v[144:147], v[96:99], v[4:19]
    ds_read_b64_tr_b16 v[140:141], v235 offset:20480
    ds_read_b64_tr_b16 v[142:143], v235 offset:21504
    s_waitcnt lgkmcnt(8)
    v_mfma_f32_32x32x16_bf16 v[20:35], v[148:151], v[96:99], v[20:35]
    ds_read_b64_tr_b16 v[144:145], v234 offset:22528
    ds_read_b64_tr_b16 v[146:147], v234 offset:23552
    buffer_load_dwordx4 v[116:119], v0, s[32:35], s62 offen offset:1024 sc1
    s_waitcnt vmcnt(4)
    s_waitcnt lgkmcnt(8)
    v_mfma_f32_32x32x16_bf16 v[4:19], v[128:131], v[100:103], v[4:19]
    ds_read_b64_tr_b16 v[148:149], v235 offset:22528
    ds_read_b64_tr_b16 v[150:151], v235 offset:23552
    s_waitcnt lgkmcnt(8)
    v_mfma_f32_32x32x16_bf16 v[20:35], v[132:135], v[100:103], v[20:35]
    ds_read_b64_tr_b16 v[128:129], v234 offset:24576
    ds_read_b64_tr_b16 v[130:131], v234 offset:25600
    buffer_load_dwordx4 v[120:123], v0, s[32:35], s62 offen offset:2048 sc1
    s_waitcnt vmcnt(4)
    s_waitcnt lgkmcnt(8)
    v_mfma_f32_32x32x16_bf16 v[4:19], v[136:139], v[104:107], v[4:19]
    ds_read_b64_tr_b16 v[132:133], v235 offset:24576
    ds_read_b64_tr_b16 v[134:135], v235 offset:25600
    s_waitcnt lgkmcnt(8)
    v_mfma_f32_32x32x16_bf16 v[20:35], v[140:143], v[104:107], v[20:35]
    ds_read_b64_tr_b16 v[136:137], v234 offset:26624
    ds_read_b64_tr_b16 v[138:139], v234 offset:27648
    buffer_load_dwordx4 v[124:127], v0, s[32:35], s62 offen offset:3072 sc1
    s_waitcnt vmcnt(4)
    s_waitcnt lgkmcnt(8)
    v_mfma_f32_32x32x16_bf16 v[4:19], v[144:147], v[108:111], v[4:19]
    ds_read_b64_tr_b16 v[140:141], v235 offset:26624
    ds_read_b64_tr_b16 v[142:143], v235 offset:27648
    s_waitcnt lgkmcnt(8)
    v_mfma_f32_32x32x16_bf16 v[20:35], v[148:151], v[108:111], v[20:35]
    s_barrier
    ds_read_b64_tr_b16 v[144:145], v234 offset:28672
    ds_read_b64_tr_b16 v[146:147], v234 offset:29696
    s_waitcnt vmcnt(3)
    s_waitcnt lgkmcnt(8)
    v_mfma_f32_32x32x16_bf16 v[4:19], v[128:131], v[112:115], v[4:19]
    ds_read_b64_tr_b16 v[148:149], v235 offset:28672
    ds_read_b64_tr_b16 v[150:151], v235 offset:29696
    s_waitcnt lgkmcnt(8)
    v_mfma_f32_32x32x16_bf16 v[20:35], v[132:135], v[112:115], v[20:35]
    ds_read_b64_tr_b16 v[128:129], v234 offset:30720
    ds_read_b64_tr_b16 v[130:131], v234 offset:31744
    s_waitcnt vmcnt(2)
    s_waitcnt lgkmcnt(8)
    v_mfma_f32_32x32x16_bf16 v[4:19], v[136:139], v[116:119], v[4:19]
    ds_read_b64_tr_b16 v[132:133], v235 offset:30720
    ds_read_b64_tr_b16 v[134:135], v235 offset:31744
    s_waitcnt lgkmcnt(8)
    v_mfma_f32_32x32x16_bf16 v[20:35], v[140:143], v[116:119], v[20:35]
    s_waitcnt vmcnt(1)
    s_waitcnt lgkmcnt(6)
    v_mfma_f32_32x32x16_bf16 v[4:19], v[144:147], v[120:123], v[4:19]
    s_waitcnt lgkmcnt(4)
    v_mfma_f32_32x32x16_bf16 v[20:35], v[148:151], v[120:123], v[20:35]
    s_waitcnt vmcnt(0)
    s_waitcnt lgkmcnt(2)
    v_mfma_f32_32x32x16_bf16 v[4:19], v[128:131], v[124:127], v[4:19]
    s_waitcnt lgkmcnt(0)
    v_mfma_f32_32x32x16_bf16 v[20:35], v[132:135], v[124:127], v[20:35]
    s_lshl_b32 s52, s44, 12
    s_add_u32 s52, s52, 65536
    v_add_u32 v200, s52, v0
    s_xor_b32 s53, s44, 1
    s_lshl_b32 s53, s53, 12
    s_add_u32 s53, s53, 65536
    v_add_u32 v201, s53, v0
    s_cmp_eq_u32 s57, 0
    s_nop 7

    s_cbranch_scc1 L_kr_3_a
    ds_write_b128 v200, v[4:7] offset:0
    ds_write_b128 v200, v[8:11] offset:1024
    ds_write_b128 v200, v[12:15] offset:2048
    ds_write_b128 v200, v[16:19] offset:3072
    v_mov_b32 v36, v20
    v_mov_b32 v37, v21
    v_mov_b32 v38, v22
    v_mov_b32 v39, v23
    v_mov_b32 v40, v24
    v_mov_b32 v41, v25
    v_mov_b32 v42, v26
    v_mov_b32 v43, v27
    v_mov_b32 v44, v28
    v_mov_b32 v45, v29
    v_mov_b32 v46, v30
    v_mov_b32 v47, v31
    v_mov_b32 v48, v32
    v_mov_b32 v49, v33
    v_mov_b32 v50, v34
    v_mov_b32 v51, v35
    s_branch L_kr_3_b
L_kr_3_a:
    ds_write_b128 v200, v[20:23] offset:0
    ds_write_b128 v200, v[24:27] offset:1024
    ds_write_b128 v200, v[28:31] offset:2048
    ds_write_b128 v200, v[32:35] offset:3072
    v_mov_b32 v36, v4
    v_mov_b32 v37, v5
    v_mov_b32 v38, v6
    v_mov_b32 v39, v7
    v_mov_b32 v40, v8
    v_mov_b32 v41, v9
    v_mov_b32 v42, v10
    v_mov_b32 v43, v11
    v_mov_b32 v44, v12
    v_mov_b32 v45, v13
    v_mov_b32 v46, v14
    v_mov_b32 v47, v15
    v_mov_b32 v48, v16
    v_mov_b32 v49, v17
    v_mov_b32 v50, v18
    v_mov_b32 v51, v19
L_kr_3_b:
    v_lshrrev_b32 v200, 5, v1
    v_lshlrev_b32 v200, 4, v200
    s_lshl_b32 s53, s57, 7
    s_add_u32 s53, s53, 162304
    v_add_u32 v238, s53, v200

    ds_read_b128 v[64:67], v238 offset:0
    ds_read_b128 v[68:71], v238 offset:32
    ds_read_b128 v[72:75], v238 offset:64
    ds_read_b128 v[76:79], v238 offset:96
    ds_read_b128 v[80:83], v238 offset:256
    ds_read_b128 v[84:87], v238 offset:288
    ds_read_b128 v[88:91], v238 offset:320
    ds_read_b128 v[92:95], v238 offset:352
    ds_read_b128 v[96:99], v238 offset:512
    ds_read_b128 v[100:103], v238 offset:544
    ds_read_b128 v[104:107], v238 offset:576
    ds_read_b128 v[108:111], v238 offset:608
    s_mov_b32 s56, 0xffff0000
    v_lshlrev_b32 v112, 16, v240
    v_and_b32 v113, s56, v240
    v_lshlrev_b32 v114, 16, v241
    v_and_b32 v115, s56, v241
    v_lshlrev_b32 v116, 16, v242
    v_and_b32 v117, s56, v242
    v_lshlrev_b32 v118, 16, v243
    v_and_b32 v119, s56, v243
    v_lshlrev_b32 v120, 16, v244
    v_and_b32 v121, s56, v244
    v_lshlrev_b32 v122, 16, v245
    v_and_b32 v123, s56, v245
    v_lshlrev_b32 v124, 16, v246
    v_and_b32 v125, s56, v246
    v_lshlrev_b32 v126, 16, v247
    v_and_b32 v127, s56, v247
    s_waitcnt lgkmcnt(0)
    s_barrier
    ds_read_b128 v[208:211], v201 offset:0
    ds_read_b128 v[212:215], v201 offset:1024
    ds_read_b128 v[216:219], v201 offset:2048
    ds_read_b128 v[220:223], v201 offset:3072
    s_waitcnt lgkmcnt(3)
    v_pk_add_f32 v[36:37], v[36:37], v[208:209]
    v_pk_add_f32 v[38:39], v[38:39], v[210:211]
    s_waitcnt lgkmcnt(2)
    v_pk_add_f32 v[40:41], v[40:41], v[212:213]
    v_pk_add_f32 v[42:43], v[42:43], v[214:215]
    s_waitcnt lgkmcnt(1)
    v_pk_add_f32 v[44:45], v[44:45], v[216:217]
    v_pk_add_f32 v[46:47], v[46:47], v[218:219]
    s_waitcnt lgkmcnt(0)
    v_pk_add_f32 v[48:49], v[48:49], v[220:221]
    v_pk_add_f32 v[50:51], v[50:51], v[222:223]
    v_pk_fma_f32 v[36:37], v[36:37], v[64:65], v[112:113]
    v_pk_fma_f32 v[38:39], v[38:39], v[66:67], v[114:115]
    v_pk_fma_f32 v[40:41], v[40:41], v[68:69], v[116:117]
    v_pk_fma_f32 v[42:43], v[42:43], v[70:71], v[118:119]
    v_pk_fma_f32 v[44:45], v[44:45], v[72:73], v[120:121]
    v_pk_fma_f32 v[46:47], v[46:47], v[74:75], v[122:123]
    v_pk_fma_f32 v[48:49], v[48:49], v[76:77], v[124:125]
    v_pk_fma_f32 v[50:51], v[50:51], v[78:79], v[126:127]
    v_pk_mul_f32 v[4:5], v[36:37], v[36:37]
    v_pk_add_f32 v[6:7], v[36:37], v[38:39]
    v_pk_fma_f32 v[4:5], v[38:39], v[38:39], v[4:5]
    v_pk_fma_f32 v[4:5], v[40:41], v[40:41], v[4:5]
    v_pk_fma_f32 v[4:5], v[42:43], v[42:43], v[4:5]
    v_pk_fma_f32 v[4:5], v[44:45], v[44:45], v[4:5]
    v_pk_fma_f32 v[4:5], v[46:47], v[46:47], v[4:5]
    v_pk_fma_f32 v[4:5], v[48:49], v[48:49], v[4:5]
    v_pk_fma_f32 v[4:5], v[50:51], v[50:51], v[4:5]
    v_pk_add_f32 v[6:7], v[6:7], v[40:41]
    v_pk_add_f32 v[6:7], v[6:7], v[42:43]
    v_pk_add_f32 v[6:7], v[6:7], v[44:45]
    v_pk_add_f32 v[6:7], v[6:7], v[46:47]
    v_pk_add_f32 v[6:7], v[6:7], v[48:49]
    v_pk_add_f32 v[6:7], v[6:7], v[50:51]
    v_add_f32 v8, v6, v7
    v_add_f32 v9, v4, v5
    v_mov_b32 v10, v8
    v_mov_b32 v11, v9
    s_nop 1
    v_permlane32_swap_b32 v8, v10
    v_permlane32_swap_b32 v9, v11
    s_nop 0
    v_add_f32 v8, v8, v10
    v_add_f32 v9, v9, v11

    s_lshl_b32 s52, s45, 2
    s_add_u32 s52, s52, s47
    s_lshl_b32 s52, s52, 14
    s_add_u32 s60, s52, 3145728
    s_lshl_b32 s53, s58, 9
    s_add_u32 s60, s60, s53
    s_lshl_b32 s52, s48, 1
    s_add_u32 s52, s52, s57
    s_lshl_b32 s52, s52, 10
    s_add_u32 s61, s60, s52
    v_and_b32 v12, 31, v1
    v_lshlrev_b32 v12, 4, v12
    v_mov_b32 v10, s49
    v_mov_b32 v11, s49
    s_mov_b32 exec_hi, 0

    buffer_store_dwordx4 v[8:11], v12, s[32:35], s61 offen sc1
    s_mov_b64 exec, -1
    s_barrier
    v_cvt_pk_bf16_f32 v244, v36, v37
    v_cvt_pk_bf16_f32 v245, v38, v39
    v_cvt_pk_bf16_f32 v246, v40, v41
    v_cvt_pk_bf16_f32 v247, v42, v43
    v_cvt_pk_bf16_f32 v248, v44, v45
    v_cvt_pk_bf16_f32 v249, v46, v47
    v_cvt_pk_bf16_f32 v250, v48, v49
    v_cvt_pk_bf16_f32 v251, v50, v51
    v_lshrrev_b32 v13, 5, v1
    v_lshl_add_u32 v12, v13, 13, v12
    s_add_u32 s61, s60, 4096
    s_mov_b32 s72, 0

L_f2a_G:
    buffer_load_dwordx4 v[160:163], v12, s[32:35], s60 offen offset:0 sc1
    buffer_load_dwordx4 v[164:167], v12, s[32:35], s60 offen offset:1024 sc1
    buffer_load_dwordx4 v[168:171], v12, s[32:35], s60 offen offset:2048 sc1
    buffer_load_dwordx4 v[172:175], v12, s[32:35], s60 offen offset:3072 sc1
    buffer_load_dwordx4 v[176:179], v12, s[32:35], s61 offen offset:0 sc1
    buffer_load_dwordx4 v[180:183], v12, s[32:35], s61 offen offset:1024 sc1
    buffer_load_dwordx4 v[184:187], v12, s[32:35], s61 offen offset:2048 sc1
    buffer_load_dwordx4 v[188:191], v12, s[32:35], s61 offen offset:3072 sc1
    s_add_u32 s72, s72, 1
    s_waitcnt vmcnt(0)
    v_xor_b32 v14, s49, v162
    v_xor_b32 v15, s49, v166
    v_xor_b32 v16, s49, v170
    v_xor_b32 v17, s49, v174
    v_xor_b32 v18, s49, v178
    v_xor_b32 v19, s49, v182
    v_xor_b32 v20, s49, v186
    v_xor_b32 v21, s49, v190
    v_or3_b32 v14, v14, v15, v16
    v_or3_b32 v17, v17, v18, v19
    v_or3_b32 v14, v14, v20, v21
    v_or_b32 v14, v14, v17
    v_cmp_ne_u32 vcc, 0, v14
    s_cmp_gt_u32 s72, 0x100000
    s_cbranch_scc1 L_f2a_G_out
    s_cbranch_vccnz L_f2a_G

L_f2a_G_out:
    s_barrier
    s_waitcnt lgkmcnt(0)
    v_pk_add_f32 v[160:161], v[160:161], v[164:165]
    v_pk_add_f32 v[160:161], v[160:161], v[168:169]
    v_pk_add_f32 v[160:161], v[160:161], v[172:173]
    v_pk_add_f32 v[160:161], v[160:161], v[176:177]
    v_pk_add_f32 v[160:161], v[160:161], v[180:181]
    v_pk_add_f32 v[160:161], v[160:161], v[184:185]
    v_pk_add_f32 v[160:161], v[160:161], v[188:189]
    v_mov_b32 v14, v160
    v_mov_b32 v15, v161
    v_mov_b32 v16, v14
    v_mov_b32 v17, v15
    s_nop 1
    v_permlane32_swap_b32 v14, v16
    v_permlane32_swap_b32 v15, v17
    s_nop 0
    v_add_f32 v14, v14, v16
    v_add_f32 v15, v15, v17
    s_mov_b32 s54, 0x3b000000
    s_mov_b32 s55, 0x3727c5ac
    v_mul_f32 v14, s54, v14
    v_mul_f32 v15, s54, v15
    v_fma_f32 v15, -v14, v14, v15
    v_max_f32 v15, 0, v15
    v_add_f32 v15, s55, v15
    v_rsq_f32 v16, v15
    s_nop 0
    v_mul_f32 v14, v14, v16
    v_sub_f32 v17, 0, v14

    v_pk_fma_f32 v[36:37], v[36:37], v[16:17], v[16:17] op_sel:[0,0,1] op_sel_hi:[1,0,1]
    v_pk_fma_f32 v[38:39], v[38:39], v[16:17], v[16:17] op_sel:[0,0,1] op_sel_hi:[1,0,1]
    v_pk_fma_f32 v[40:41], v[40:41], v[16:17], v[16:17] op_sel:[0,0,1] op_sel_hi:[1,0,1]
    v_pk_fma_f32 v[42:43], v[42:43], v[16:17], v[16:17] op_sel:[0,0,1] op_sel_hi:[1,0,1]
    v_pk_fma_f32 v[44:45], v[44:45], v[16:17], v[16:17] op_sel:[0,0,1] op_sel_hi:[1,0,1]
    v_pk_fma_f32 v[46:47], v[46:47], v[16:17], v[16:17] op_sel:[0,0,1] op_sel_hi:[1,0,1]
    v_pk_fma_f32 v[48:49], v[48:49], v[16:17], v[16:17] op_sel:[0,0,1] op_sel_hi:[1,0,1]
    v_pk_fma_f32 v[50:51], v[50:51], v[16:17], v[16:17] op_sel:[0,0,1] op_sel_hi:[1,0,1]
    v_pk_fma_f32 v[36:37], v[36:37], v[80:81], v[96:97]
    v_pk_fma_f32 v[38:39], v[38:39], v[82:83], v[98:99]
    v_pk_fma_f32 v[40:41], v[40:41], v[84:85], v[100:101]
    v_pk_fma_f32 v[42:43], v[42:43], v[86:87], v[102:103]
    v_pk_fma_f32 v[44:45], v[44:45], v[88:89], v[104:105]
    v_pk_fma_f32 v[46:47], v[46:47], v[90:91], v[106:107]
    v_pk_fma_f32 v[48:49], v[48:49], v[92:93], v[108:109]
    v_pk_fma_f32 v[50:51], v[50:51], v[94:95], v[110:111]
    v_cvt_pk_bf16_f32 v20, v36, v37
    v_cvt_pk_bf16_f32 v21, v38, v39
    v_cvt_pk_bf16_f32 v22, v40, v41
    v_cvt_pk_bf16_f32 v23, v42, v43
    v_cvt_pk_bf16_f32 v24, v44, v45
    v_cvt_pk_bf16_f32 v25, v46, v47
    v_cvt_pk_bf16_f32 v26, v48, v49
    v_cvt_pk_bf16_f32 v27, v50, v51
    s_lshl_b32 s52, s59, 5
    s_lshl_b32 s53, s48, 2
    s_add_u32 s52, s52, s53
    s_lshl_b32 s53, s57, 1
    s_add_u32 s52, s52, s53
    s_lshl_b32 s52, s52, 10
    s_add_u32 s52, s52, 4194304

    buffer_store_dwordx4 v[20:23], v0, s[32:35], s52 offen sc1
    buffer_store_dwordx4 v[24:27], v0, s[32:35], s52 offen offset:1024 sc1
    s_barrier
    s_lshl_b32 s53, s57, 11
    v_add_u32 v115, s53, v232
    v_add_u32 v254, s53, v233
    s_lshr_b32 s52, s47, 1
    s_mul_i32 s52, s52, 14
    s_lshl_b32 s52, s52, 4
    s_and_b32 s53, s47, 1
    s_lshl_b32 s53, s53, 1
    s_add_u32 s53, s53, s58
    s_lshl_b32 s53, s53, 2
    s_add_u32 s52, s52, s53
    s_lshl_b32 s53, s45, 12
    s_add_u32 s52, s52, s53
    s_add_u32 s74, s52, 67072
    v_mul_u32_u24 v98, 0x4925, v1
    v_lshrrev_b32 v98, 18, v98
    v_mul_u32_u24 v99, 14, v98
    v_sub_u32 v99, v1, v99
    v_lshlrev_b32 v99, 4, v99
    v_lshl_add_u32 v99, v98, 9, v99
    v_add_u32 v253, s74, v99
    s_lshl_b32 s52, s45, 12
    s_lshl_b32 s53, s46, 4
    s_add_u32 s52, s52, s53
    s_lshl_b32 s53, s44, 2
    s_add_u32 s52, s52, s53
    s_add_u32 s73, s52, 67072

    s_lshl_b32 s52, s45, 3
    s_lshl_b32 s53, s47, 1
    s_add_u32 s52, s52, s53
    s_add_u32 s52, s52, s58
    s_mul_i32 s52, s52, 112
    s_add_u32 s52, s52, s57
    s_lshl_b32 s52, s52, 10
    s_add_u32 s75, s52, 6291456

    v_mov_b32 v113, v253
    s_waitcnt vmcnt(0)
    s_lshl_b32 s53, s45, 12
    s_lshl_b32 s54, s46, 4
    s_add_u32 s53, s53, s54
    s_lshl_b32 s54, s44, 2
    s_add_u32 s53, s53, s54
    s_add_u32 s53, s53, 66560
    v_mov_b32 v252, s49
    v_mov_b32 v253, 0
    s_mov_b64 exec, 1

    buffer_store_dword v252, v253, s[32:35], s53 offen sc1
    s_mov_b64 exec, -1
    v_mov_b32 v253, v113
    s_cmp_ge_u32 s46, 28
    s_cbranch_scc1 L_c_idle_G
    s_cmp_ge_u32 s46, 14
    s_cselect_b32 s66, 1, 0
    s_mul_i32 s53, s66, 14
    s_sub_u32 s67, s46, s53
    s_lshl_b32 s52, s66, 1
    s_lshr_b32 s53, s44, 1
    s_add_u32 s52, s52, s53
    s_lshl_b32 s52, s52, 7
    s_lshl_b32 s53, s45, 12
    s_add_u32 s52, s52, s53
    s_add_u32 s52, s52, 66560
    v_lshlrev_b32 v111, 2, v1
    v_add_u32 v111, s52, v111

    s_lshl_b32 s52, s45, 3
    s_lshl_b32 s53, s66, 2
    s_add_u32 s52, s52, s53
    s_add_u32 s68, s52, s44
    s_lshl_b32 s52, s68, 15
    s_add_u32 s62, s52, 4194304

    s_mul_i32 s69, s68, 112
    s_lshl_b32 s53, s67, 3
    s_add_u32 s69, s69, s53
    s_lshl_b32 s69, s69, 10
    s_add_u32 s69, s69, 6291456
    s_mov_b32 s77, 0x3fb8aa3b

    s_mov_b32 s78, s69
    v_lshrrev_b32 v98, 4, v1
    v_and_b32 v99, 1, v98
    v_lshrrev_b32 v98, 1, v98
    v_and_b32 v100, 15, v1
    v_lshrrev_b32 v101, 2, v100
    v_and_b32 v102, 3, v100
    v_lshl_add_u32 v103, v98, 2, v101
    v_lshlrev_b32 v103, 7, v103
    v_lshl_add_u32 v103, v99, 11, v103
    v_and_b32 v104, 1, v102
    v_lshl_add_u32 v103, v104, 3, v103
    v_lshrrev_b32 v104, 1, v102
    v_lshl_add_u32 v103, v104, 4, v103
    v_lshrrev_b32 v105, 1, v101
    v_lshlrev_b32 v105, 1, v105
    v_lshl_add_u32 v105, v99, 2, v105

    v_xor_b32 v106, 0, v105
    v_lshl_add_u32 v2, v106, 4, v103
    v_xor_b32 v106, 2, v105
    v_lshl_add_u32 v3, v106, 4, v103
    v_xor_b32 v106, 4, v105
    v_lshl_add_u32 v4, v106, 4, v103
    v_xor_b32 v106, 6, v105
    v_lshl_add_u32 v5, v106, 4, v103
    v_mov_b32 v114, s49
    v_add_u32 v6, 0x10000, v2
    v_add_u32 v7, 0x10000, v3
    v_add_u32 v8, 0x20000, v2
    v_add_u32 v9, 0x20000, v3
    s_mov_b32 s72, 0
    s_mov_b32 exec_lo, -1
    s_mov_b32 exec_hi, 0x0
L_f2b_G:
    buffer_load_dword v110, v111, s[32:35], 0 offen sc1
    s_add_u32 s72, s72, 1
    s_waitcnt vmcnt(0)
    v_cmp_ne_u32 vcc, s49, v110
    s_cmp_gt_u32 s72, 0x100000
    s_cbranch_scc1 L_f2b_G_out
    s_cbranch_vccnz L_f2b_G
L_f2b_G_out:
    s_mov_b64 exec, -1
    buffer_load_dwordx4 v[116:119], v0, s[32:35], s62 offen offset:0 sc1
    buffer_load_dwordx4 v[120:123], v0, s[32:35], s62 offen offset:1024 sc1
    buffer_load_dwordx4 v[124:127], v0, s[32:35], s62 offen offset:2048 sc1
    buffer_load_dwordx4 v[128:131], v0, s[32:35], s62 offen offset:3072 sc1
    s_add_u32 s62, s62, 4096
    buffer_load_dwordx4 v[132:135], v0, s[32:35], s62 offen offset:0 sc1
    buffer_load_dwordx4 v[136:139], v0, s[32:35], s62 offen offset:1024 sc1
    buffer_load_dwordx4 v[140:143], v0, s[32:35], s62 offen offset:2048 sc1
    buffer_load_dwordx4 v[144:147], v0, s[32:35], s62 offen offset:3072 sc1
    s_barrier
    ds_read_b64_tr_b16 v[74:75], v6 offset:16384
    ds_read_b64_tr_b16 v[76:77], v6 offset:17408
    ds_read_b64_tr_b16 v[78:79], v7 offset:16384
    ds_read_b64_tr_b16 v[80:81], v7 offset:17408
    ds_read_b64_tr_b16 v[82:83], v6 offset:20480
    ds_read_b64_tr_b16 v[84:85], v6 offset:21504
    ds_read_b64_tr_b16 v[86:87], v7 offset:20480
    ds_read_b64_tr_b16 v[88:89], v7 offset:21504
    ds_read_b64_tr_b16 v[90:91], v6 offset:24576
    ds_read_b64_tr_b16 v[92:93], v6 offset:25600
    s_add_u32 s62, s62, 4096
    buffer_load_dwordx4 v[148:151], v0, s[32:35], s62 offen offset:0 sc1
    s_waitcnt vmcnt(8)
    s_waitcnt lgkmcnt(6)
    v_mfma_f32_32x32x16_bf16 v[10:25], v[74:77], v[116:119], 0
    ds_read_b64_tr_b16 v[94:95], v7 offset:24576
    ds_read_b64_tr_b16 v[96:97], v7 offset:25600
    v_mfma_f32_32x32x16_bf16 v[26:41], v[78:81], v[116:119], 0
    ds_read_b64_tr_b16 v[74:75], v6 offset:28672
    ds_read_b64_tr_b16 v[76:77], v6 offset:29696
    buffer_load_dwordx4 v[152:155], v0, s[32:35], s62 offen offset:1024 sc1
    s_waitcnt vmcnt(8)
    s_waitcnt lgkmcnt(6)
    v_mfma_f32_32x32x16_bf16 v[10:25], v[82:85], v[120:123], v[10:25]
    ds_read_b64_tr_b16 v[78:79], v7 offset:28672
    ds_read_b64_tr_b16 v[80:81], v7 offset:29696
    v_mfma_f32_32x32x16_bf16 v[26:41], v[86:89], v[120:123], v[26:41]
    ds_read_b64_tr_b16 v[82:83], v6 offset:32768
    ds_read_b64_tr_b16 v[84:85], v6 offset:33792
    buffer_load_dwordx4 v[156:159], v0, s[32:35], s62 offen offset:2048 sc1
    s_waitcnt vmcnt(8)
    s_waitcnt lgkmcnt(6)
    v_mfma_f32_32x32x16_bf16 v[10:25], v[90:93], v[124:127], v[10:25]
    ds_read_b64_tr_b16 v[86:87], v7 offset:32768
    ds_read_b64_tr_b16 v[88:89], v7 offset:33792
    v_mfma_f32_32x32x16_bf16 v[26:41], v[94:97], v[124:127], v[26:41]
    ds_read_b64_tr_b16 v[90:91], v6 offset:36864
    ds_read_b64_tr_b16 v[92:93], v6 offset:37888
    buffer_load_dwordx4 v[160:163], v0, s[32:35], s62 offen offset:3072 sc1
    s_waitcnt vmcnt(8)
    s_waitcnt lgkmcnt(6)
    v_mfma_f32_32x32x16_bf16 v[10:25], v[74:77], v[128:131], v[10:25]
    ds_read_b64_tr_b16 v[94:95], v7 offset:36864
    ds_read_b64_tr_b16 v[96:97], v7 offset:37888
    v_mfma_f32_32x32x16_bf16 v[26:41], v[78:81], v[128:131], v[26:41]
    ds_read_b64_tr_b16 v[74:75], v6 offset:40960
    ds_read_b64_tr_b16 v[76:77], v6 offset:41984
    s_add_u32 s62, s62, 4096
    buffer_load_dwordx4 v[164:167], v0, s[32:35], s62 offen offset:0 sc1
    s_waitcnt vmcnt(8)
    s_waitcnt lgkmcnt(6)
    v_mfma_f32_32x32x16_bf16 v[10:25], v[82:85], v[132:135], v[10:25]
    ds_read_b64_tr_b16 v[78:79], v7 offset:40960
    ds_read_b64_tr_b16 v[80:81], v7 offset:41984
    v_mfma_f32_32x32x16_bf16 v[26:41], v[86:89], v[132:135], v[26:41]
    ds_read_b64_tr_b16 v[82:83], v6 offset:45056
    ds_read_b64_tr_b16 v[84:85], v6 offset:46080
    buffer_load_dwordx4 v[168:171], v0, s[32:35], s62 offen offset:1024 sc1
    s_waitcnt vmcnt(8)
    s_waitcnt lgkmcnt(6)
    v_mfma_f32_32x32x16_bf16 v[10:25], v[90:93], v[136:139], v[10:25]
    ds_read_b64_tr_b16 v[86:87], v7 offset:45056
    ds_read_b64_tr_b16 v[88:89], v7 offset:46080
    v_mfma_f32_32x32x16_bf16 v[26:41], v[94:97], v[136:139], v[26:41]
    ds_read_b64_tr_b16 v[90:91], v6 offset:49152
    ds_read_b64_tr_b16 v[92:93], v6 offset:50176
    buffer_load_dwordx4 v[172:175], v0, s[32:35], s62 offen offset:2048 sc1
    s_waitcnt vmcnt(8)
    s_waitcnt lgkmcnt(6)
    v_mfma_f32_32x32x16_bf16 v[10:25], v[74:77], v[140:143], v[10:25]
    ds_read_b64_tr_b16 v[94:95], v7 offset:49152
    ds_read_b64_tr_b16 v[96:97], v7 offset:50176
    v_mfma_f32_32x32x16_bf16 v[26:41], v[78:81], v[140:143], v[26:41]
    ds_read_b64_tr_b16 v[74:75], v6 offset:53248
    ds_read_b64_tr_b16 v[76:77], v6 offset:54272
    buffer_load_dwordx4 v[176:179], v0, s[32:35], s62 offen offset:3072 sc1
    s_waitcnt vmcnt(8)
    s_waitcnt lgkmcnt(6)
    v_mfma_f32_32x32x16_bf16 v[10:25], v[82:85], v[144:147], v[10:25]
    ds_read_b64_tr_b16 v[78:79], v7 offset:53248
    ds_read_b64_tr_b16 v[80:81], v7 offset:54272
    v_mfma_f32_32x32x16_bf16 v[26:41], v[86:89], v[144:147], v[26:41]
    ds_read_b64_tr_b16 v[82:83], v6 offset:57344
    ds_read_b64_tr_b16 v[84:85], v6 offset:58368
    s_add_u32 s62, s62, 4096
    buffer_load_dwordx4 v[180:183], v0, s[32:35], s62 offen offset:0 sc1
    s_waitcnt vmcnt(8)
    s_waitcnt lgkmcnt(6)
    v_mfma_f32_32x32x16_bf16 v[10:25], v[90:93], v[148:151], v[10:25]
    ds_read_b64_tr_b16 v[86:87], v7 offset:57344
    ds_read_b64_tr_b16 v[88:89], v7 offset:58368
    v_mfma_f32_32x32x16_bf16 v[26:41], v[94:97], v[148:151], v[26:41]
    ds_read_b64_tr_b16 v[90:91], v6 offset:61440
    ds_read_b64_tr_b16 v[92:93], v6 offset:62464
    buffer_load_dwordx4 v[184:187], v0, s[32:35], s62 offen offset:1024 sc1
    s_waitcnt vmcnt(8)
    s_waitcnt lgkmcnt(6)
    v_mfma_f32_32x32x16_bf16 v[10:25], v[74:77], v[152:155], v[10:25]
    ds_read_b64_tr_b16 v[94:95], v7 offset:61440
    ds_read_b64_tr_b16 v[96:97], v7 offset:62464
    v_mfma_f32_32x32x16_bf16 v[26:41], v[78:81], v[152:155], v[26:41]
    ds_read_b64_tr_b16 v[74:75], v8 offset:0
    ds_read_b64_tr_b16 v[76:77], v8 offset:1024
    buffer_load_dwordx4 v[188:191], v0, s[32:35], s62 offen offset:2048 sc1
    s_waitcnt vmcnt(8)
    s_waitcnt lgkmcnt(6)
    v_mfma_f32_32x32x16_bf16 v[10:25], v[82:85], v[156:159], v[10:25]
    ds_read_b64_tr_b16 v[78:79], v9 offset:0
    ds_read_b64_tr_b16 v[80:81], v9 offset:1024
    v_mfma_f32_32x32x16_bf16 v[26:41], v[86:89], v[156:159], v[26:41]
    ds_read_b64_tr_b16 v[82:83], v8 offset:4096
    ds_read_b64_tr_b16 v[84:85], v8 offset:5120
    buffer_load_dwordx4 v[192:195], v0, s[32:35], s62 offen offset:3072 sc1
    s_waitcnt vmcnt(8)
    s_waitcnt lgkmcnt(6)
    v_mfma_f32_32x32x16_bf16 v[10:25], v[90:93], v[160:163], v[10:25]
    ds_read_b64_tr_b16 v[86:87], v9 offset:4096
    ds_read_b64_tr_b16 v[88:89], v9 offset:5120
    v_mfma_f32_32x32x16_bf16 v[26:41], v[94:97], v[160:163], v[26:41]
    ds_read_b64_tr_b16 v[90:91], v8 offset:8192
    ds_read_b64_tr_b16 v[92:93], v8 offset:9216
    s_add_u32 s62, s62, 4096
    buffer_load_dwordx4 v[196:199], v0, s[32:35], s62 offen offset:0 sc1
    s_waitcnt vmcnt(8)
    s_waitcnt lgkmcnt(6)
    v_mfma_f32_32x32x16_bf16 v[10:25], v[74:77], v[164:167], v[10:25]
    ds_read_b64_tr_b16 v[94:95], v9 offset:8192
    ds_read_b64_tr_b16 v[96:97], v9 offset:9216
    v_mfma_f32_32x32x16_bf16 v[26:41], v[78:81], v[164:167], v[26:41]
    ds_read_b64_tr_b16 v[74:75], v8 offset:12288
    ds_read_b64_tr_b16 v[76:77], v8 offset:13312
    buffer_load_dwordx4 v[200:203], v0, s[32:35], s62 offen offset:1024 sc1
    s_waitcnt vmcnt(8)
    s_waitcnt lgkmcnt(6)
    v_mfma_f32_32x32x16_bf16 v[10:25], v[82:85], v[168:171], v[10:25]
    ds_read_b64_tr_b16 v[78:79], v9 offset:12288
    ds_read_b64_tr_b16 v[80:81], v9 offset:13312
    v_mfma_f32_32x32x16_bf16 v[26:41], v[86:89], v[168:171], v[26:41]
    ds_read_b64_tr_b16 v[82:83], v8 offset:16384
    ds_read_b64_tr_b16 v[84:85], v8 offset:17408
    buffer_load_dwordx4 v[204:207], v0, s[32:35], s62 offen offset:2048 sc1
    s_waitcnt vmcnt(8)
    s_waitcnt lgkmcnt(6)
    v_mfma_f32_32x32x16_bf16 v[10:25], v[90:93], v[172:175], v[10:25]
    ds_read_b64_tr_b16 v[86:87], v9 offset:16384
    ds_read_b64_tr_b16 v[88:89], v9 offset:17408
    v_mfma_f32_32x32x16_bf16 v[26:41], v[94:97], v[172:175], v[26:41]
    ds_read_b64_tr_b16 v[90:91], v8 offset:20480
    ds_read_b64_tr_b16 v[92:93], v8 offset:21504
    buffer_load_dwordx4 v[208:211], v0, s[32:35], s62 offen offset:3072 sc1
    s_waitcnt vmcnt(8)
    s_waitcnt lgkmcnt(6)
    v_mfma_f32_32x32x16_bf16 v[10:25], v[74:77], v[176:179], v[10:25]
    ds_read_b64_tr_b16 v[94:95], v9 offset:20480
    ds_read_b64_tr_b16 v[96:97], v9 offset:21504
    v_mfma_f32_32x32x16_bf16 v[26:41], v[78:81], v[176:179], v[26:41]
    ds_read_b64_tr_b16 v[74:75], v8 offset:24576
    ds_read_b64_tr_b16 v[76:77], v8 offset:25600
    s_add_u32 s62, s62, 4096
    buffer_load_dwordx4 v[212:215], v0, s[32:35], s62 offen offset:0 sc1
    s_waitcnt vmcnt(8)
    s_waitcnt lgkmcnt(6)
    v_mfma_f32_32x32x16_bf16 v[10:25], v[82:85], v[180:183], v[10:25]
    ds_read_b64_tr_b16 v[78:79], v9 offset:24576
    ds_read_b64_tr_b16 v[80:81], v9 offset:25600
    v_mfma_f32_32x32x16_bf16 v[26:41], v[86:89], v[180:183], v[26:41]
    ds_read_b64_tr_b16 v[82:83], v2 offset:0
    ds_read_b64_tr_b16 v[84:85], v2 offset:1024
    buffer_load_dwordx4 v[216:219], v0, s[32:35], s62 offen offset:1024 sc1
    s_waitcnt vmcnt(8)
    s_waitcnt lgkmcnt(6)
    v_mfma_f32_32x32x16_bf16 v[10:25], v[90:93], v[184:187], v[10:25]
    ds_read_b64_tr_b16 v[86:87], v3 offset:0
    ds_read_b64_tr_b16 v[88:89], v3 offset:1024
    v_mfma_f32_32x32x16_bf16 v[26:41], v[94:97], v[184:187], v[26:41]
    ds_read_b64_tr_b16 v[90:91], v2 offset:4096
    ds_read_b64_tr_b16 v[92:93], v2 offset:5120
    buffer_load_dwordx4 v[220:223], v0, s[32:35], s62 offen offset:2048 sc1
    s_waitcnt vmcnt(8)
    s_waitcnt lgkmcnt(6)
    v_mfma_f32_32x32x16_bf16 v[10:25], v[74:77], v[188:191], v[10:25]
    ds_read_b64_tr_b16 v[94:95], v3 offset:4096
    ds_read_b64_tr_b16 v[96:97], v3 offset:5120
    v_mfma_f32_32x32x16_bf16 v[26:41], v[78:81], v[188:191], v[26:41]
    ds_read_b64_tr_b16 v[74:75], v2 offset:8192
    ds_read_b64_tr_b16 v[76:77], v2 offset:9216
    buffer_load_dwordx4 v[224:227], v0, s[32:35], s62 offen offset:3072 sc1
    s_waitcnt vmcnt(8)
    s_waitcnt lgkmcnt(6)
    v_mfma_f32_32x32x16_bf16 v[10:25], v[82:85], v[192:195], v[10:25]
    ds_read_b64_tr_b16 v[78:79], v3 offset:8192
    ds_read_b64_tr_b16 v[80:81], v3 offset:9216
    v_mfma_f32_32x32x16_bf16 v[26:41], v[86:89], v[192:195], v[26:41]
    ds_read_b64_tr_b16 v[82:83], v2 offset:12288
    ds_read_b64_tr_b16 v[84:85], v2 offset:13312
    s_add_u32 s62, s62, 4096
    buffer_load_dwordx4 v[228:231], v0, s[32:35], s62 offen offset:0 sc1
    s_waitcnt vmcnt(8)
    s_waitcnt lgkmcnt(6)
    v_mfma_f32_32x32x16_bf16 v[10:25], v[90:93], v[196:199], v[10:25]
    ds_read_b64_tr_b16 v[86:87], v3 offset:12288
    ds_read_b64_tr_b16 v[88:89], v3 offset:13312
    v_mfma_f32_32x32x16_bf16 v[26:41], v[94:97], v[196:199], v[26:41]
    ds_read_b64_tr_b16 v[90:91], v2 offset:16384
    ds_read_b64_tr_b16 v[92:93], v2 offset:17408
    buffer_load_dwordx4 v[232:235], v0, s[32:35], s62 offen offset:1024 sc1
    s_waitcnt vmcnt(8)
    s_waitcnt lgkmcnt(6)
    v_mfma_f32_32x32x16_bf16 v[10:25], v[74:77], v[200:203], v[10:25]
    ds_read_b64_tr_b16 v[94:95], v3 offset:16384
    ds_read_b64_tr_b16 v[96:97], v3 offset:17408
    v_mfma_f32_32x32x16_bf16 v[26:41], v[78:81], v[200:203], v[26:41]
    ds_read_b64_tr_b16 v[74:75], v2 offset:20480
    ds_read_b64_tr_b16 v[76:77], v2 offset:21504
    buffer_load_dwordx4 v[236:239], v0, s[32:35], s62 offen offset:2048 sc1
    s_waitcnt vmcnt(8)
    s_waitcnt lgkmcnt(6)
    v_mfma_f32_32x32x16_bf16 v[10:25], v[82:85], v[204:207], v[10:25]
    ds_read_b64_tr_b16 v[78:79], v3 offset:20480
    ds_read_b64_tr_b16 v[80:81], v3 offset:21504
    v_mfma_f32_32x32x16_bf16 v[26:41], v[86:89], v[204:207], v[26:41]
    ds_read_b64_tr_b16 v[82:83], v2 offset:24576
    ds_read_b64_tr_b16 v[84:85], v2 offset:25600
    buffer_load_dwordx4 v[240:243], v0, s[32:35], s62 offen offset:3072 sc1
    s_waitcnt vmcnt(8)
    s_waitcnt lgkmcnt(6)
    v_mfma_f32_32x32x16_bf16 v[10:25], v[90:93], v[208:211], v[10:25]
    ds_read_b64_tr_b16 v[86:87], v3 offset:24576
    ds_read_b64_tr_b16 v[88:89], v3 offset:25600
    v_mfma_f32_32x32x16_bf16 v[26:41], v[94:97], v[208:211], v[26:41]
    ds_read_b64_tr_b16 v[90:91], v2 offset:28672
    ds_read_b64_tr_b16 v[92:93], v2 offset:29696
    s_waitcnt vmcnt(7)
    s_waitcnt lgkmcnt(6)
    v_mfma_f32_32x32x16_bf16 v[10:25], v[74:77], v[212:215], v[10:25]
    ds_read_b64_tr_b16 v[94:95], v3 offset:28672
    ds_read_b64_tr_b16 v[96:97], v3 offset:29696
    v_mfma_f32_32x32x16_bf16 v[26:41], v[78:81], v[212:215], v[26:41]
    ds_read_b64_tr_b16 v[74:75], v2 offset:32768
    ds_read_b64_tr_b16 v[76:77], v2 offset:33792
    s_waitcnt vmcnt(6)
    s_waitcnt lgkmcnt(6)
    v_mfma_f32_32x32x16_bf16 v[10:25], v[82:85], v[216:219], v[10:25]
    ds_read_b64_tr_b16 v[78:79], v3 offset:32768
    ds_read_b64_tr_b16 v[80:81], v3 offset:33792
    v_mfma_f32_32x32x16_bf16 v[26:41], v[86:89], v[216:219], v[26:41]
    ds_read_b64_tr_b16 v[82:83], v2 offset:36864
    ds_read_b64_tr_b16 v[84:85], v2 offset:37888
    s_waitcnt vmcnt(5)
    s_waitcnt lgkmcnt(6)
    v_mfma_f32_32x32x16_bf16 v[10:25], v[90:93], v[220:223], v[10:25]
    ds_read_b64_tr_b16 v[86:87], v3 offset:36864
    ds_read_b64_tr_b16 v[88:89], v3 offset:37888
    v_mfma_f32_32x32x16_bf16 v[26:41], v[94:97], v[220:223], v[26:41]
    ds_read_b64_tr_b16 v[90:91], v2 offset:40960
    ds_read_b64_tr_b16 v[92:93], v2 offset:41984
    s_waitcnt vmcnt(4)
    s_waitcnt lgkmcnt(6)
    v_mfma_f32_32x32x16_bf16 v[10:25], v[74:77], v[224:227], v[10:25]
    ds_read_b64_tr_b16 v[94:95], v3 offset:40960
    ds_read_b64_tr_b16 v[96:97], v3 offset:41984
    v_mfma_f32_32x32x16_bf16 v[26:41], v[78:81], v[224:227], v[26:41]
    ds_read_b64_tr_b16 v[74:75], v2 offset:45056
    ds_read_b64_tr_b16 v[76:77], v2 offset:46080
    s_waitcnt vmcnt(3)
    s_waitcnt lgkmcnt(6)
    v_mfma_f32_32x32x16_bf16 v[10:25], v[82:85], v[228:231], v[10:25]
    ds_read_b64_tr_b16 v[78:79], v3 offset:45056
    ds_read_b64_tr_b16 v[80:81], v3 offset:46080
    v_mfma_f32_32x32x16_bf16 v[26:41], v[86:89], v[228:231], v[26:41]
    ds_read_b64_tr_b16 v[82:83], v2 offset:49152
    ds_read_b64_tr_b16 v[84:85], v2 offset:50176
    s_waitcnt vmcnt(2)
    s_waitcnt lgkmcnt(6)
    v_mfma_f32_32x32x16_bf16 v[10:25], v[90:93], v[232:235], v[10:25]
    ds_read_b64_tr_b16 v[86:87], v3 offset:49152
    ds_read_b64_tr_b16 v[88:89], v3 offset:50176
    v_mfma_f32_32x32x16_bf16 v[26:41], v[94:97], v[232:235], v[26:41]
    v_add_u32 v6, 0x10000, v4
    v_add_u32 v7, 0x10000, v5
    v_add_u32 v8, 0x20000, v4
    v_add_u32 v9, 0x20000, v5
    ds_read_b64_tr_b16 v[90:91], v6 offset:16384
    ds_read_b64_tr_b16 v[92:93], v6 offset:17408
    s_waitcnt vmcnt(1)
    s_waitcnt lgkmcnt(6)
    v_mfma_f32_32x32x16_bf16 v[10:25], v[74:77], v[236:239], v[10:25]
    ds_read_b64_tr_b16 v[94:95], v7 offset:16384
    ds_read_b64_tr_b16 v[96:97], v7 offset:17408
    v_mfma_f32_32x32x16_bf16 v[26:41], v[78:81], v[236:239], v[26:41]
    ds_read_b64_tr_b16 v[74:75], v6 offset:20480
    ds_read_b64_tr_b16 v[76:77], v6 offset:21504
    s_waitcnt vmcnt(0)
    s_waitcnt lgkmcnt(6)
    v_mfma_f32_32x32x16_bf16 v[10:25], v[82:85], v[240:243], v[10:25]
    ds_read_b64_tr_b16 v[78:79], v7 offset:20480
    ds_read_b64_tr_b16 v[80:81], v7 offset:21504
    v_mfma_f32_32x32x16_bf16 v[26:41], v[86:89], v[240:243], v[26:41]
    ds_read_b64_tr_b16 v[82:83], v6 offset:24576
    ds_read_b64_tr_b16 v[84:85], v6 offset:25600
    s_waitcnt lgkmcnt(6)
    v_mfma_f32_32x32x16_bf16 v[42:57], v[90:93], v[116:119], 0
    ds_read_b64_tr_b16 v[86:87], v7 offset:24576
    ds_read_b64_tr_b16 v[88:89], v7 offset:25600
    v_mfma_f32_32x32x16_bf16 v[58:73], v[94:97], v[116:119], 0
    ds_read_b64_tr_b16 v[90:91], v6 offset:28672
    ds_read_b64_tr_b16 v[92:93], v6 offset:29696
    s_waitcnt lgkmcnt(6)
    v_mfma_f32_32x32x16_bf16 v[42:57], v[74:77], v[120:123], v[42:57]
    ds_read_b64_tr_b16 v[94:95], v7 offset:28672
    ds_read_b64_tr_b16 v[96:97], v7 offset:29696
    v_exp_f32 v98, -v10
    v_exp_f32 v99, -v11
    v_mfma_f32_32x32x16_bf16 v[58:73], v[78:81], v[120:123], v[58:73]
    ds_read_b64_tr_b16 v[74:75], v6 offset:32768
    ds_read_b64_tr_b16 v[76:77], v6 offset:33792
    v_fma_f32 v98, v98, s77, s77
    v_fma_f32 v99, v99, s77, s77
    s_waitcnt lgkmcnt(6)
    v_mfma_f32_32x32x16_bf16 v[42:57], v[82:85], v[124:127], v[42:57]
    ds_read_b64_tr_b16 v[78:79], v7 offset:32768
    ds_read_b64_tr_b16 v[80:81], v7 offset:33792
    v_rcp_f32 v98, v98
    v_rcp_f32 v99, v99
    v_mfma_f32_32x32x16_bf16 v[58:73], v[86:89], v[124:127], v[58:73]
    ds_read_b64_tr_b16 v[82:83], v6 offset:36864
    ds_read_b64_tr_b16 v[84:85], v6 offset:37888
    v_mul_f32 v98, v98, v18
    v_mul_f32 v99, v99, v19
    v_cvt_pk_bf16_f32 v106, v98, v99
    s_waitcnt lgkmcnt(6)
    v_mfma_f32_32x32x16_bf16 v[42:57], v[90:93], v[128:131], v[42:57]
    ds_read_b64_tr_b16 v[86:87], v7 offset:36864
    ds_read_b64_tr_b16 v[88:89], v7 offset:37888
    v_exp_f32 v100, -v12
    v_exp_f32 v101, -v13
    v_mfma_f32_32x32x16_bf16 v[58:73], v[94:97], v[128:131], v[58:73]
    s_barrier
    ds_read_b64_tr_b16 v[90:91], v6 offset:40960
    ds_read_b64_tr_b16 v[92:93], v6 offset:41984
    v_fma_f32 v100, v100, s77, s77
    v_fma_f32 v101, v101, s77, s77
    s_waitcnt lgkmcnt(6)
    v_mfma_f32_32x32x16_bf16 v[42:57], v[74:77], v[132:135], v[42:57]
    ds_read_b64_tr_b16 v[94:95], v7 offset:40960
    ds_read_b64_tr_b16 v[96:97], v7 offset:41984
    v_rcp_f32 v100, v100
    v_rcp_f32 v101, v101
    v_mfma_f32_32x32x16_bf16 v[58:73], v[78:81], v[132:135], v[58:73]
    ds_read_b64_tr_b16 v[74:75], v6 offset:45056
    ds_read_b64_tr_b16 v[76:77], v6 offset:46080
    v_mul_f32 v100, v100, v20
    v_mul_f32 v101, v101, v21
    v_cvt_pk_bf16_f32 v107, v100, v101
    s_waitcnt lgkmcnt(6)
    v_mfma_f32_32x32x16_bf16 v[42:57], v[82:85], v[136:139], v[42:57]
    ds_read_b64_tr_b16 v[78:79], v7 offset:45056
    ds_read_b64_tr_b16 v[80:81], v7 offset:46080
    v_exp_f32 v102, -v14
    v_exp_f32 v103, -v15
    v_mfma_f32_32x32x16_bf16 v[58:73], v[86:89], v[136:139], v[58:73]
    ds_read_b64_tr_b16 v[82:83], v6 offset:49152
    ds_read_b64_tr_b16 v[84:85], v6 offset:50176
    v_fma_f32 v102, v102, s77, s77
    v_fma_f32 v103, v103, s77, s77
    s_waitcnt lgkmcnt(6)
    v_mfma_f32_32x32x16_bf16 v[42:57], v[90:93], v[140:143], v[42:57]
    ds_read_b64_tr_b16 v[86:87], v7 offset:49152
    ds_read_b64_tr_b16 v[88:89], v7 offset:50176
    v_rcp_f32 v102, v102
    v_rcp_f32 v103, v103
    v_mfma_f32_32x32x16_bf16 v[58:73], v[94:97], v[140:143], v[58:73]
    ds_read_b64_tr_b16 v[90:91], v6 offset:53248
    ds_read_b64_tr_b16 v[92:93], v6 offset:54272
    v_mul_f32 v102, v102, v22
    v_mul_f32 v103, v103, v23
    v_cvt_pk_bf16_f32 v108, v102, v103
    s_waitcnt lgkmcnt(6)
    v_mfma_f32_32x32x16_bf16 v[42:57], v[74:77], v[144:147], v[42:57]
    ds_read_b64_tr_b16 v[94:95], v7 offset:53248
    ds_read_b64_tr_b16 v[96:97], v7 offset:54272
    v_exp_f32 v104, -v16
    v_exp_f32 v105, -v17
    v_mfma_f32_32x32x16_bf16 v[58:73], v[78:81], v[144:147], v[58:73]
    ds_read_b64_tr_b16 v[74:75], v6 offset:57344
    ds_read_b64_tr_b16 v[76:77], v6 offset:58368
    v_fma_f32 v104, v104, s77, s77
    v_fma_f32 v105, v105, s77, s77
    s_waitcnt lgkmcnt(6)
    v_mfma_f32_32x32x16_bf16 v[42:57], v[82:85], v[148:151], v[42:57]
    ds_read_b64_tr_b16 v[78:79], v7 offset:57344
    ds_read_b64_tr_b16 v[80:81], v7 offset:58368
    v_rcp_f32 v104, v104
    v_rcp_f32 v105, v105
    v_mfma_f32_32x32x16_bf16 v[58:73], v[86:89], v[148:151], v[58:73]
    ds_read_b64_tr_b16 v[82:83], v6 offset:61440
    ds_read_b64_tr_b16 v[84:85], v6 offset:62464
    v_mul_f32 v104, v104, v24
    v_mul_f32 v105, v105, v25
    v_cvt_pk_bf16_f32 v109, v104, v105
    s_waitcnt lgkmcnt(6)
    v_mfma_f32_32x32x16_bf16 v[42:57], v[90:93], v[152:155], v[42:57]
    ds_read_b64_tr_b16 v[86:87], v7 offset:61440
    ds_read_b64_tr_b16 v[88:89], v7 offset:62464
    s_add_u32 s70, s69, 0
    buffer_store_dwordx4 v[106:109], v0, s[32:35], s70 offen sc1
    v_exp_f32 v98, -v26
    v_mfma_f32_32x32x16_bf16 v[58:73], v[94:97], v[152:155], v[58:73]
    ds_read_b64_tr_b16 v[90:91], v8 offset:0
    ds_read_b64_tr_b16 v[92:93], v8 offset:1024
    v_exp_f32 v99, -v27
    v_fma_f32 v98, v98, s77, s77
    s_waitcnt lgkmcnt(6)
    v_mfma_f32_32x32x16_bf16 v[42:57], v[74:77], v[156:159], v[42:57]
    ds_read_b64_tr_b16 v[94:95], v9 offset:0
    ds_read_b64_tr_b16 v[96:97], v9 offset:1024
    v_fma_f32 v99, v99, s77, s77
    v_rcp_f32 v98, v98
    v_mfma_f32_32x32x16_bf16 v[58:73], v[78:81], v[156:159], v[58:73]
    ds_read_b64_tr_b16 v[74:75], v8 offset:4096
    ds_read_b64_tr_b16 v[76:77], v8 offset:5120
    v_rcp_f32 v99, v99
    v_mul_f32 v98, v98, v34
    s_waitcnt lgkmcnt(6)
    v_mfma_f32_32x32x16_bf16 v[42:57], v[82:85], v[160:163], v[42:57]
    ds_read_b64_tr_b16 v[78:79], v9 offset:4096
    ds_read_b64_tr_b16 v[80:81], v9 offset:5120
    v_mul_f32 v99, v99, v35
    v_cvt_pk_bf16_f32 v110, v98, v99
    v_exp_f32 v100, -v28
    v_mfma_f32_32x32x16_bf16 v[58:73], v[86:89], v[160:163], v[58:73]
    s_barrier
    ds_read_b64_tr_b16 v[82:83], v8 offset:8192
    ds_read_b64_tr_b16 v[84:85], v8 offset:9216
    v_exp_f32 v101, -v29
    s_waitcnt lgkmcnt(6)
    v_mfma_f32_32x32x16_bf16 v[42:57], v[90:93], v[164:167], v[42:57]
    ds_read_b64_tr_b16 v[86:87], v9 offset:8192
    ds_read_b64_tr_b16 v[88:89], v9 offset:9216
    v_fma_f32 v100, v100, s77, s77
    v_fma_f32 v101, v101, s77, s77
    v_rcp_f32 v100, v100
    v_mfma_f32_32x32x16_bf16 v[58:73], v[94:97], v[164:167], v[58:73]
    ds_read_b64_tr_b16 v[90:91], v8 offset:12288
    ds_read_b64_tr_b16 v[92:93], v8 offset:13312
    v_rcp_f32 v101, v101
    v_mul_f32 v100, v100, v36
    s_waitcnt lgkmcnt(6)
    v_mfma_f32_32x32x16_bf16 v[42:57], v[74:77], v[168:171], v[42:57]
    ds_read_b64_tr_b16 v[94:95], v9 offset:12288
    ds_read_b64_tr_b16 v[96:97], v9 offset:13312
    v_mul_f32 v101, v101, v37
    v_cvt_pk_bf16_f32 v111, v100, v101
    v_exp_f32 v102, -v30
    v_mfma_f32_32x32x16_bf16 v[58:73], v[78:81], v[168:171], v[58:73]
    ds_read_b64_tr_b16 v[74:75], v8 offset:16384
    ds_read_b64_tr_b16 v[76:77], v8 offset:17408
    v_exp_f32 v103, -v31
    v_fma_f32 v102, v102, s77, s77
    s_waitcnt lgkmcnt(6)
    v_mfma_f32_32x32x16_bf16 v[42:57], v[82:85], v[172:175], v[42:57]
    ds_read_b64_tr_b16 v[78:79], v9 offset:16384
    ds_read_b64_tr_b16 v[80:81], v9 offset:17408
    v_fma_f32 v103, v103, s77, s77
    v_rcp_f32 v102, v102
    v_mfma_f32_32x32x16_bf16 v[58:73], v[86:89], v[172:175], v[58:73]
    ds_read_b64_tr_b16 v[82:83], v8 offset:20480
    ds_read_b64_tr_b16 v[84:85], v8 offset:21504
    v_rcp_f32 v103, v103
    v_mul_f32 v102, v102, v38
    s_waitcnt lgkmcnt(6)
    v_mfma_f32_32x32x16_bf16 v[42:57], v[90:93], v[176:179], v[42:57]
    ds_read_b64_tr_b16 v[86:87], v9 offset:20480
    ds_read_b64_tr_b16 v[88:89], v9 offset:21504
    v_mul_f32 v103, v103, v39
    v_cvt_pk_bf16_f32 v112, v102, v103
    v_exp_f32 v104, -v32
    v_mfma_f32_32x32x16_bf16 v[58:73], v[94:97], v[176:179], v[58:73]
    ds_read_b64_tr_b16 v[90:91], v8 offset:24576
    ds_read_b64_tr_b16 v[92:93], v8 offset:25600
    v_exp_f32 v105, -v33
    v_fma_f32 v104, v104, s77, s77
    s_waitcnt lgkmcnt(6)
    v_mfma_f32_32x32x16_bf16 v[42:57], v[74:77], v[180:183], v[42:57]
    ds_read_b64_tr_b16 v[94:95], v9 offset:24576
    ds_read_b64_tr_b16 v[96:97], v9 offset:25600
    v_fma_f32 v105, v105, s77, s77
    v_rcp_f32 v104, v104
    v_mfma_f32_32x32x16_bf16 v[58:73], v[78:81], v[180:183], v[58:73]
    ds_read_b64_tr_b16 v[74:75], v4 offset:0
    ds_read_b64_tr_b16 v[76:77], v4 offset:1024
    v_rcp_f32 v105, v105
    v_mul_f32 v104, v104, v40
    s_waitcnt lgkmcnt(6)
    v_mfma_f32_32x32x16_bf16 v[42:57], v[82:85], v[184:187], v[42:57]
    ds_read_b64_tr_b16 v[78:79], v5 offset:0
    ds_read_b64_tr_b16 v[80:81], v5 offset:1024
    v_mul_f32 v105, v105, v41
    v_cvt_pk_bf16_f32 v113, v104, v105
    s_add_u32 s70, s69, 1024
    buffer_store_dwordx4 v[110:113], v0, s[32:35], s70 offen sc1
    v_mfma_f32_32x32x16_bf16 v[58:73], v[86:89], v[184:187], v[58:73]
    ds_read_b64_tr_b16 v[82:83], v4 offset:4096
    ds_read_b64_tr_b16 v[84:85], v4 offset:5120
    s_waitcnt lgkmcnt(6)
    v_mfma_f32_32x32x16_bf16 v[42:57], v[90:93], v[188:191], v[42:57]
    ds_read_b64_tr_b16 v[86:87], v5 offset:4096
    ds_read_b64_tr_b16 v[88:89], v5 offset:5120
    v_mfma_f32_32x32x16_bf16 v[58:73], v[94:97], v[188:191], v[58:73]
    ds_read_b64_tr_b16 v[90:91], v4 offset:8192
    ds_read_b64_tr_b16 v[92:93], v4 offset:9216
    s_waitcnt lgkmcnt(6)
    v_mfma_f32_32x32x16_bf16 v[42:57], v[74:77], v[192:195], v[42:57]
    ds_read_b64_tr_b16 v[94:95], v5 offset:8192
    ds_read_b64_tr_b16 v[96:97], v5 offset:9216
    v_mfma_f32_32x32x16_bf16 v[58:73], v[78:81], v[192:195], v[58:73]
    s_barrier
    ds_read_b64_tr_b16 v[74:75], v4 offset:12288
    ds_read_b64_tr_b16 v[76:77], v4 offset:13312
    s_waitcnt lgkmcnt(6)
    v_mfma_f32_32x32x16_bf16 v[42:57], v[82:85], v[196:199], v[42:57]
    ds_read_b64_tr_b16 v[78:79], v5 offset:12288
    ds_read_b64_tr_b16 v[80:81], v5 offset:13312
    v_mfma_f32_32x32x16_bf16 v[58:73], v[86:89], v[196:199], v[58:73]
    ds_read_b64_tr_b16 v[82:83], v4 offset:16384
    ds_read_b64_tr_b16 v[84:85], v4 offset:17408
    s_waitcnt lgkmcnt(6)
    v_mfma_f32_32x32x16_bf16 v[42:57], v[90:93], v[200:203], v[42:57]
    ds_read_b64_tr_b16 v[86:87], v5 offset:16384
    ds_read_b64_tr_b16 v[88:89], v5 offset:17408
    v_mfma_f32_32x32x16_bf16 v[58:73], v[94:97], v[200:203], v[58:73]
    ds_read_b64_tr_b16 v[90:91], v4 offset:20480
    ds_read_b64_tr_b16 v[92:93], v4 offset:21504
    s_waitcnt lgkmcnt(6)
    v_mfma_f32_32x32x16_bf16 v[42:57], v[74:77], v[204:207], v[42:57]
    ds_read_b64_tr_b16 v[94:95], v5 offset:20480
    ds_read_b64_tr_b16 v[96:97], v5 offset:21504
    v_mfma_f32_32x32x16_bf16 v[58:73], v[78:81], v[204:207], v[58:73]
    ds_read_b64_tr_b16 v[74:75], v4 offset:24576
    ds_read_b64_tr_b16 v[76:77], v4 offset:25600
    s_waitcnt lgkmcnt(6)
    v_mfma_f32_32x32x16_bf16 v[42:57], v[82:85], v[208:211], v[42:57]
    ds_read_b64_tr_b16 v[78:79], v5 offset:24576
    ds_read_b64_tr_b16 v[80:81], v5 offset:25600
    v_mfma_f32_32x32x16_bf16 v[58:73], v[86:89], v[208:211], v[58:73]
    ds_read_b64_tr_b16 v[82:83], v4 offset:28672
    ds_read_b64_tr_b16 v[84:85], v4 offset:29696
    s_waitcnt lgkmcnt(6)
    v_mfma_f32_32x32x16_bf16 v[42:57], v[90:93], v[212:215], v[42:57]
    ds_read_b64_tr_b16 v[86:87], v5 offset:28672
    ds_read_b64_tr_b16 v[88:89], v5 offset:29696
    v_mfma_f32_32x32x16_bf16 v[58:73], v[94:97], v[212:215], v[58:73]
    ds_read_b64_tr_b16 v[90:91], v4 offset:32768
    ds_read_b64_tr_b16 v[92:93], v4 offset:33792
    s_waitcnt lgkmcnt(6)
    v_mfma_f32_32x32x16_bf16 v[42:57], v[74:77], v[216:219], v[42:57]
    ds_read_b64_tr_b16 v[94:95], v5 offset:32768
    ds_read_b64_tr_b16 v[96:97], v5 offset:33792
    v_mfma_f32_32x32x16_bf16 v[58:73], v[78:81], v[216:219], v[58:73]
    ds_read_b64_tr_b16 v[74:75], v4 offset:36864
    ds_read_b64_tr_b16 v[76:77], v4 offset:37888
    s_waitcnt lgkmcnt(6)
    v_mfma_f32_32x32x16_bf16 v[42:57], v[82:85], v[220:223], v[42:57]
    ds_read_b64_tr_b16 v[78:79], v5 offset:36864
    ds_read_b64_tr_b16 v[80:81], v5 offset:37888
    v_mfma_f32_32x32x16_bf16 v[58:73], v[86:89], v[220:223], v[58:73]
    ds_read_b64_tr_b16 v[82:83], v4 offset:40960
    ds_read_b64_tr_b16 v[84:85], v4 offset:41984
    s_waitcnt lgkmcnt(6)
    v_mfma_f32_32x32x16_bf16 v[42:57], v[90:93], v[224:227], v[42:57]
    ds_read_b64_tr_b16 v[86:87], v5 offset:40960
    ds_read_b64_tr_b16 v[88:89], v5 offset:41984
    v_mfma_f32_32x32x16_bf16 v[58:73], v[94:97], v[224:227], v[58:73]
    s_barrier
    ds_read_b64_tr_b16 v[90:91], v4 offset:45056
    ds_read_b64_tr_b16 v[92:93], v4 offset:46080
    s_waitcnt lgkmcnt(6)
    v_mfma_f32_32x32x16_bf16 v[42:57], v[74:77], v[228:231], v[42:57]
    ds_read_b64_tr_b16 v[94:95], v5 offset:45056
    ds_read_b64_tr_b16 v[96:97], v5 offset:46080
    v_mfma_f32_32x32x16_bf16 v[58:73], v[78:81], v[228:231], v[58:73]
    ds_read_b64_tr_b16 v[74:75], v4 offset:49152
    ds_read_b64_tr_b16 v[76:77], v4 offset:50176
    s_waitcnt lgkmcnt(6)
    v_mfma_f32_32x32x16_bf16 v[42:57], v[82:85], v[232:235], v[42:57]
    ds_read_b64_tr_b16 v[78:79], v5 offset:49152
    ds_read_b64_tr_b16 v[80:81], v5 offset:50176
    v_mfma_f32_32x32x16_bf16 v[58:73], v[86:89], v[232:235], v[58:73]
    v_add_u32 v6, 0x10000, v2
    v_add_u32 v7, 0x10000, v3
    v_add_u32 v8, 0x20000, v2
    v_add_u32 v9, 0x20000, v3
    ds_read_b64_tr_b16 v[82:83], v2 offset:53248
    ds_read_b64_tr_b16 v[84:85], v2 offset:54272
    s_waitcnt lgkmcnt(6)
    v_mfma_f32_32x32x16_bf16 v[42:57], v[90:93], v[236:239], v[42:57]
    ds_read_b64_tr_b16 v[86:87], v3 offset:53248
    ds_read_b64_tr_b16 v[88:89], v3 offset:54272
    v_mfma_f32_32x32x16_bf16 v[58:73], v[94:97], v[236:239], v[58:73]
    ds_read_b64_tr_b16 v[90:91], v2 offset:57344
    ds_read_b64_tr_b16 v[92:93], v2 offset:58368
    s_waitcnt lgkmcnt(6)
    v_mfma_f32_32x32x16_bf16 v[42:57], v[74:77], v[240:243], v[42:57]
    ds_read_b64_tr_b16 v[94:95], v3 offset:57344
    ds_read_b64_tr_b16 v[96:97], v3 offset:58368
    v_mfma_f32_32x32x16_bf16 v[58:73], v[78:81], v[240:243], v[58:73]
    ds_read_b64_tr_b16 v[74:75], v2 offset:61440
    ds_read_b64_tr_b16 v[76:77], v2 offset:62464
    s_waitcnt lgkmcnt(6)
    v_mfma_f32_32x32x16_bf16 v[10:25], v[82:85], v[116:119], 0
    ds_read_b64_tr_b16 v[78:79], v3 offset:61440
    ds_read_b64_tr_b16 v[80:81], v3 offset:62464
    v_mfma_f32_32x32x16_bf16 v[26:41], v[86:89], v[116:119], 0
    ds_read_b64_tr_b16 v[82:83], v6 offset:0
    ds_read_b64_tr_b16 v[84:85], v6 offset:1024
    s_waitcnt lgkmcnt(6)
    v_mfma_f32_32x32x16_bf16 v[10:25], v[90:93], v[120:123], v[10:25]
    ds_read_b64_tr_b16 v[86:87], v7 offset:0
    ds_read_b64_tr_b16 v[88:89], v7 offset:1024
    v_exp_f32 v98, -v42
    v_exp_f32 v99, -v43
    v_mfma_f32_32x32x16_bf16 v[26:41], v[94:97], v[120:123], v[26:41]
    ds_read_b64_tr_b16 v[90:91], v6 offset:4096
    ds_read_b64_tr_b16 v[92:93], v6 offset:5120
    v_fma_f32 v98, v98, s77, s77
    v_fma_f32 v99, v99, s77, s77
    s_waitcnt lgkmcnt(6)
    v_mfma_f32_32x32x16_bf16 v[10:25], v[74:77], v[124:127], v[10:25]
    ds_read_b64_tr_b16 v[94:95], v7 offset:4096
    ds_read_b64_tr_b16 v[96:97], v7 offset:5120
    v_rcp_f32 v98, v98
    v_rcp_f32 v99, v99
    v_mfma_f32_32x32x16_bf16 v[26:41], v[78:81], v[124:127], v[26:41]
    ds_read_b64_tr_b16 v[74:75], v6 offset:8192
    ds_read_b64_tr_b16 v[76:77], v6 offset:9216
    v_mul_f32 v98, v98, v50
    v_mul_f32 v99, v99, v51
    v_cvt_pk_bf16_f32 v106, v98, v99
    s_waitcnt lgkmcnt(6)
    v_mfma_f32_32x32x16_bf16 v[10:25], v[82:85], v[128:131], v[10:25]
    ds_read_b64_tr_b16 v[78:79], v7 offset:8192
    ds_read_b64_tr_b16 v[80:81], v7 offset:9216
    v_exp_f32 v100, -v44
    v_exp_f32 v101, -v45
    v_mfma_f32_32x32x16_bf16 v[26:41], v[86:89], v[128:131], v[26:41]
    s_barrier
    ds_read_b64_tr_b16 v[82:83], v6 offset:12288
    ds_read_b64_tr_b16 v[84:85], v6 offset:13312
    v_fma_f32 v100, v100, s77, s77
    v_fma_f32 v101, v101, s77, s77
    s_waitcnt lgkmcnt(6)
    v_mfma_f32_32x32x16_bf16 v[10:25], v[90:93], v[132:135], v[10:25]
    ds_read_b64_tr_b16 v[86:87], v7 offset:12288
    ds_read_b64_tr_b16 v[88:89], v7 offset:13312
    v_rcp_f32 v100, v100
    v_rcp_f32 v101, v101
    v_mfma_f32_32x32x16_bf16 v[26:41], v[94:97], v[132:135], v[26:41]
    ds_read_b64_tr_b16 v[90:91], v6 offset:16384
    ds_read_b64_tr_b16 v[92:93], v6 offset:17408
    v_mul_f32 v100, v100, v52
    v_mul_f32 v101, v101, v53
    v_cvt_pk_bf16_f32 v107, v100, v101
    s_waitcnt lgkmcnt(6)
    v_mfma_f32_32x32x16_bf16 v[10:25], v[74:77], v[136:139], v[10:25]
    ds_read_b64_tr_b16 v[94:95], v7 offset:16384
    ds_read_b64_tr_b16 v[96:97], v7 offset:17408
    v_exp_f32 v102, -v46
    v_exp_f32 v103, -v47
    v_mfma_f32_32x32x16_bf16 v[26:41], v[78:81], v[136:139], v[26:41]
    ds_read_b64_tr_b16 v[74:75], v6 offset:20480
    ds_read_b64_tr_b16 v[76:77], v6 offset:21504
    v_fma_f32 v102, v102, s77, s77
    v_fma_f32 v103, v103, s77, s77
    s_waitcnt lgkmcnt(6)
    v_mfma_f32_32x32x16_bf16 v[10:25], v[82:85], v[140:143], v[10:25]
    ds_read_b64_tr_b16 v[78:79], v7 offset:20480
    ds_read_b64_tr_b16 v[80:81], v7 offset:21504
    v_rcp_f32 v102, v102
    v_rcp_f32 v103, v103
    s_waitcnt vmcnt(0)
    s_add_u32 s71, s73, 0
    s_mov_b64 exec, 1
    buffer_store_dword v114, v0, s[32:35], s71 offen sc1
    s_mov_b64 exec, -1
    v_mfma_f32_32x32x16_bf16 v[26:41], v[86:89], v[140:143], v[26:41]
    ds_read_b64_tr_b16 v[82:83], v6 offset:24576
    ds_read_b64_tr_b16 v[84:85], v6 offset:25600
    v_mul_f32 v102, v102, v54
    v_mul_f32 v103, v103, v55
    v_cvt_pk_bf16_f32 v108, v102, v103
    s_waitcnt lgkmcnt(6)
    v_mfma_f32_32x32x16_bf16 v[10:25], v[90:93], v[144:147], v[10:25]
    ds_read_b64_tr_b16 v[86:87], v7 offset:24576
    ds_read_b64_tr_b16 v[88:89], v7 offset:25600
    v_exp_f32 v104, -v48
    v_exp_f32 v105, -v49
    v_mfma_f32_32x32x16_bf16 v[26:41], v[94:97], v[144:147], v[26:41]
    ds_read_b64_tr_b16 v[90:91], v6 offset:28672
    ds_read_b64_tr_b16 v[92:93], v6 offset:29696
    v_fma_f32 v104, v104, s77, s77
    v_fma_f32 v105, v105, s77, s77
    s_waitcnt lgkmcnt(6)
    v_mfma_f32_32x32x16_bf16 v[10:25], v[74:77], v[148:151], v[10:25]
    ds_read_b64_tr_b16 v[94:95], v7 offset:28672
    ds_read_b64_tr_b16 v[96:97], v7 offset:29696
    v_rcp_f32 v104, v104
    v_rcp_f32 v105, v105
    v_mfma_f32_32x32x16_bf16 v[26:41], v[78:81], v[148:151], v[26:41]
    ds_read_b64_tr_b16 v[74:75], v6 offset:32768
    ds_read_b64_tr_b16 v[76:77], v6 offset:33792
    v_mul_f32 v104, v104, v56
    v_mul_f32 v105, v105, v57
    v_cvt_pk_bf16_f32 v109, v104, v105
    s_waitcnt lgkmcnt(6)
    v_mfma_f32_32x32x16_bf16 v[10:25], v[82:85], v[152:155], v[10:25]
    ds_read_b64_tr_b16 v[78:79], v7 offset:32768
    ds_read_b64_tr_b16 v[80:81], v7 offset:33792
    s_add_u32 s70, s69, 2048
    buffer_store_dwordx4 v[106:109], v0, s[32:35], s70 offen sc1
    v_exp_f32 v98, -v58
    v_mfma_f32_32x32x16_bf16 v[26:41], v[86:89], v[152:155], v[26:41]
    ds_read_b64_tr_b16 v[82:83], v6 offset:36864
    ds_read_b64_tr_b16 v[84:85], v6 offset:37888
    v_exp_f32 v99, -v59
    v_fma_f32 v98, v98, s77, s77
    s_waitcnt lgkmcnt(6)
    v_mfma_f32_32x32x16_bf16 v[10:25], v[90:93], v[156:159], v[10:25]
    ds_read_b64_tr_b16 v[86:87], v7 offset:36864
    ds_read_b64_tr_b16 v[88:89], v7 offset:37888
    v_fma_f32 v99, v99, s77, s77
    v_rcp_f32 v98, v98
    v_mfma_f32_32x32x16_bf16 v[26:41], v[94:97], v[156:159], v[26:41]
    ds_read_b64_tr_b16 v[90:91], v6 offset:40960
    ds_read_b64_tr_b16 v[92:93], v6 offset:41984
    v_rcp_f32 v99, v99
    v_mul_f32 v98, v98, v66
    s_waitcnt lgkmcnt(6)
    v_mfma_f32_32x32x16_bf16 v[10:25], v[74:77], v[160:163], v[10:25]
    ds_read_b64_tr_b16 v[94:95], v7 offset:40960
    ds_read_b64_tr_b16 v[96:97], v7 offset:41984
    v_mul_f32 v99, v99, v67
    v_cvt_pk_bf16_f32 v110, v98, v99
    v_exp_f32 v100, -v60
    v_mfma_f32_32x32x16_bf16 v[26:41], v[78:81], v[160:163], v[26:41]
    s_barrier
    ds_read_b64_tr_b16 v[74:75], v6 offset:45056
    ds_read_b64_tr_b16 v[76:77], v6 offset:46080
    v_exp_f32 v101, -v61
    s_waitcnt lgkmcnt(6)
    v_mfma_f32_32x32x16_bf16 v[10:25], v[82:85], v[164:167], v[10:25]
    ds_read_b64_tr_b16 v[78:79], v7 offset:45056
    ds_read_b64_tr_b16 v[80:81], v7 offset:46080
    v_fma_f32 v100, v100, s77, s77
    v_fma_f32 v101, v101, s77, s77
    v_rcp_f32 v100, v100
    v_mfma_f32_32x32x16_bf16 v[26:41], v[86:89], v[164:167], v[26:41]
    ds_read_b64_tr_b16 v[82:83], v6 offset:49152
    ds_read_b64_tr_b16 v[84:85], v6 offset:50176
    v_rcp_f32 v101, v101
    v_mul_f32 v100, v100, v68
    s_waitcnt lgkmcnt(6)
    v_mfma_f32_32x32x16_bf16 v[10:25], v[90:93], v[168:171], v[10:25]
    ds_read_b64_tr_b16 v[86:87], v7 offset:49152
    ds_read_b64_tr_b16 v[88:89], v7 offset:50176
    v_mul_f32 v101, v101, v69
    v_cvt_pk_bf16_f32 v111, v100, v101
    v_exp_f32 v102, -v62
    v_mfma_f32_32x32x16_bf16 v[26:41], v[94:97], v[168:171], v[26:41]
    ds_read_b64_tr_b16 v[90:91], v6 offset:53248
    ds_read_b64_tr_b16 v[92:93], v6 offset:54272
    v_exp_f32 v103, -v63
    v_fma_f32 v102, v102, s77, s77
    s_waitcnt lgkmcnt(6)
    v_mfma_f32_32x32x16_bf16 v[10:25], v[74:77], v[172:175], v[10:25]
    ds_read_b64_tr_b16 v[94:95], v7 offset:53248
    ds_read_b64_tr_b16 v[96:97], v7 offset:54272
    v_fma_f32 v103, v103, s77, s77
    v_rcp_f32 v102, v102
    v_mfma_f32_32x32x16_bf16 v[26:41], v[78:81], v[172:175], v[26:41]
    ds_read_b64_tr_b16 v[74:75], v6 offset:57344
    ds_read_b64_tr_b16 v[76:77], v6 offset:58368
    v_rcp_f32 v103, v103
    v_mul_f32 v102, v102, v70
    s_waitcnt lgkmcnt(6)
    v_mfma_f32_32x32x16_bf16 v[10:25], v[82:85], v[176:179], v[10:25]
    ds_read_b64_tr_b16 v[78:79], v7 offset:57344
    ds_read_b64_tr_b16 v[80:81], v7 offset:58368
    v_mul_f32 v103, v103, v71
    v_cvt_pk_bf16_f32 v112, v102, v103
    v_exp_f32 v104, -v64
    v_mfma_f32_32x32x16_bf16 v[26:41], v[86:89], v[176:179], v[26:41]
    ds_read_b64_tr_b16 v[82:83], v6 offset:61440
    ds_read_b64_tr_b16 v[84:85], v6 offset:62464
    v_exp_f32 v105, -v65
    v_fma_f32 v104, v104, s77, s77
    s_waitcnt lgkmcnt(6)
    v_mfma_f32_32x32x16_bf16 v[10:25], v[90:93], v[180:183], v[10:25]
    ds_read_b64_tr_b16 v[86:87], v7 offset:61440
    ds_read_b64_tr_b16 v[88:89], v7 offset:62464
    v_fma_f32 v105, v105, s77, s77
    v_rcp_f32 v104, v104
    v_mfma_f32_32x32x16_bf16 v[26:41], v[94:97], v[180:183], v[26:41]
    ds_read_b64_tr_b16 v[90:91], v8 offset:0
    ds_read_b64_tr_b16 v[92:93], v8 offset:1024
    v_rcp_f32 v105, v105
    v_mul_f32 v104, v104, v72
    s_waitcnt lgkmcnt(6)
    v_mfma_f32_32x32x16_bf16 v[10:25], v[74:77], v[184:187], v[10:25]
    ds_read_b64_tr_b16 v[94:95], v9 offset:0
    ds_read_b64_tr_b16 v[96:97], v9 offset:1024
    v_mul_f32 v105, v105, v73
    v_cvt_pk_bf16_f32 v113, v104, v105
    s_add_u32 s70, s69, 3072
    buffer_store_dwordx4 v[110:113], v0, s[32:35], s70 offen sc1
    v_mfma_f32_32x32x16_bf16 v[26:41], v[78:81], v[184:187], v[26:41]
    ds_read_b64_tr_b16 v[74:75], v8 offset:4096
    ds_read_b64_tr_b16 v[76:77], v8 offset:5120
    s_waitcnt lgkmcnt(6)
    v_mfma_f32_32x32x16_bf16 v[10:25], v[82:85], v[188:191], v[10:25]
    ds_read_b64_tr_b16 v[78:79], v9 offset:4096
    ds_read_b64_tr_b16 v[80:81], v9 offset:5120
    v_mfma_f32_32x32x16_bf16 v[26:41], v[86:89], v[188:191], v[26:41]
    ds_read_b64_tr_b16 v[82:83], v8 offset:8192
    ds_read_b64_tr_b16 v[84:85], v8 offset:9216
    s_waitcnt lgkmcnt(6)
    v_mfma_f32_32x32x16_bf16 v[10:25], v[90:93], v[192:195], v[10:25]
    ds_read_b64_tr_b16 v[86:87], v9 offset:8192
    ds_read_b64_tr_b16 v[88:89], v9 offset:9216
    v_mfma_f32_32x32x16_bf16 v[26:41], v[94:97], v[192:195], v[26:41]
    s_barrier
    ds_read_b64_tr_b16 v[90:91], v8 offset:12288
    ds_read_b64_tr_b16 v[92:93], v8 offset:13312
    s_waitcnt lgkmcnt(6)
    v_mfma_f32_32x32x16_bf16 v[10:25], v[74:77], v[196:199], v[10:25]
    ds_read_b64_tr_b16 v[94:95], v9 offset:12288
    ds_read_b64_tr_b16 v[96:97], v9 offset:13312
    v_mfma_f32_32x32x16_bf16 v[26:41], v[78:81], v[196:199], v[26:41]
    ds_read_b64_tr_b16 v[74:75], v8 offset:16384
    ds_read_b64_tr_b16 v[76:77], v8 offset:17408
    s_waitcnt lgkmcnt(6)
    v_mfma_f32_32x32x16_bf16 v[10:25], v[82:85], v[200:203], v[10:25]
    ds_read_b64_tr_b16 v[78:79], v9 offset:16384
    ds_read_b64_tr_b16 v[80:81], v9 offset:17408
    v_mfma_f32_32x32x16_bf16 v[26:41], v[86:89], v[200:203], v[26:41]
    ds_read_b64_tr_b16 v[82:83], v8 offset:20480
    ds_read_b64_tr_b16 v[84:85], v8 offset:21504
    s_waitcnt lgkmcnt(6)
    v_mfma_f32_32x32x16_bf16 v[10:25], v[90:93], v[204:207], v[10:25]
    ds_read_b64_tr_b16 v[86:87], v9 offset:20480
    ds_read_b64_tr_b16 v[88:89], v9 offset:21504
    v_mfma_f32_32x32x16_bf16 v[26:41], v[94:97], v[204:207], v[26:41]
    ds_read_b64_tr_b16 v[90:91], v8 offset:24576
    ds_read_b64_tr_b16 v[92:93], v8 offset:25600
    s_waitcnt lgkmcnt(6)
    v_mfma_f32_32x32x16_bf16 v[10:25], v[74:77], v[208:211], v[10:25]
    ds_read_b64_tr_b16 v[94:95], v9 offset:24576
    ds_read_b64_tr_b16 v[96:97], v9 offset:25600
    v_mfma_f32_32x32x16_bf16 v[26:41], v[78:81], v[208:211], v[26:41]
    ds_read_b64_tr_b16 v[74:75], v2 offset:0
    ds_read_b64_tr_b16 v[76:77], v2 offset:1024
    s_waitcnt lgkmcnt(6)
    v_mfma_f32_32x32x16_bf16 v[10:25], v[82:85], v[212:215], v[10:25]
    ds_read_b64_tr_b16 v[78:79], v3 offset:0
    ds_read_b64_tr_b16 v[80:81], v3 offset:1024
    v_mfma_f32_32x32x16_bf16 v[26:41], v[86:89], v[212:215], v[26:41]
    ds_read_b64_tr_b16 v[82:83], v2 offset:4096
    ds_read_b64_tr_b16 v[84:85], v2 offset:5120
    s_waitcnt lgkmcnt(6)
    v_mfma_f32_32x32x16_bf16 v[10:25], v[90:93], v[216:219], v[10:25]
    ds_read_b64_tr_b16 v[86:87], v3 offset:4096
    ds_read_b64_tr_b16 v[88:89], v3 offset:5120
    v_mfma_f32_32x32x16_bf16 v[26:41], v[94:97], v[216:219], v[26:41]
    ds_read_b64_tr_b16 v[90:91], v2 offset:8192
    ds_read_b64_tr_b16 v[92:93], v2 offset:9216
    s_waitcnt lgkmcnt(6)
    v_mfma_f32_32x32x16_bf16 v[10:25], v[74:77], v[220:223], v[10:25]
    ds_read_b64_tr_b16 v[94:95], v3 offset:8192
    ds_read_b64_tr_b16 v[96:97], v3 offset:9216
    v_mfma_f32_32x32x16_bf16 v[26:41], v[78:81], v[220:223], v[26:41]
    ds_read_b64_tr_b16 v[74:75], v2 offset:12288
    ds_read_b64_tr_b16 v[76:77], v2 offset:13312
    s_waitcnt lgkmcnt(6)
    v_mfma_f32_32x32x16_bf16 v[10:25], v[82:85], v[224:227], v[10:25]
    ds_read_b64_tr_b16 v[78:79], v3 offset:12288
    ds_read_b64_tr_b16 v[80:81], v3 offset:13312
    v_mfma_f32_32x32x16_bf16 v[26:41], v[86:89], v[224:227], v[26:41]
    ds_read_b64_tr_b16 v[82:83], v2 offset:16384
    ds_read_b64_tr_b16 v[84:85], v2 offset:17408
    s_waitcnt lgkmcnt(6)
    v_mfma_f32_32x32x16_bf16 v[10:25], v[90:93], v[228:231], v[10:25]
    ds_read_b64_tr_b16 v[86:87], v3 offset:16384
    ds_read_b64_tr_b16 v[88:89], v3 offset:17408
    v_mfma_f32_32x32x16_bf16 v[26:41], v[94:97], v[228:231], v[26:41]
    ds_read_b64_tr_b16 v[90:91], v2 offset:20480
    ds_read_b64_tr_b16 v[92:93], v2 offset:21504
    s_waitcnt lgkmcnt(6)
    v_mfma_f32_32x32x16_bf16 v[10:25], v[74:77], v[232:235], v[10:25]
    ds_read_b64_tr_b16 v[94:95], v3 offset:20480
    ds_read_b64_tr_b16 v[96:97], v3 offset:21504
    v_mfma_f32_32x32x16_bf16 v[26:41], v[78:81], v[232:235], v[26:41]
    v_add_u32 v6, 0x10000, v4
    v_add_u32 v7, 0x10000, v5
    v_add_u32 v8, 0x20000, v4
    v_add_u32 v9, 0x20000, v5
    ds_read_b64_tr_b16 v[74:75], v4 offset:53248
    ds_read_b64_tr_b16 v[76:77], v4 offset:54272
    s_waitcnt lgkmcnt(6)
    v_mfma_f32_32x32x16_bf16 v[10:25], v[82:85], v[236:239], v[10:25]
    ds_read_b64_tr_b16 v[78:79], v5 offset:53248
    ds_read_b64_tr_b16 v[80:81], v5 offset:54272
    v_mfma_f32_32x32x16_bf16 v[26:41], v[86:89], v[236:239], v[26:41]
    ds_read_b64_tr_b16 v[82:83], v4 offset:57344
    ds_read_b64_tr_b16 v[84:85], v4 offset:58368
    s_waitcnt lgkmcnt(6)
    v_mfma_f32_32x32x16_bf16 v[10:25], v[90:93], v[240:243], v[10:25]
    ds_read_b64_tr_b16 v[86:87], v5 offset:57344
    ds_read_b64_tr_b16 v[88:89], v5 offset:58368
    v_mfma_f32_32x32x16_bf16 v[26:41], v[94:97], v[240:243], v[26:41]
    ds_read_b64_tr_b16 v[90:91], v4 offset:61440
    ds_read_b64_tr_b16 v[92:93], v4 offset:62464
    s_waitcnt lgkmcnt(6)
    v_mfma_f32_32x32x16_bf16 v[42:57], v[74:77], v[116:119], 0
    ds_read_b64_tr_b16 v[94:95], v5 offset:61440
    ds_read_b64_tr_b16 v[96:97], v5 offset:62464
    v_mfma_f32_32x32x16_bf16 v[58:73], v[78:81], v[116:119], 0
    ds_read_b64_tr_b16 v[74:75], v6 offset:0
    ds_read_b64_tr_b16 v[76:77], v6 offset:1024
    s_waitcnt lgkmcnt(6)
    v_mfma_f32_32x32x16_bf16 v[42:57], v[82:85], v[120:123], v[42:57]
    ds_read_b64_tr_b16 v[78:79], v7 offset:0
    ds_read_b64_tr_b16 v[80:81], v7 offset:1024
    v_exp_f32 v98, -v10
    v_exp_f32 v99, -v11
    v_mfma_f32_32x32x16_bf16 v[58:73], v[86:89], v[120:123], v[58:73]
    ds_read_b64_tr_b16 v[82:83], v6 offset:4096
    ds_read_b64_tr_b16 v[84:85], v6 offset:5120
    v_fma_f32 v98, v98, s77, s77
    v_fma_f32 v99, v99, s77, s77
    s_waitcnt lgkmcnt(6)
    v_mfma_f32_32x32x16_bf16 v[42:57], v[90:93], v[124:127], v[42:57]
    ds_read_b64_tr_b16 v[86:87], v7 offset:4096
    ds_read_b64_tr_b16 v[88:89], v7 offset:5120
    v_rcp_f32 v98, v98
    v_rcp_f32 v99, v99
    v_mfma_f32_32x32x16_bf16 v[58:73], v[94:97], v[124:127], v[58:73]
    ds_read_b64_tr_b16 v[90:91], v6 offset:8192
    ds_read_b64_tr_b16 v[92:93], v6 offset:9216
    v_mul_f32 v98, v98, v18
    v_mul_f32 v99, v99, v19
    v_cvt_pk_bf16_f32 v106, v98, v99
    s_waitcnt lgkmcnt(6)
    v_mfma_f32_32x32x16_bf16 v[42:57], v[74:77], v[128:131], v[42:57]
    ds_read_b64_tr_b16 v[94:95], v7 offset:8192
    ds_read_b64_tr_b16 v[96:97], v7 offset:9216
    v_exp_f32 v100, -v12
    v_exp_f32 v101, -v13
    v_mfma_f32_32x32x16_bf16 v[58:73], v[78:81], v[128:131], v[58:73]
    s_barrier
    ds_read_b64_tr_b16 v[74:75], v6 offset:12288
    ds_read_b64_tr_b16 v[76:77], v6 offset:13312
    v_fma_f32 v100, v100, s77, s77
    v_fma_f32 v101, v101, s77, s77
    s_waitcnt lgkmcnt(6)
    v_mfma_f32_32x32x16_bf16 v[42:57], v[82:85], v[132:135], v[42:57]
    ds_read_b64_tr_b16 v[78:79], v7 offset:12288
    ds_read_b64_tr_b16 v[80:81], v7 offset:13312
    v_rcp_f32 v100, v100
    v_rcp_f32 v101, v101
    v_mfma_f32_32x32x16_bf16 v[58:73], v[86:89], v[132:135], v[58:73]
    ds_read_b64_tr_b16 v[82:83], v6 offset:16384
    ds_read_b64_tr_b16 v[84:85], v6 offset:17408
    v_mul_f32 v100, v100, v20
    v_mul_f32 v101, v101, v21
    v_cvt_pk_bf16_f32 v107, v100, v101
    s_waitcnt lgkmcnt(6)
    v_mfma_f32_32x32x16_bf16 v[42:57], v[90:93], v[136:139], v[42:57]
    ds_read_b64_tr_b16 v[86:87], v7 offset:16384
    ds_read_b64_tr_b16 v[88:89], v7 offset:17408
    v_exp_f32 v102, -v14
    v_exp_f32 v103, -v15
    v_mfma_f32_32x32x16_bf16 v[58:73], v[94:97], v[136:139], v[58:73]
    ds_read_b64_tr_b16 v[90:91], v6 offset:20480
    ds_read_b64_tr_b16 v[92:93], v6 offset:21504
    v_fma_f32 v102, v102, s77, s77
    v_fma_f32 v103, v103, s77, s77
    s_waitcnt lgkmcnt(6)
    v_mfma_f32_32x32x16_bf16 v[42:57], v[74:77], v[140:143], v[42:57]
    ds_read_b64_tr_b16 v[94:95], v7 offset:20480
    ds_read_b64_tr_b16 v[96:97], v7 offset:21504
    v_rcp_f32 v102, v102
    v_rcp_f32 v103, v103
    s_waitcnt vmcnt(0)
    s_add_u32 s71, s73, 512
    s_mov_b64 exec, 1
    buffer_store_dword v114, v0, s[32:35], s71 offen sc1
    s_mov_b64 exec, -1
    v_mfma_f32_32x32x16_bf16 v[58:73], v[78:81], v[140:143], v[58:73]
    ds_read_b64_tr_b16 v[74:75], v6 offset:24576
    ds_read_b64_tr_b16 v[76:77], v6 offset:25600
    v_mul_f32 v102, v102, v22
    v_mul_f32 v103, v103, v23
    v_cvt_pk_bf16_f32 v108, v102, v103
    s_waitcnt lgkmcnt(6)
    v_mfma_f32_32x32x16_bf16 v[42:57], v[82:85], v[144:147], v[42:57]
    ds_read_b64_tr_b16 v[78:79], v7 offset:24576
    ds_read_b64_tr_b16 v[80:81], v7 offset:25600
    v_exp_f32 v104, -v16
    v_exp_f32 v105, -v17
    v_mfma_f32_32x32x16_bf16 v[58:73], v[86:89], v[144:147], v[58:73]
    ds_read_b64_tr_b16 v[82:83], v6 offset:28672
    ds_read_b64_tr_b16 v[84:85], v6 offset:29696
    v_fma_f32 v104, v104, s77, s77
    v_fma_f32 v105, v105, s77, s77
    s_waitcnt lgkmcnt(6)
    v_mfma_f32_32x32x16_bf16 v[42:57], v[90:93], v[148:151], v[42:57]
    ds_read_b64_tr_b16 v[86:87], v7 offset:28672
    ds_read_b64_tr_b16 v[88:89], v7 offset:29696
    v_rcp_f32 v104, v104
    v_rcp_f32 v105, v105
    v_mfma_f32_32x32x16_bf16 v[58:73], v[94:97], v[148:151], v[58:73]
    ds_read_b64_tr_b16 v[90:91], v6 offset:32768
    ds_read_b64_tr_b16 v[92:93], v6 offset:33792
    v_mul_f32 v104, v104, v24
    v_mul_f32 v105, v105, v25
    v_cvt_pk_bf16_f32 v109, v104, v105
    s_waitcnt lgkmcnt(6)
    v_mfma_f32_32x32x16_bf16 v[42:57], v[74:77], v[152:155], v[42:57]
    ds_read_b64_tr_b16 v[94:95], v7 offset:32768
    ds_read_b64_tr_b16 v[96:97], v7 offset:33792
    s_add_u32 s70, s78, 4096
    buffer_store_dwordx4 v[106:109], v0, s[32:35], s70 offen sc1
    v_exp_f32 v98, -v26
    v_mfma_f32_32x32x16_bf16 v[58:73], v[78:81], v[152:155], v[58:73]
    ds_read_b64_tr_b16 v[74:75], v6 offset:36864
    ds_read_b64_tr_b16 v[76:77], v6 offset:37888
    v_exp_f32 v99, -v27
    v_fma_f32 v98, v98, s77, s77
    s_waitcnt lgkmcnt(6)
    v_mfma_f32_32x32x16_bf16 v[42:57], v[82:85], v[156:159], v[42:57]
    ds_read_b64_tr_b16 v[78:79], v7 offset:36864
    ds_read_b64_tr_b16 v[80:81], v7 offset:37888
    v_fma_f32 v99, v99, s77, s77
    v_rcp_f32 v98, v98
    v_mfma_f32_32x32x16_bf16 v[58:73], v[86:89], v[156:159], v[58:73]
    ds_read_b64_tr_b16 v[82:83], v6 offset:40960
    ds_read_b64_tr_b16 v[84:85], v6 offset:41984
    v_rcp_f32 v99, v99
    v_mul_f32 v98, v98, v34
    s_waitcnt lgkmcnt(6)
    v_mfma_f32_32x32x16_bf16 v[42:57], v[90:93], v[160:163], v[42:57]
    ds_read_b64_tr_b16 v[86:87], v7 offset:40960
    ds_read_b64_tr_b16 v[88:89], v7 offset:41984
    v_mul_f32 v99, v99, v35
    v_cvt_pk_bf16_f32 v110, v98, v99
    v_exp_f32 v100, -v28
    v_mfma_f32_32x32x16_bf16 v[58:73], v[94:97], v[160:163], v[58:73]
    s_barrier
    ds_read_b64_tr_b16 v[90:91], v6 offset:45056
    ds_read_b64_tr_b16 v[92:93], v6 offset:46080
    v_exp_f32 v101, -v29
    s_waitcnt lgkmcnt(6)
    v_mfma_f32_32x32x16_bf16 v[42:57], v[74:77], v[164:167], v[42:57]
    ds_read_b64_tr_b16 v[94:95], v7 offset:45056
    ds_read_b64_tr_b16 v[96:97], v7 offset:46080
    v_fma_f32 v100, v100, s77, s77
    v_fma_f32 v101, v101, s77, s77
    v_rcp_f32 v100, v100
    v_mfma_f32_32x32x16_bf16 v[58:73], v[78:81], v[164:167], v[58:73]
    ds_read_b64_tr_b16 v[74:75], v6 offset:49152
    ds_read_b64_tr_b16 v[76:77], v6 offset:50176
    v_rcp_f32 v101, v101
    v_mul_f32 v100, v100, v36
    s_waitcnt lgkmcnt(6)
    v_mfma_f32_32x32x16_bf16 v[42:57], v[82:85], v[168:171], v[42:57]
    ds_read_b64_tr_b16 v[78:79], v7 offset:49152
    ds_read_b64_tr_b16 v[80:81], v7 offset:50176
    v_mul_f32 v101, v101, v37
    v_cvt_pk_bf16_f32 v111, v100, v101
    v_exp_f32 v102, -v30
    v_mfma_f32_32x32x16_bf16 v[58:73], v[86:89], v[168:171], v[58:73]
    ds_read_b64_tr_b16 v[82:83], v6 offset:53248
    ds_read_b64_tr_b16 v[84:85], v6 offset:54272
    v_exp_f32 v103, -v31
    v_fma_f32 v102, v102, s77, s77
    s_waitcnt lgkmcnt(6)
    v_mfma_f32_32x32x16_bf16 v[42:57], v[90:93], v[172:175], v[42:57]
    ds_read_b64_tr_b16 v[86:87], v7 offset:53248
    ds_read_b64_tr_b16 v[88:89], v7 offset:54272
    v_fma_f32 v103, v103, s77, s77
    v_rcp_f32 v102, v102
    v_mfma_f32_32x32x16_bf16 v[58:73], v[94:97], v[172:175], v[58:73]
    ds_read_b64_tr_b16 v[90:91], v6 offset:57344
    ds_read_b64_tr_b16 v[92:93], v6 offset:58368
    v_rcp_f32 v103, v103
    v_mul_f32 v102, v102, v38
    s_waitcnt lgkmcnt(6)
    v_mfma_f32_32x32x16_bf16 v[42:57], v[74:77], v[176:179], v[42:57]
    ds_read_b64_tr_b16 v[94:95], v7 offset:57344
    ds_read_b64_tr_b16 v[96:97], v7 offset:58368
    v_mul_f32 v103, v103, v39
    v_cvt_pk_bf16_f32 v112, v102, v103
    v_exp_f32 v104, -v32
    v_mfma_f32_32x32x16_bf16 v[58:73], v[78:81], v[176:179], v[58:73]
    ds_read_b64_tr_b16 v[74:75], v6 offset:61440
    ds_read_b64_tr_b16 v[76:77], v6 offset:62464
    v_exp_f32 v105, -v33
    v_fma_f32 v104, v104, s77, s77
    s_waitcnt lgkmcnt(6)
    v_mfma_f32_32x32x16_bf16 v[42:57], v[82:85], v[180:183], v[42:57]
    ds_read_b64_tr_b16 v[78:79], v7 offset:61440
    ds_read_b64_tr_b16 v[80:81], v7 offset:62464
    v_fma_f32 v105, v105, s77, s77
    v_rcp_f32 v104, v104
    v_mfma_f32_32x32x16_bf16 v[58:73], v[86:89], v[180:183], v[58:73]
    ds_read_b64_tr_b16 v[82:83], v8 offset:0
    ds_read_b64_tr_b16 v[84:85], v8 offset:1024
    v_rcp_f32 v105, v105
    v_mul_f32 v104, v104, v40
    s_waitcnt lgkmcnt(6)
    v_mfma_f32_32x32x16_bf16 v[42:57], v[90:93], v[184:187], v[42:57]
    ds_read_b64_tr_b16 v[86:87], v9 offset:0
    ds_read_b64_tr_b16 v[88:89], v9 offset:1024
    v_mul_f32 v105, v105, v41
    v_cvt_pk_bf16_f32 v113, v104, v105
    s_add_u32 s70, s78, 5120
    buffer_store_dwordx4 v[110:113], v0, s[32:35], s70 offen sc1
    v_mfma_f32_32x32x16_bf16 v[58:73], v[94:97], v[184:187], v[58:73]
    ds_read_b64_tr_b16 v[90:91], v8 offset:4096
    ds_read_b64_tr_b16 v[92:93], v8 offset:5120
    s_waitcnt lgkmcnt(6)
    v_mfma_f32_32x32x16_bf16 v[42:57], v[74:77], v[188:191], v[42:57]
    ds_read_b64_tr_b16 v[94:95], v9 offset:4096
    ds_read_b64_tr_b16 v[96:97], v9 offset:5120
    v_mfma_f32_32x32x16_bf16 v[58:73], v[78:81], v[188:191], v[58:73]
    ds_read_b64_tr_b16 v[74:75], v8 offset:8192
    ds_read_b64_tr_b16 v[76:77], v8 offset:9216
    s_waitcnt lgkmcnt(6)
    v_mfma_f32_32x32x16_bf16 v[42:57], v[82:85], v[192:195], v[42:57]
    ds_read_b64_tr_b16 v[78:79], v9 offset:8192
    ds_read_b64_tr_b16 v[80:81], v9 offset:9216
    v_mfma_f32_32x32x16_bf16 v[58:73], v[86:89], v[192:195], v[58:73]
    s_barrier
    ds_read_b64_tr_b16 v[82:83], v8 offset:12288
    ds_read_b64_tr_b16 v[84:85], v8 offset:13312
    s_waitcnt lgkmcnt(6)
    v_mfma_f32_32x32x16_bf16 v[42:57], v[90:93], v[196:199], v[42:57]
    ds_read_b64_tr_b16 v[86:87], v9 offset:12288
    ds_read_b64_tr_b16 v[88:89], v9 offset:13312
    v_mfma_f32_32x32x16_bf16 v[58:73], v[94:97], v[196:199], v[58:73]
    ds_read_b64_tr_b16 v[90:91], v8 offset:16384
    ds_read_b64_tr_b16 v[92:93], v8 offset:17408
    s_waitcnt lgkmcnt(6)
    v_mfma_f32_32x32x16_bf16 v[42:57], v[74:77], v[200:203], v[42:57]
    ds_read_b64_tr_b16 v[94:95], v9 offset:16384
    ds_read_b64_tr_b16 v[96:97], v9 offset:17408
    v_mfma_f32_32x32x16_bf16 v[58:73], v[78:81], v[200:203], v[58:73]
    ds_read_b64_tr_b16 v[74:75], v8 offset:20480
    ds_read_b64_tr_b16 v[76:77], v8 offset:21504
    s_mov_b64 exec, 0xfffffff
    buffer_load_dword v252, v253, s[32:35], 0 offen sc1
    s_mov_b64 exec, -1
    s_waitcnt lgkmcnt(6)
    v_mfma_f32_32x32x16_bf16 v[42:57], v[82:85], v[204:207], v[42:57]
    ds_read_b64_tr_b16 v[78:79], v9 offset:20480
    ds_read_b64_tr_b16 v[80:81], v9 offset:21504
    v_mfma_f32_32x32x16_bf16 v[58:73], v[86:89], v[204:207], v[58:73]
    ds_read_b64_tr_b16 v[82:83], v8 offset:24576
    ds_read_b64_tr_b16 v[84:85], v8 offset:25600
    s_waitcnt lgkmcnt(6)
    v_mfma_f32_32x32x16_bf16 v[42:57], v[90:93], v[208:211], v[42:57]
    ds_read_b64_tr_b16 v[86:87], v9 offset:24576
    ds_read_b64_tr_b16 v[88:89], v9 offset:25600
    v_mfma_f32_32x32x16_bf16 v[58:73], v[94:97], v[208:211], v[58:73]
    ds_read_b64_tr_b16 v[90:91], v4 offset:0
    ds_read_b64_tr_b16 v[92:93], v4 offset:1024
    s_waitcnt lgkmcnt(6)
    v_mfma_f32_32x32x16_bf16 v[42:57], v[74:77], v[212:215], v[42:57]
    ds_read_b64_tr_b16 v[94:95], v5 offset:0
    ds_read_b64_tr_b16 v[96:97], v5 offset:1024
    v_mfma_f32_32x32x16_bf16 v[58:73], v[78:81], v[212:215], v[58:73]
    ds_read_b64_tr_b16 v[74:75], v4 offset:4096
    ds_read_b64_tr_b16 v[76:77], v4 offset:5120
    s_waitcnt lgkmcnt(6)
    v_mfma_f32_32x32x16_bf16 v[42:57], v[82:85], v[216:219], v[42:57]
    ds_read_b64_tr_b16 v[78:79], v5 offset:4096
    ds_read_b64_tr_b16 v[80:81], v5 offset:5120
    v_mfma_f32_32x32x16_bf16 v[58:73], v[86:89], v[216:219], v[58:73]
    ds_read_b64_tr_b16 v[82:83], v4 offset:8192
    ds_read_b64_tr_b16 v[84:85], v4 offset:9216
    s_waitcnt lgkmcnt(6)
    v_mfma_f32_32x32x16_bf16 v[42:57], v[90:93], v[220:223], v[42:57]
    ds_read_b64_tr_b16 v[86:87], v5 offset:8192
    ds_read_b64_tr_b16 v[88:89], v5 offset:9216
    v_mfma_f32_32x32x16_bf16 v[58:73], v[94:97], v[220:223], v[58:73]
    ds_read_b64_tr_b16 v[90:91], v4 offset:12288
    ds_read_b64_tr_b16 v[92:93], v4 offset:13312
    s_waitcnt lgkmcnt(6)
    v_mfma_f32_32x32x16_bf16 v[42:57], v[74:77], v[224:227], v[42:57]
    ds_read_b64_tr_b16 v[94:95], v5 offset:12288
    ds_read_b64_tr_b16 v[96:97], v5 offset:13312
    v_mfma_f32_32x32x16_bf16 v[58:73], v[78:81], v[224:227], v[58:73]
    s_barrier
    ds_read_b64_tr_b16 v[74:75], v4 offset:16384
    ds_read_b64_tr_b16 v[76:77], v4 offset:17408
    s_waitcnt lgkmcnt(6)
    v_mfma_f32_32x32x16_bf16 v[42:57], v[82:85], v[228:231], v[42:57]
    ds_read_b64_tr_b16 v[78:79], v5 offset:16384
    ds_read_b64_tr_b16 v[80:81], v5 offset:17408
    v_mfma_f32_32x32x16_bf16 v[58:73], v[86:89], v[228:231], v[58:73]
    ds_read_b64_tr_b16 v[82:83], v4 offset:20480
    ds_read_b64_tr_b16 v[84:85], v4 offset:21504
    s_waitcnt lgkmcnt(6)
    v_mfma_f32_32x32x16_bf16 v[42:57], v[90:93], v[232:235], v[42:57]
    ds_read_b64_tr_b16 v[86:87], v5 offset:20480
    ds_read_b64_tr_b16 v[88:89], v5 offset:21504
    v_mfma_f32_32x32x16_bf16 v[58:73], v[94:97], v[232:235], v[58:73]
    s_waitcnt lgkmcnt(4)
    v_mfma_f32_32x32x16_bf16 v[42:57], v[74:77], v[236:239], v[42:57]
    v_mfma_f32_32x32x16_bf16 v[58:73], v[78:81], v[236:239], v[58:73]
    s_waitcnt lgkmcnt(0)
    v_mfma_f32_32x32x16_bf16 v[42:57], v[82:85], v[240:243], v[42:57]
    v_mfma_f32_32x32x16_bf16 v[58:73], v[86:89], v[240:243], v[58:73]
    v_mov_b32 v164, v115
    v_mov_b32 v165, v254
    v_add_u32 v166, 0x10000, v115
    v_add_u32 v167, 0x10000, v254
    v_add_u32 v168, 0x20000, v115
    v_add_u32 v169, 0x20000, v254

    s_waitcnt vmcnt(0)
    s_mov_b64 exec, 0xfffffff
    v_cmp_ne_u32 vcc, s49, v252
    s_cbranch_vccz L_f3_Ga_ok
    s_mov_b64 exec, -1
    s_mov_b32 s72, 0
    s_mov_b64 exec, 0xfffffff
L_f3_Ga:
    buffer_load_dword v252, v253, s[32:35], 0 offen sc1
    s_add_u32 s72, s72, 1
    s_waitcnt vmcnt(0)
    v_cmp_ne_u32 vcc, s49, v252
    s_cmp_gt_u32 s72, 0x100000
    s_cbranch_scc1 L_f3_Ga_out
    s_cbranch_vccnz L_f3_Ga
L_f3_Ga_out:
    s_mov_b64 exec, -1
L_f3_Ga_ok:
    s_mov_b64 exec, -1
    s_nop 3
    v_exp_f32 v98, -v42
    v_exp_f32 v99, -v43
    v_fma_f32 v98, v98, s77, s77
    v_fma_f32 v99, v99, s77, s77
    v_rcp_f32 v98, v98
    v_rcp_f32 v99, v99
    s_add_u32 s76, s75, 0
    buffer_load_dwordx4 v[116:119], v0, s[32:35], s76 offen sc1
    v_mul_f32 v98, v98, v50
    v_mul_f32 v99, v99, v51
    v_cvt_pk_bf16_f32 v106, v98, v99
    v_exp_f32 v100, -v44
    v_exp_f32 v101, -v45
    v_fma_f32 v100, v100, s77, s77
    s_add_u32 s76, s75, 8192
    buffer_load_dwordx4 v[120:123], v0, s[32:35], s76 offen sc1
    v_fma_f32 v101, v101, s77, s77
    v_rcp_f32 v100, v100
    v_rcp_f32 v101, v101
    v_mul_f32 v100, v100, v52
    v_mul_f32 v101, v101, v53
    v_cvt_pk_bf16_f32 v107, v100, v101
    s_add_u32 s76, s75, 16384
    buffer_load_dwordx4 v[124:127], v0, s[32:35], s76 offen sc1
    v_exp_f32 v102, -v46
    v_exp_f32 v103, -v47
    v_fma_f32 v102, v102, s77, s77
    v_fma_f32 v103, v103, s77, s77
    v_rcp_f32 v102, v102
    v_rcp_f32 v103, v103
    s_add_u32 s76, s75, 24576
    buffer_load_dwordx4 v[128:131], v0, s[32:35], s76 offen sc1
    v_mul_f32 v102, v102, v54
    v_mul_f32 v103, v103, v55
    v_cvt_pk_bf16_f32 v108, v102, v103
    v_exp_f32 v104, -v48
    v_exp_f32 v105, -v49
    v_fma_f32 v104, v104, s77, s77
    s_add_u32 s76, s75, 32768
    buffer_load_dwordx4 v[132:135], v0, s[32:35], s76 offen sc1
    v_fma_f32 v105, v105, s77, s77
    v_rcp_f32 v104, v104
    v_rcp_f32 v105, v105
    v_mul_f32 v104, v104, v56
    v_mul_f32 v105, v105, v57
    v_cvt_pk_bf16_f32 v109, v104, v105
    s_add_u32 s76, s75, 40960
    buffer_load_dwordx4 v[136:139], v0, s[32:35], s76 offen sc1
    s_add_u32 s70, s78, 6144
    buffer_store_dwordx4 v[106:109], v0, s[32:35], s70 offen sc1
    v_exp_f32 v98, -v58
    v_exp_f32 v99, -v59
    v_fma_f32 v98, v98, s77, s77
    v_fma_f32 v99, v99, s77, s77
    v_rcp_f32 v98, v98
    v_rcp_f32 v99, v99
    v_mul_f32 v98, v98, v66
    v_mul_f32 v99, v99, v67
    v_cvt_pk_bf16_f32 v110, v98, v99
    v_exp_f32 v100, -v60
    v_exp_f32 v101, -v61
    v_fma_f32 v100, v100, s77, s77
    v_fma_f32 v101, v101, s77, s77
    v_rcp_f32 v100, v100
    v_rcp_f32 v101, v101
    v_mul_f32 v100, v100, v68
    v_mul_f32 v101, v101, v69
    v_cvt_pk_bf16_f32 v111, v100, v101
    v_exp_f32 v102, -v62
    v_exp_f32 v103, -v63
    v_fma_f32 v102, v102, s77, s77
    v_fma_f32 v103, v103, s77, s77
    v_rcp_f32 v102, v102
    v_rcp_f32 v103, v103
    v_mul_f32 v102, v102, v70
    v_mul_f32 v103, v103, v71
    v_cvt_pk_bf16_f32 v112, v102, v103
    v_exp_f32 v104, -v64
    v_exp_f32 v105, -v65
    v_fma_f32 v104, v104, s77, s77
    v_fma_f32 v105, v105, s77, s77
    v_rcp_f32 v104, v104
    v_rcp_f32 v105, v105
    v_mul_f32 v104, v104, v72
    v_mul_f32 v105, v105, v73
    v_cvt_pk_bf16_f32 v113, v104, v105
    s_add_u32 s71, s73, 1024
    s_mov_b64 exec, 1
    buffer_store_dword v114, v0, s[32:35], s71 offen sc1
    s_mov_b64 exec, -1
    s_add_u32 s70, s78, 7168
    buffer_store_dwordx4 v[110:113], v0, s[32:35], s70 offen sc1
    s_add_u32 s76, s75, 49152
    buffer_load_dwordx4 v[140:143], v0, s[32:35], s76 offen sc1
    s_add_u32 s76, s75, 57344
    buffer_load_dwordx4 v[144:147], v0, s[32:35], s76 offen sc1
    s_add_u32 s76, s75, 65536
    buffer_load_dwordx4 v[148:151], v0, s[32:35], s76 offen sc1
    s_add_u32 s76, s75, 73728
    buffer_load_dwordx4 v[152:155], v0, s[32:35], s76 offen sc1
    s_add_u32 s76, s75, 81920
    buffer_load_dwordx4 v[156:159], v0, s[32:35], s76 offen sc1
    s_branch L_c_p4_G
L_c_idle_G:
    s_barrier
    v_mov_b32 v164, v115
    v_mov_b32 v165, v254
    v_add_u32 v166, 0x10000, v115
    v_add_u32 v167, 0x10000, v254
    v_add_u32 v168, 0x20000, v115
    v_add_u32 v169, 0x20000, v254

    s_mov_b32 s72, 0
    s_mov_b64 exec, 0xfffffff
L_f3_Gi:
    buffer_load_dword v252, v253, s[32:35], 0 offen sc1
    s_add_u32 s72, s72, 1
    s_waitcnt vmcnt(0)
    v_cmp_ne_u32 vcc, s49, v252
    s_cmp_gt_u32 s72, 0x100000
    s_cbranch_scc1 L_f3_Gi_out
    s_cbranch_vccnz L_f3_Gi
L_f3_Gi_out:
    s_mov_b64 exec, -1
    s_add_u32 s76, s75, 0
    buffer_load_dwordx4 v[116:119], v0, s[32:35], s76 offen sc1
    s_add_u32 s76, s75, 8192
    buffer_load_dwordx4 v[120:123], v0, s[32:35], s76 offen sc1
    s_add_u32 s76, s75, 16384
    buffer_load_dwordx4 v[124:127], v0, s[32:35], s76 offen sc1
    s_add_u32 s76, s75, 24576
    buffer_load_dwordx4 v[128:131], v0, s[32:35], s76 offen sc1
    s_add_u32 s76, s75, 32768
    buffer_load_dwordx4 v[132:135], v0, s[32:35], s76 offen sc1
    s_add_u32 s76, s75, 40960
    buffer_load_dwordx4 v[136:139], v0, s[32:35], s76 offen sc1
    buffer_load_dword v252, v253, s[32:35], 0 offen sc1
    s_add_u32 s76, s75, 49152
    buffer_load_dwordx4 v[140:143], v0, s[32:35], s76 offen sc1
    s_add_u32 s76, s75, 57344
    buffer_load_dwordx4 v[144:147], v0, s[32:35], s76 offen sc1
    s_add_u32 s76, s75, 65536
    buffer_load_dwordx4 v[148:151], v0, s[32:35], s76 offen sc1
    s_add_u32 s76, s75, 73728
    buffer_load_dwordx4 v[152:155], v0, s[32:35], s76 offen sc1
    s_add_u32 s76, s75, 81920
    buffer_load_dwordx4 v[156:159], v0, s[32:35], s76 offen sc1
L_c_p4_G:
    s_barrier
    ds_read_b64_tr_b16 v[74:75], v164 offset:24576
    ds_read_b64_tr_b16 v[76:77], v164 offset:25600
    ds_read_b64_tr_b16 v[78:79], v165 offset:24576
    ds_read_b64_tr_b16 v[80:81], v165 offset:25600
    ds_read_b64_tr_b16 v[82:83], v164 offset:28672
    ds_read_b64_tr_b16 v[84:85], v164 offset:29696
    ds_read_b64_tr_b16 v[86:87], v165 offset:28672
    ds_read_b64_tr_b16 v[88:89], v165 offset:29696
    s_add_u32 s76, s75, 90112
    buffer_load_dwordx4 v[160:163], v0, s[32:35], s76 offen sc1
    s_waitcnt vmcnt(12)
    s_waitcnt lgkmcnt(4)
    v_mfma_f32_32x32x16_bf16 v[4:19], v[74:77], v[116:119], 0
    v_mfma_f32_32x32x16_bf16 v[20:35], v[78:81], v[116:119], 0
    ds_read_b64_tr_b16 v[90:91], v164 offset:32768
    ds_read_b64_tr_b16 v[92:93], v164 offset:33792
    ds_read_b64_tr_b16 v[94:95], v165 offset:32768
    ds_read_b64_tr_b16 v[96:97], v165 offset:33792
    s_add_u32 s76, s75, 98304
    buffer_load_dwordx4 v[116:119], v0, s[32:35], s76 offen sc1
    s_waitcnt vmcnt(12)
    s_waitcnt lgkmcnt(4)
    v_mfma_f32_32x32x16_bf16 v[4:19], v[82:85], v[120:123], v[4:19]
    v_mfma_f32_32x32x16_bf16 v[20:35], v[86:89], v[120:123], v[20:35]
    ds_read_b64_tr_b16 v[74:75], v164 offset:36864
    ds_read_b64_tr_b16 v[76:77], v164 offset:37888
    ds_read_b64_tr_b16 v[78:79], v165 offset:36864
    ds_read_b64_tr_b16 v[80:81], v165 offset:37888
    s_add_u32 s76, s75, 106496
    buffer_load_dwordx4 v[120:123], v0, s[32:35], s76 offen sc1
    s_waitcnt vmcnt(12)
    s_waitcnt lgkmcnt(4)
    v_mfma_f32_32x32x16_bf16 v[4:19], v[90:93], v[124:127], v[4:19]
    v_mfma_f32_32x32x16_bf16 v[20:35], v[94:97], v[124:127], v[20:35]
    ds_read_b64_tr_b16 v[82:83], v164 offset:40960
    ds_read_b64_tr_b16 v[84:85], v164 offset:41984
    ds_read_b64_tr_b16 v[86:87], v165 offset:40960
    ds_read_b64_tr_b16 v[88:89], v165 offset:41984
    s_add_u32 s76, s75, 2048
    buffer_load_dwordx4 v[124:127], v0, s[32:35], s76 offen sc1
    s_waitcnt vmcnt(12)
    s_waitcnt lgkmcnt(4)
    v_mfma_f32_32x32x16_bf16 v[4:19], v[74:77], v[128:131], v[4:19]
    v_mfma_f32_32x32x16_bf16 v[20:35], v[78:81], v[128:131], v[20:35]
    ds_read_b64_tr_b16 v[90:91], v164 offset:45056
    ds_read_b64_tr_b16 v[92:93], v164 offset:46080
    ds_read_b64_tr_b16 v[94:95], v165 offset:45056
    ds_read_b64_tr_b16 v[96:97], v165 offset:46080
    s_add_u32 s76, s75, 10240
    buffer_load_dwordx4 v[128:131], v0, s[32:35], s76 offen sc1
    s_waitcnt vmcnt(12)
    s_waitcnt lgkmcnt(4)
    v_mfma_f32_32x32x16_bf16 v[4:19], v[82:85], v[132:135], v[4:19]
    v_mfma_f32_32x32x16_bf16 v[20:35], v[86:89], v[132:135], v[20:35]
    ds_read_b64_tr_b16 v[74:75], v164 offset:49152
    ds_read_b64_tr_b16 v[76:77], v164 offset:50176
    ds_read_b64_tr_b16 v[78:79], v165 offset:49152
    ds_read_b64_tr_b16 v[80:81], v165 offset:50176
    s_add_u32 s76, s75, 18432
    buffer_load_dwordx4 v[132:135], v0, s[32:35], s76 offen sc1
    s_waitcnt vmcnt(12)
    s_waitcnt lgkmcnt(4)
    v_mfma_f32_32x32x16_bf16 v[4:19], v[90:93], v[136:139], v[4:19]
    v_mfma_f32_32x32x16_bf16 v[20:35], v[94:97], v[136:139], v[20:35]
    v_lshlrev_b32 v99, 4, v1
    v_add_u32 v253, s74, v99
    s_mov_b64 exec, 0x3fff
    buffer_load_dword v252, v253, s[32:35], 0 offen offset:1024 sc1
    s_mov_b64 exec, -1
    ds_read_b64_tr_b16 v[82:83], v164 offset:53248
    ds_read_b64_tr_b16 v[84:85], v164 offset:54272
    ds_read_b64_tr_b16 v[86:87], v165 offset:53248
    ds_read_b64_tr_b16 v[88:89], v165 offset:54272
    s_add_u32 s76, s75, 26624
    buffer_load_dwordx4 v[136:139], v0, s[32:35], s76 offen sc1
    s_waitcnt vmcnt(12)
    s_add_u32 s71, s73, 1536
    v_mov_b32 v114, s49
    s_mov_b64 exec, 1
    buffer_store_dword v114, v0, s[32:35], s71 offen sc1
    s_mov_b64 exec, -1
    s_waitcnt lgkmcnt(4)
    v_mfma_f32_32x32x16_bf16 v[4:19], v[74:77], v[140:143], v[4:19]
    v_mfma_f32_32x32x16_bf16 v[20:35], v[78:81], v[140:143], v[20:35]
    ds_read_b64_tr_b16 v[90:91], v164 offset:57344
    ds_read_b64_tr_b16 v[92:93], v164 offset:58368
    ds_read_b64_tr_b16 v[94:95], v165 offset:57344
    ds_read_b64_tr_b16 v[96:97], v165 offset:58368
    s_add_u32 s76, s75, 34816
    buffer_load_dwordx4 v[140:143], v0, s[32:35], s76 offen sc1
    s_waitcnt vmcnt(13)
    s_waitcnt lgkmcnt(4)
    v_mfma_f32_32x32x16_bf16 v[4:19], v[82:85], v[144:147], v[4:19]
    v_mfma_f32_32x32x16_bf16 v[20:35], v[86:89], v[144:147], v[20:35]
    s_waitcnt lgkmcnt(0)
    s_barrier
    ds_read_b64_tr_b16 v[74:75], v164 offset:61440
    ds_read_b64_tr_b16 v[76:77], v164 offset:62464
    ds_read_b64_tr_b16 v[78:79], v165 offset:61440
    ds_read_b64_tr_b16 v[80:81], v165 offset:62464
    s_add_u32 s76, s75, 43008
    buffer_load_dwordx4 v[144:147], v0, s[32:35], s76 offen sc1
    s_waitcnt vmcnt(13)
    s_waitcnt lgkmcnt(4)
    v_mfma_f32_32x32x16_bf16 v[4:19], v[90:93], v[148:151], v[4:19]
    v_mfma_f32_32x32x16_bf16 v[20:35], v[94:97], v[148:151], v[20:35]
    ds_read_b64_tr_b16 v[82:83], v166 offset:0
    ds_read_b64_tr_b16 v[84:85], v166 offset:1024
    ds_read_b64_tr_b16 v[86:87], v167 offset:0
    ds_read_b64_tr_b16 v[88:89], v167 offset:1024
    s_add_u32 s76, s75, 51200
    buffer_load_dwordx4 v[148:151], v0, s[32:35], s76 offen sc1
    s_waitcnt vmcnt(13)
    s_waitcnt lgkmcnt(4)
    v_mfma_f32_32x32x16_bf16 v[4:19], v[74:77], v[152:155], v[4:19]
    v_mfma_f32_32x32x16_bf16 v[20:35], v[78:81], v[152:155], v[20:35]
    ds_read_b64_tr_b16 v[90:91], v166 offset:4096
    ds_read_b64_tr_b16 v[92:93], v166 offset:5120
    ds_read_b64_tr_b16 v[94:95], v167 offset:4096
    ds_read_b64_tr_b16 v[96:97], v167 offset:5120
    s_add_u32 s76, s75, 59392
    buffer_load_dwordx4 v[152:155], v0, s[32:35], s76 offen sc1
    s_waitcnt vmcnt(13)
    s_waitcnt lgkmcnt(4)
    v_mfma_f32_32x32x16_bf16 v[4:19], v[82:85], v[156:159], v[4:19]
    v_mfma_f32_32x32x16_bf16 v[20:35], v[86:89], v[156:159], v[20:35]
    ds_read_b64_tr_b16 v[74:75], v166 offset:8192
    ds_read_b64_tr_b16 v[76:77], v166 offset:9216
    ds_read_b64_tr_b16 v[78:79], v167 offset:8192
    ds_read_b64_tr_b16 v[80:81], v167 offset:9216
    s_add_u32 s76, s75, 67584
    buffer_load_dwordx4 v[156:159], v0, s[32:35], s76 offen sc1
    s_waitcnt vmcnt(13)
    s_waitcnt lgkmcnt(4)
    v_mfma_f32_32x32x16_bf16 v[4:19], v[90:93], v[160:163], v[4:19]
    v_mfma_f32_32x32x16_bf16 v[20:35], v[94:97], v[160:163], v[20:35]
    ds_read_b64_tr_b16 v[82:83], v166 offset:12288
    ds_read_b64_tr_b16 v[84:85], v166 offset:13312
    ds_read_b64_tr_b16 v[86:87], v167 offset:12288
    ds_read_b64_tr_b16 v[88:89], v167 offset:13312
    s_add_u32 s76, s75, 75776
    buffer_load_dwordx4 v[160:163], v0, s[32:35], s76 offen sc1
    s_waitcnt vmcnt(13)
    s_waitcnt lgkmcnt(4)
    v_mfma_f32_32x32x16_bf16 v[4:19], v[74:77], v[116:119], v[4:19]
    v_mfma_f32_32x32x16_bf16 v[20:35], v[78:81], v[116:119], v[20:35]
    ds_read_b64_tr_b16 v[90:91], v166 offset:16384
    ds_read_b64_tr_b16 v[92:93], v166 offset:17408
    ds_read_b64_tr_b16 v[94:95], v167 offset:16384
    ds_read_b64_tr_b16 v[96:97], v167 offset:17408
    s_add_u32 s76, s75, 83968
    buffer_load_dwordx4 v[116:119], v0, s[32:35], s76 offen sc1
    s_waitcnt vmcnt(13)
    s_waitcnt lgkmcnt(4)
    v_mfma_f32_32x32x16_bf16 v[4:19], v[82:85], v[120:123], v[4:19]
    v_mfma_f32_32x32x16_bf16 v[20:35], v[86:89], v[120:123], v[20:35]
    ds_read_b64_tr_b16 v[74:75], v166 offset:20480
    ds_read_b64_tr_b16 v[76:77], v166 offset:21504
    ds_read_b64_tr_b16 v[78:79], v167 offset:20480
    ds_read_b64_tr_b16 v[80:81], v167 offset:21504
    s_add_u32 s76, s75, 92160
    buffer_load_dwordx4 v[120:123], v0, s[32:35], s76 offen sc1
    s_waitcnt vmcnt(13)
    s_waitcnt lgkmcnt(4)
    v_mfma_f32_32x32x16_bf16 v[4:19], v[90:93], v[124:127], v[4:19]
    v_mfma_f32_32x32x16_bf16 v[20:35], v[94:97], v[124:127], v[20:35]
    ds_read_b64_tr_b16 v[82:83], v166 offset:24576
    ds_read_b64_tr_b16 v[84:85], v166 offset:25600
    ds_read_b64_tr_b16 v[86:87], v167 offset:24576
    ds_read_b64_tr_b16 v[88:89], v167 offset:25600
    s_add_u32 s76, s75, 100352
    buffer_load_dwordx4 v[124:127], v0, s[32:35], s76 offen sc1
    s_waitcnt vmcnt(13)
    s_waitcnt lgkmcnt(4)
    v_mfma_f32_32x32x16_bf16 v[4:19], v[74:77], v[128:131], v[4:19]
    v_mfma_f32_32x32x16_bf16 v[20:35], v[78:81], v[128:131], v[20:35]
    s_waitcnt lgkmcnt(0)
    s_barrier
    s_waitcnt vmcnt(11)
    s_mov_b64 exec, 0x3fff
    v_cmp_ne_u32 vcc, s49, v252
    s_cbranch_vccz L_f3b2_G_ok
    v_add_u32 v253, 1024, v253
    s_mov_b64 exec, -1
    s_mov_b32 s72, 0
    s_mov_b64 exec, 0x3fff
L_f3b2_G:
    buffer_load_dword v252, v253, s[32:35], 0 offen sc1
    s_add_u32 s72, s72, 1
    s_waitcnt vmcnt(0)
    v_cmp_ne_u32 vcc, s49, v252
    s_cmp_gt_u32 s72, 0x100000
    s_cbranch_scc1 L_f3b2_G_out
    s_cbranch_vccnz L_f3b2_G
L_f3b2_G_out:
    s_mov_b64 exec, -1
L_f3b2_G_ok:
    s_mov_b64 exec, -1
    ds_read_b64_tr_b16 v[90:91], v166 offset:28672
    ds_read_b64_tr_b16 v[92:93], v166 offset:29696
    ds_read_b64_tr_b16 v[94:95], v167 offset:28672
    ds_read_b64_tr_b16 v[96:97], v167 offset:29696
    s_add_u32 s76, s75, 108544
    buffer_load_dwordx4 v[128:131], v0, s[32:35], s76 offen sc1
    s_waitcnt lgkmcnt(4)
    v_mfma_f32_32x32x16_bf16 v[4:19], v[82:85], v[132:135], v[4:19]
    v_mfma_f32_32x32x16_bf16 v[20:35], v[86:89], v[132:135], v[20:35]
    ds_read_b64_tr_b16 v[74:75], v166 offset:32768
    ds_read_b64_tr_b16 v[76:77], v166 offset:33792
    ds_read_b64_tr_b16 v[78:79], v167 offset:32768
    ds_read_b64_tr_b16 v[80:81], v167 offset:33792
    s_add_u32 s76, s75, 4096
    buffer_load_dwordx4 v[132:135], v0, s[32:35], s76 offen sc1
    s_waitcnt vmcnt(12)
    s_waitcnt lgkmcnt(4)
    v_mfma_f32_32x32x16_bf16 v[4:19], v[90:93], v[136:139], v[4:19]
    v_mfma_f32_32x32x16_bf16 v[20:35], v[94:97], v[136:139], v[20:35]
    ds_read_b64_tr_b16 v[82:83], v166 offset:36864
    ds_read_b64_tr_b16 v[84:85], v166 offset:37888
    ds_read_b64_tr_b16 v[86:87], v167 offset:36864
    ds_read_b64_tr_b16 v[88:89], v167 offset:37888
    s_add_u32 s76, s75, 12288
    buffer_load_dwordx4 v[136:139], v0, s[32:35], s76 offen sc1
    s_waitcnt vmcnt(11)
    s_waitcnt lgkmcnt(4)
    v_mfma_f32_32x32x16_bf16 v[4:19], v[74:77], v[140:143], v[4:19]
    v_mfma_f32_32x32x16_bf16 v[20:35], v[78:81], v[140:143], v[20:35]
    ds_read_b64_tr_b16 v[90:91], v166 offset:40960
    ds_read_b64_tr_b16 v[92:93], v166 offset:41984
    ds_read_b64_tr_b16 v[94:95], v167 offset:40960
    ds_read_b64_tr_b16 v[96:97], v167 offset:41984
    s_add_u32 s76, s75, 20480
    buffer_load_dwordx4 v[140:143], v0, s[32:35], s76 offen sc1
    s_waitcnt vmcnt(11)
    s_waitcnt lgkmcnt(4)
    v_mfma_f32_32x32x16_bf16 v[4:19], v[82:85], v[144:147], v[4:19]
    v_mfma_f32_32x32x16_bf16 v[20:35], v[86:89], v[144:147], v[20:35]
    v_lshlrev_b32 v99, 4, v1
    v_add_u32 v253, s74, v99
    s_mov_b64 exec, 0x3fff
    buffer_load_dword v252, v253, s[32:35], 0 offen offset:1536 sc1
    s_mov_b64 exec, -1
    ds_read_b64_tr_b16 v[74:75], v166 offset:45056
    ds_read_b64_tr_b16 v[76:77], v166 offset:46080
    ds_read_b64_tr_b16 v[78:79], v167 offset:45056
    ds_read_b64_tr_b16 v[80:81], v167 offset:46080
    s_add_u32 s76, s75, 28672
    buffer_load_dwordx4 v[144:147], v0, s[32:35], s76 offen sc1
    s_waitcnt vmcnt(12)
    s_waitcnt lgkmcnt(4)
    v_mfma_f32_32x32x16_bf16 v[4:19], v[90:93], v[148:151], v[4:19]
    v_mfma_f32_32x32x16_bf16 v[20:35], v[94:97], v[148:151], v[20:35]
    ds_read_b64_tr_b16 v[82:83], v166 offset:49152
    ds_read_b64_tr_b16 v[84:85], v166 offset:50176
    ds_read_b64_tr_b16 v[86:87], v167 offset:49152
    ds_read_b64_tr_b16 v[88:89], v167 offset:50176
    s_add_u32 s76, s75, 36864
    buffer_load_dwordx4 v[148:151], v0, s[32:35], s76 offen sc1
    s_waitcnt vmcnt(12)
    s_waitcnt lgkmcnt(4)
    v_mfma_f32_32x32x16_bf16 v[4:19], v[74:77], v[152:155], v[4:19]
    v_mfma_f32_32x32x16_bf16 v[20:35], v[78:81], v[152:155], v[20:35]
    ds_read_b64_tr_b16 v[90:91], v166 offset:53248
    ds_read_b64_tr_b16 v[92:93], v166 offset:54272
    ds_read_b64_tr_b16 v[94:95], v167 offset:53248
    ds_read_b64_tr_b16 v[96:97], v167 offset:54272
    s_add_u32 s76, s75, 45056
    buffer_load_dwordx4 v[152:155], v0, s[32:35], s76 offen sc1
    s_waitcnt vmcnt(12)
    s_waitcnt lgkmcnt(4)
    v_mfma_f32_32x32x16_bf16 v[4:19], v[82:85], v[156:159], v[4:19]
    v_mfma_f32_32x32x16_bf16 v[20:35], v[86:89], v[156:159], v[20:35]
    ds_read_b64_tr_b16 v[74:75], v166 offset:57344
    ds_read_b64_tr_b16 v[76:77], v166 offset:58368
    ds_read_b64_tr_b16 v[78:79], v167 offset:57344
    ds_read_b64_tr_b16 v[80:81], v167 offset:58368
    s_add_u32 s76, s75, 53248
    buffer_load_dwordx4 v[156:159], v0, s[32:35], s76 offen sc1
    s_waitcnt vmcnt(12)
    s_waitcnt lgkmcnt(4)
    v_mfma_f32_32x32x16_bf16 v[4:19], v[90:93], v[160:163], v[4:19]
    v_mfma_f32_32x32x16_bf16 v[20:35], v[94:97], v[160:163], v[20:35]
    s_waitcnt lgkmcnt(0)
    s_barrier
    ds_read_b64_tr_b16 v[82:83], v166 offset:61440
    ds_read_b64_tr_b16 v[84:85], v166 offset:62464
    ds_read_b64_tr_b16 v[86:87], v167 offset:61440
    ds_read_b64_tr_b16 v[88:89], v167 offset:62464
    s_add_u32 s76, s75, 61440
    buffer_load_dwordx4 v[160:163], v0, s[32:35], s76 offen sc1
    s_waitcnt vmcnt(12)
    s_waitcnt lgkmcnt(4)
    v_mfma_f32_32x32x16_bf16 v[4:19], v[74:77], v[116:119], v[4:19]
    v_mfma_f32_32x32x16_bf16 v[20:35], v[78:81], v[116:119], v[20:35]
    ds_read_b64_tr_b16 v[90:91], v168 offset:0
    ds_read_b64_tr_b16 v[92:93], v168 offset:1024
    ds_read_b64_tr_b16 v[94:95], v169 offset:0
    ds_read_b64_tr_b16 v[96:97], v169 offset:1024
    s_add_u32 s76, s75, 69632
    buffer_load_dwordx4 v[116:119], v0, s[32:35], s76 offen sc1
    s_waitcnt vmcnt(12)
    s_waitcnt lgkmcnt(4)
    v_mfma_f32_32x32x16_bf16 v[4:19], v[82:85], v[120:123], v[4:19]
    v_mfma_f32_32x32x16_bf16 v[20:35], v[86:89], v[120:123], v[20:35]
    ds_read_b64_tr_b16 v[74:75], v168 offset:4096
    ds_read_b64_tr_b16 v[76:77], v168 offset:5120
    ds_read_b64_tr_b16 v[78:79], v169 offset:4096
    ds_read_b64_tr_b16 v[80:81], v169 offset:5120
    s_add_u32 s76, s75, 77824
    buffer_load_dwordx4 v[120:123], v0, s[32:35], s76 offen sc1
    s_waitcnt vmcnt(12)
    s_waitcnt lgkmcnt(4)
    v_mfma_f32_32x32x16_bf16 v[4:19], v[90:93], v[124:127], v[4:19]
    v_mfma_f32_32x32x16_bf16 v[20:35], v[94:97], v[124:127], v[20:35]
    ds_read_b64_tr_b16 v[82:83], v168 offset:8192
    ds_read_b64_tr_b16 v[84:85], v168 offset:9216
    ds_read_b64_tr_b16 v[86:87], v169 offset:8192
    ds_read_b64_tr_b16 v[88:89], v169 offset:9216
    s_add_u32 s76, s75, 86016
    buffer_load_dwordx4 v[124:127], v0, s[32:35], s76 offen sc1
    s_waitcnt vmcnt(12)
    s_waitcnt lgkmcnt(4)
    v_mfma_f32_32x32x16_bf16 v[4:19], v[74:77], v[128:131], v[4:19]
    v_mfma_f32_32x32x16_bf16 v[20:35], v[78:81], v[128:131], v[20:35]
    ds_read_b64_tr_b16 v[90:91], v168 offset:12288
    ds_read_b64_tr_b16 v[92:93], v168 offset:13312
    ds_read_b64_tr_b16 v[94:95], v169 offset:12288
    ds_read_b64_tr_b16 v[96:97], v169 offset:13312
    s_add_u32 s76, s75, 94208
    buffer_load_dwordx4 v[128:131], v0, s[32:35], s76 offen sc1
    s_waitcnt vmcnt(12)
    s_waitcnt lgkmcnt(4)
    v_mfma_f32_32x32x16_bf16 v[4:19], v[82:85], v[132:135], v[4:19]
    v_mfma_f32_32x32x16_bf16 v[20:35], v[86:89], v[132:135], v[20:35]
    ds_read_b64_tr_b16 v[74:75], v168 offset:16384
    ds_read_b64_tr_b16 v[76:77], v168 offset:17408
    ds_read_b64_tr_b16 v[78:79], v169 offset:16384
    ds_read_b64_tr_b16 v[80:81], v169 offset:17408
    s_add_u32 s76, s75, 102400
    buffer_load_dwordx4 v[132:135], v0, s[32:35], s76 offen sc1
    s_waitcnt vmcnt(12)
    s_waitcnt lgkmcnt(4)
    v_mfma_f32_32x32x16_bf16 v[4:19], v[90:93], v[136:139], v[4:19]
    v_mfma_f32_32x32x16_bf16 v[20:35], v[94:97], v[136:139], v[20:35]
    s_waitcnt vmcnt(10)
    s_mov_b64 exec, 0x3fff
    v_cmp_ne_u32 vcc, s49, v252
    s_cbranch_vccz L_f3b3_G_ok
    v_add_u32 v253, 1536, v253
    s_mov_b64 exec, -1
    s_mov_b32 s72, 0
    s_mov_b64 exec, 0x3fff
L_f3b3_G:
    buffer_load_dword v252, v253, s[32:35], 0 offen sc1
    s_add_u32 s72, s72, 1
    s_waitcnt vmcnt(0)
    v_cmp_ne_u32 vcc, s49, v252
    s_cmp_gt_u32 s72, 0x100000
    s_cbranch_scc1 L_f3b3_G_out
    s_cbranch_vccnz L_f3b3_G
L_f3b3_G_out:
    s_mov_b64 exec, -1
L_f3b3_G_ok:
    s_mov_b64 exec, -1
    ds_read_b64_tr_b16 v[82:83], v168 offset:20480
    ds_read_b64_tr_b16 v[84:85], v168 offset:21504
    ds_read_b64_tr_b16 v[86:87], v169 offset:20480
    ds_read_b64_tr_b16 v[88:89], v169 offset:21504
    s_add_u32 s76, s75, 110592
    buffer_load_dwordx4 v[136:139], v0, s[32:35], s76 offen sc1
    s_waitcnt lgkmcnt(4)
    v_mfma_f32_32x32x16_bf16 v[4:19], v[74:77], v[140:143], v[4:19]
    v_mfma_f32_32x32x16_bf16 v[20:35], v[78:81], v[140:143], v[20:35]
    ds_read_b64_tr_b16 v[90:91], v168 offset:24576
    ds_read_b64_tr_b16 v[92:93], v168 offset:25600
    ds_read_b64_tr_b16 v[94:95], v169 offset:24576
    ds_read_b64_tr_b16 v[96:97], v169 offset:25600
    s_add_u32 s76, s75, 6144
    buffer_load_dwordx4 v[140:143], v0, s[32:35], s76 offen sc1
    s_waitcnt vmcnt(11)
    s_waitcnt lgkmcnt(4)
    v_mfma_f32_32x32x16_bf16 v[4:19], v[82:85], v[144:147], v[4:19]
    v_mfma_f32_32x32x16_bf16 v[20:35], v[86:89], v[144:147], v[20:35]
    s_waitcnt lgkmcnt(0)
    s_barrier
    ds_read_b64_tr_b16 v[74:75], v164 offset:0
    ds_read_b64_tr_b16 v[76:77], v164 offset:1024
    ds_read_b64_tr_b16 v[78:79], v165 offset:0
    ds_read_b64_tr_b16 v[80:81], v165 offset:1024
    s_add_u32 s76, s75, 14336
    buffer_load_dwordx4 v[144:147], v0, s[32:35], s76 offen sc1
    s_waitcnt vmcnt(11)
    s_waitcnt lgkmcnt(4)
    v_mfma_f32_32x32x16_bf16 v[4:19], v[90:93], v[148:151], v[4:19]
    v_mfma_f32_32x32x16_bf16 v[20:35], v[94:97], v[148:151], v[20:35]
    ds_read_b64_tr_b16 v[82:83], v164 offset:4096
    ds_read_b64_tr_b16 v[84:85], v164 offset:5120
    ds_read_b64_tr_b16 v[86:87], v165 offset:4096
    ds_read_b64_tr_b16 v[88:89], v165 offset:5120
    s_add_u32 s76, s75, 22528
    buffer_load_dwordx4 v[148:151], v0, s[32:35], s76 offen sc1
    s_waitcnt vmcnt(11)
    s_waitcnt lgkmcnt(4)
    v_mfma_f32_32x32x16_bf16 v[4:19], v[74:77], v[152:155], v[4:19]
    v_mfma_f32_32x32x16_bf16 v[20:35], v[78:81], v[152:155], v[20:35]
    ds_read_b64_tr_b16 v[90:91], v164 offset:8192
    ds_read_b64_tr_b16 v[92:93], v164 offset:9216
    ds_read_b64_tr_b16 v[94:95], v165 offset:8192
    ds_read_b64_tr_b16 v[96:97], v165 offset:9216
    s_add_u32 s76, s75, 30720
    buffer_load_dwordx4 v[152:155], v0, s[32:35], s76 offen sc1
    s_waitcnt vmcnt(11)
    s_waitcnt lgkmcnt(4)
    v_mfma_f32_32x32x16_bf16 v[4:19], v[82:85], v[156:159], v[4:19]
    v_mfma_f32_32x32x16_bf16 v[20:35], v[86:89], v[156:159], v[20:35]
    ds_read_b64_tr_b16 v[74:75], v164 offset:12288
    ds_read_b64_tr_b16 v[76:77], v164 offset:13312
    ds_read_b64_tr_b16 v[78:79], v165 offset:12288
    ds_read_b64_tr_b16 v[80:81], v165 offset:13312
    s_add_u32 s76, s75, 38912
    buffer_load_dwordx4 v[156:159], v0, s[32:35], s76 offen sc1
    s_waitcnt vmcnt(11)
    s_waitcnt lgkmcnt(4)
    v_mfma_f32_32x32x16_bf16 v[4:19], v[90:93], v[160:163], v[4:19]
    v_mfma_f32_32x32x16_bf16 v[20:35], v[94:97], v[160:163], v[20:35]
    ds_read_b64_tr_b16 v[82:83], v164 offset:16384
    ds_read_b64_tr_b16 v[84:85], v164 offset:17408
    ds_read_b64_tr_b16 v[86:87], v165 offset:16384
    ds_read_b64_tr_b16 v[88:89], v165 offset:17408
    s_add_u32 s76, s75, 47104
    buffer_load_dwordx4 v[160:163], v0, s[32:35], s76 offen sc1
    s_waitcnt vmcnt(11)
    s_waitcnt lgkmcnt(4)
    v_mfma_f32_32x32x16_bf16 v[4:19], v[74:77], v[116:119], v[4:19]
    v_mfma_f32_32x32x16_bf16 v[20:35], v[78:81], v[116:119], v[20:35]
    ds_read_b64_tr_b16 v[90:91], v164 offset:20480
    ds_read_b64_tr_b16 v[92:93], v164 offset:21504
    ds_read_b64_tr_b16 v[94:95], v165 offset:20480
    ds_read_b64_tr_b16 v[96:97], v165 offset:21504
    s_add_u32 s76, s75, 55296
    buffer_load_dwordx4 v[116:119], v0, s[32:35], s76 offen sc1
    s_waitcnt vmcnt(11)
    s_waitcnt lgkmcnt(4)
    v_mfma_f32_32x32x16_bf16 v[4:19], v[82:85], v[120:123], v[4:19]
    v_mfma_f32_32x32x16_bf16 v[20:35], v[86:89], v[120:123], v[20:35]
    ds_read_b64_tr_b16 v[74:75], v164 offset:24576
    ds_read_b64_tr_b16 v[76:77], v164 offset:25600
    ds_read_b64_tr_b16 v[78:79], v165 offset:24576
    ds_read_b64_tr_b16 v[80:81], v165 offset:25600
    s_add_u32 s76, s75, 63488
    buffer_load_dwordx4 v[120:123], v0, s[32:35], s76 offen sc1
    s_waitcnt vmcnt(11)
    s_waitcnt lgkmcnt(4)
    v_mfma_f32_32x32x16_bf16 v[4:19], v[90:93], v[124:127], v[4:19]
    v_mfma_f32_32x32x16_bf16 v[20:35], v[94:97], v[124:127], v[20:35]
    ds_read_b64_tr_b16 v[82:83], v164 offset:28672
    ds_read_b64_tr_b16 v[84:85], v164 offset:29696
    ds_read_b64_tr_b16 v[86:87], v165 offset:28672
    ds_read_b64_tr_b16 v[88:89], v165 offset:29696
    s_add_u32 s76, s75, 71680
    buffer_load_dwordx4 v[124:127], v0, s[32:35], s76 offen sc1
    s_waitcnt vmcnt(11)
    s_waitcnt lgkmcnt(4)
    v_mfma_f32_32x32x16_bf16 v[4:19], v[74:77], v[128:131], v[4:19]
    v_mfma_f32_32x32x16_bf16 v[20:35], v[78:81], v[128:131], v[20:35]
    s_waitcnt lgkmcnt(0)
    s_barrier
    ds_read_b64_tr_b16 v[90:91], v164 offset:32768
    ds_read_b64_tr_b16 v[92:93], v164 offset:33792
    ds_read_b64_tr_b16 v[94:95], v165 offset:32768
    ds_read_b64_tr_b16 v[96:97], v165 offset:33792
    s_add_u32 s76, s75, 79872
    buffer_load_dwordx4 v[128:131], v0, s[32:35], s76 offen sc1
    s_waitcnt vmcnt(11)
    s_waitcnt lgkmcnt(4)
    v_mfma_f32_32x32x16_bf16 v[4:19], v[82:85], v[132:135], v[4:19]
    v_mfma_f32_32x32x16_bf16 v[20:35], v[86:89], v[132:135], v[20:35]
    ds_read_b64_tr_b16 v[74:75], v164 offset:36864
    ds_read_b64_tr_b16 v[76:77], v164 offset:37888
    ds_read_b64_tr_b16 v[78:79], v165 offset:36864
    ds_read_b64_tr_b16 v[80:81], v165 offset:37888
    s_add_u32 s76, s75, 88064
    buffer_load_dwordx4 v[132:135], v0, s[32:35], s76 offen sc1
    s_waitcnt vmcnt(11)
    s_waitcnt lgkmcnt(4)
    v_mfma_f32_32x32x16_bf16 v[4:19], v[90:93], v[136:139], v[4:19]
    v_mfma_f32_32x32x16_bf16 v[20:35], v[94:97], v[136:139], v[20:35]
    ds_read_b64_tr_b16 v[82:83], v164 offset:40960
    ds_read_b64_tr_b16 v[84:85], v164 offset:41984
    ds_read_b64_tr_b16 v[86:87], v165 offset:40960
    ds_read_b64_tr_b16 v[88:89], v165 offset:41984
    s_add_u32 s76, s75, 96256
    buffer_load_dwordx4 v[136:139], v0, s[32:35], s76 offen sc1
    s_waitcnt vmcnt(11)
    s_waitcnt lgkmcnt(4)
    v_mfma_f32_32x32x16_bf16 v[4:19], v[74:77], v[140:143], v[4:19]
    v_mfma_f32_32x32x16_bf16 v[20:35], v[78:81], v[140:143], v[20:35]
    ds_read_b64_tr_b16 v[90:91], v164 offset:45056
    ds_read_b64_tr_b16 v[92:93], v164 offset:46080
    ds_read_b64_tr_b16 v[94:95], v165 offset:45056
    ds_read_b64_tr_b16 v[96:97], v165 offset:46080
    s_add_u32 s76, s75, 104448
    buffer_load_dwordx4 v[140:143], v0, s[32:35], s76 offen sc1
    s_waitcnt vmcnt(11)
    s_waitcnt lgkmcnt(4)
    v_mfma_f32_32x32x16_bf16 v[4:19], v[82:85], v[144:147], v[4:19]
    v_mfma_f32_32x32x16_bf16 v[20:35], v[86:89], v[144:147], v[20:35]
    ds_read_b64_tr_b16 v[74:75], v164 offset:49152
    ds_read_b64_tr_b16 v[76:77], v164 offset:50176
    ds_read_b64_tr_b16 v[78:79], v165 offset:49152
    ds_read_b64_tr_b16 v[80:81], v165 offset:50176
    s_add_u32 s76, s75, 112640
    buffer_load_dwordx4 v[144:147], v0, s[32:35], s76 offen sc1
    s_waitcnt vmcnt(11)
    s_waitcnt lgkmcnt(4)
    v_mfma_f32_32x32x16_bf16 v[4:19], v[90:93], v[148:151], v[4:19]
    v_mfma_f32_32x32x16_bf16 v[20:35], v[94:97], v[148:151], v[20:35]
    ds_read_b64_tr_b16 v[82:83], v164 offset:53248
    ds_read_b64_tr_b16 v[84:85], v164 offset:54272
    ds_read_b64_tr_b16 v[86:87], v165 offset:53248
    ds_read_b64_tr_b16 v[88:89], v165 offset:54272
    s_waitcnt vmcnt(10)
    s_waitcnt lgkmcnt(4)
    v_mfma_f32_32x32x16_bf16 v[4:19], v[74:77], v[152:155], v[4:19]
    v_mfma_f32_32x32x16_bf16 v[20:35], v[78:81], v[152:155], v[20:35]
    ds_read_b64_tr_b16 v[90:91], v164 offset:57344
    ds_read_b64_tr_b16 v[92:93], v164 offset:58368
    ds_read_b64_tr_b16 v[94:95], v165 offset:57344
    ds_read_b64_tr_b16 v[96:97], v165 offset:58368
    s_waitcnt vmcnt(9)
    s_waitcnt lgkmcnt(4)
    v_mfma_f32_32x32x16_bf16 v[4:19], v[82:85], v[156:159], v[4:19]
    v_mfma_f32_32x32x16_bf16 v[20:35], v[86:89], v[156:159], v[20:35]
    ds_read_b64_tr_b16 v[74:75], v164 offset:61440
    ds_read_b64_tr_b16 v[76:77], v164 offset:62464
    ds_read_b64_tr_b16 v[78:79], v165 offset:61440
    ds_read_b64_tr_b16 v[80:81], v165 offset:62464
    s_waitcnt vmcnt(8)
    s_waitcnt lgkmcnt(4)
    v_mfma_f32_32x32x16_bf16 v[4:19], v[90:93], v[160:163], v[4:19]
    v_mfma_f32_32x32x16_bf16 v[20:35], v[94:97], v[160:163], v[20:35]
    s_waitcnt lgkmcnt(0)
    s_barrier
    ds_read_b64_tr_b16 v[82:83], v166 offset:0
    ds_read_b64_tr_b16 v[84:85], v166 offset:1024
    ds_read_b64_tr_b16 v[86:87], v167 offset:0
    ds_read_b64_tr_b16 v[88:89], v167 offset:1024
    s_waitcnt vmcnt(7)
    s_waitcnt lgkmcnt(4)
    v_mfma_f32_32x32x16_bf16 v[4:19], v[74:77], v[116:119], v[4:19]
    v_mfma_f32_32x32x16_bf16 v[20:35], v[78:81], v[116:119], v[20:35]
    ds_read_b64_tr_b16 v[90:91], v166 offset:4096
    ds_read_b64_tr_b16 v[92:93], v166 offset:5120
    ds_read_b64_tr_b16 v[94:95], v167 offset:4096
    ds_read_b64_tr_b16 v[96:97], v167 offset:5120
    s_waitcnt vmcnt(6)
    s_waitcnt lgkmcnt(4)
    v_mfma_f32_32x32x16_bf16 v[4:19], v[82:85], v[120:123], v[4:19]
    v_mfma_f32_32x32x16_bf16 v[20:35], v[86:89], v[120:123], v[20:35]
    ds_read_b64_tr_b16 v[74:75], v166 offset:8192
    ds_read_b64_tr_b16 v[76:77], v166 offset:9216
    ds_read_b64_tr_b16 v[78:79], v167 offset:8192
    ds_read_b64_tr_b16 v[80:81], v167 offset:9216
    s_waitcnt vmcnt(5)
    s_waitcnt lgkmcnt(4)
    v_mfma_f32_32x32x16_bf16 v[4:19], v[90:93], v[124:127], v[4:19]
    v_mfma_f32_32x32x16_bf16 v[20:35], v[94:97], v[124:127], v[20:35]
    ds_read_b64_tr_b16 v[82:83], v166 offset:12288
    ds_read_b64_tr_b16 v[84:85], v166 offset:13312
    ds_read_b64_tr_b16 v[86:87], v167 offset:12288
    ds_read_b64_tr_b16 v[88:89], v167 offset:13312
    s_waitcnt vmcnt(4)
    s_waitcnt lgkmcnt(4)
    v_mfma_f32_32x32x16_bf16 v[4:19], v[74:77], v[128:131], v[4:19]
    v_mfma_f32_32x32x16_bf16 v[20:35], v[78:81], v[128:131], v[20:35]
    ds_read_b64_tr_b16 v[90:91], v166 offset:16384
    ds_read_b64_tr_b16 v[92:93], v166 offset:17408
    ds_read_b64_tr_b16 v[94:95], v167 offset:16384
    ds_read_b64_tr_b16 v[96:97], v167 offset:17408
    s_waitcnt vmcnt(3)
    s_waitcnt lgkmcnt(4)
    v_mfma_f32_32x32x16_bf16 v[4:19], v[82:85], v[132:135], v[4:19]
    v_mfma_f32_32x32x16_bf16 v[20:35], v[86:89], v[132:135], v[20:35]
    ds_read_b64_tr_b16 v[74:75], v166 offset:20480
    ds_read_b64_tr_b16 v[76:77], v166 offset:21504
    ds_read_b64_tr_b16 v[78:79], v167 offset:20480
    ds_read_b64_tr_b16 v[80:81], v167 offset:21504
    s_waitcnt vmcnt(2)
    s_waitcnt lgkmcnt(4)
    v_mfma_f32_32x32x16_bf16 v[4:19], v[90:93], v[136:139], v[4:19]
    v_mfma_f32_32x32x16_bf16 v[20:35], v[94:97], v[136:139], v[20:35]
    ds_read_b64_tr_b16 v[82:83], v166 offset:24576
    ds_read_b64_tr_b16 v[84:85], v166 offset:25600
    ds_read_b64_tr_b16 v[86:87], v167 offset:24576
    ds_read_b64_tr_b16 v[88:89], v167 offset:25600
    s_waitcnt vmcnt(1)
    s_waitcnt lgkmcnt(4)
    v_mfma_f32_32x32x16_bf16 v[4:19], v[74:77], v[140:143], v[4:19]
    v_mfma_f32_32x32x16_bf16 v[20:35], v[78:81], v[140:143], v[20:35]
    s_waitcnt vmcnt(0)
    s_waitcnt lgkmcnt(0)
    v_mfma_f32_32x32x16_bf16 v[4:19], v[82:85], v[144:147], v[4:19]
    v_mfma_f32_32x32x16_bf16 v[20:35], v[86:89], v[144:147], v[20:35]
    s_waitcnt lgkmcnt(0)
    s_barrier
    s_lshl_b32 s52, s44, 12
    s_add_u32 s52, s52, 0
    v_add_u32 v200, s52, v0
    s_xor_b32 s53, s44, 1
    s_lshl_b32 s53, s53, 12
    s_add_u32 s53, s53, 0
    v_add_u32 v201, s53, v0
    s_cmp_eq_u32 s57, 0
    s_nop 7

    s_cbranch_scc1 L_kr_4_a
    ds_write_b128 v200, v[4:7] offset:0
    ds_write_b128 v200, v[8:11] offset:1024
    ds_write_b128 v200, v[12:15] offset:2048
    ds_write_b128 v200, v[16:19] offset:3072
    v_mov_b32 v36, v20
    v_mov_b32 v37, v21
    v_mov_b32 v38, v22
    v_mov_b32 v39, v23
    v_mov_b32 v40, v24
    v_mov_b32 v41, v25
    v_mov_b32 v42, v26
    v_mov_b32 v43, v27
    v_mov_b32 v44, v28
    v_mov_b32 v45, v29
    v_mov_b32 v46, v30
    v_mov_b32 v47, v31
    v_mov_b32 v48, v32
    v_mov_b32 v49, v33
    v_mov_b32 v50, v34
    v_mov_b32 v51, v35
    s_branch L_kr_4_b
L_kr_4_a:
    ds_write_b128 v200, v[20:23] offset:0
    ds_write_b128 v200, v[24:27] offset:1024
    ds_write_b128 v200, v[28:31] offset:2048
    ds_write_b128 v200, v[32:35] offset:3072
    v_mov_b32 v36, v4
    v_mov_b32 v37, v5
    v_mov_b32 v38, v6
    v_mov_b32 v39, v7
    v_mov_b32 v40, v8
    v_mov_b32 v41, v9
    v_mov_b32 v42, v10
    v_mov_b32 v43, v11
    v_mov_b32 v44, v12
    v_mov_b32 v45, v13
    v_mov_b32 v46, v14
    v_mov_b32 v47, v15
    v_mov_b32 v48, v16
    v_mov_b32 v49, v17
    v_mov_b32 v50, v18
    v_mov_b32 v51, v19
L_kr_4_b:
    s_waitcnt lgkmcnt(0)
    s_barrier
    ds_read_b128 v[208:211], v201 offset:0
    ds_read_b128 v[212:215], v201 offset:1024
    ds_read_b128 v[216:219], v201 offset:2048
    ds_read_b128 v[220:223], v201 offset:3072
    s_waitcnt lgkmcnt(3)
    v_pk_add_f32 v[36:37], v[36:37], v[208:209]
    v_pk_add_f32 v[38:39], v[38:39], v[210:211]
    s_waitcnt lgkmcnt(2)
    v_pk_add_f32 v[40:41], v[40:41], v[212:213]
    v_pk_add_f32 v[42:43], v[42:43], v[214:215]
    s_waitcnt lgkmcnt(1)
    v_pk_add_f32 v[44:45], v[44:45], v[216:217]
    v_pk_add_f32 v[46:47], v[46:47], v[218:219]
    s_waitcnt lgkmcnt(0)
    v_pk_add_f32 v[48:49], v[48:49], v[220:221]
    v_pk_add_f32 v[50:51], v[50:51], v[222:223]
    v_lshrrev_b32 v200, 5, v1
    v_lshlrev_b32 v200, 4, v200
    s_lshl_b32 s53, s57, 7
    s_add_u32 s53, s53, 163072
    v_add_u32 v238, s53, v200

    ds_read_b128 v[64:67], v238 offset:0
    ds_read_b128 v[68:71], v238 offset:32
    ds_read_b128 v[72:75], v238 offset:64
    ds_read_b128 v[76:79], v238 offset:96
    s_mov_b32 s56, 0xffff0000
    v_lshlrev_b32 v80, 16, v244
    v_and_b32 v81, s56, v244
    v_lshlrev_b32 v82, 16, v245
    v_and_b32 v83, s56, v245
    v_lshlrev_b32 v84, 16, v246
    v_and_b32 v85, s56, v246
    v_lshlrev_b32 v86, 16, v247
    v_and_b32 v87, s56, v247
    v_lshlrev_b32 v88, 16, v248
    v_and_b32 v89, s56, v248
    v_lshlrev_b32 v90, 16, v249
    v_and_b32 v91, s56, v249
    v_lshlrev_b32 v92, 16, v250
    v_and_b32 v93, s56, v250
    v_lshlrev_b32 v94, 16, v251
    v_and_b32 v95, s56, v251
    s_lshl_b32 s52, s45, 8
    s_lshl_b32 s53, s47, 6
    s_add_u32 s52, s52, s53
    s_lshl_b32 s53, s58, 5
    s_add_u32 s52, s52, s53
    v_and_b32 v236, 31, v1
    v_add_u32 v236, s52, v236
    v_lshlrev_b32 v236, 10, v236
    v_lshrrev_b32 v237, 5, v1
    v_lshl_add_u32 v236, v237, 3, v236
    s_lshl_b32 s52, s48, 7
    s_lshl_b32 s53, s57, 6
    s_add_u32 s52, s52, s53
    v_add_u32 v236, s52, v236

    s_mov_b32 s36, s22
    s_and_b32 s37, s23, 0xffff
    s_mov_b32 s38, 0x200000
    s_mov_b32 s39, 0x20000
    s_waitcnt lgkmcnt(0)
    v_pk_fma_f32 v[36:37], v[36:37], v[64:65], v[80:81]
    v_pk_fma_f32 v[38:39], v[38:39], v[66:67], v[82:83]
    v_pk_fma_f32 v[40:41], v[40:41], v[68:69], v[84:85]
    v_pk_fma_f32 v[42:43], v[42:43], v[70:71], v[86:87]
    v_pk_fma_f32 v[44:45], v[44:45], v[72:73], v[88:89]
    v_pk_fma_f32 v[46:47], v[46:47], v[74:75], v[90:91]
    v_pk_fma_f32 v[48:49], v[48:49], v[76:77], v[92:93]
    v_pk_fma_f32 v[50:51], v[50:51], v[78:79], v[94:95]
    v_cvt_pk_bf16_f32 v4, v36, v37
    v_cvt_pk_bf16_f32 v5, v38, v39
    v_cvt_pk_bf16_f32 v6, v40, v41
    v_cvt_pk_bf16_f32 v7, v42, v43
    v_cvt_pk_bf16_f32 v8, v44, v45
    v_cvt_pk_bf16_f32 v9, v46, v47
    v_cvt_pk_bf16_f32 v10, v48, v49
    v_cvt_pk_bf16_f32 v11, v50, v51
    v_lshl_add_u32 v236, v237, 3, v236
    s_nop 0
    v_permlane32_swap_b32 v4, v6
    v_permlane32_swap_b32 v5, v7
    v_permlane32_swap_b32 v8, v10
    v_permlane32_swap_b32 v9, v11
    s_nop 0
    buffer_store_dwordx4 v[4:7], v236, s[36:39], 0 offen offset:0
    buffer_store_dwordx4 v[8:11], v236, s[36:39], 0 offen offset:32
    s_branch L_fin
.section .rodata,"a"
.p2align 6
.amdhsa_kernel adaLN_cond__sliding_local_dilated__glu_gated_glu__prompt_kernel
  .amdhsa_next_free_vgpr 256
  .amdhsa_next_free_sgpr 102
  .amdhsa_accum_offset 256
  .amdhsa_group_segment_fixed_size 0
  .amdhsa_kernarg_size 96
  .amdhsa_user_sgpr_count 2
  .amdhsa_user_sgpr_kernarg_segment_ptr 1
  .amdhsa_system_sgpr_workgroup_id_x 1
.end_amdhsa_kernel
```
